```python
import torch

def _softmax(x, axis=-1):
    return torch.softmax(x, dim=axis)
def _gelu(x):
    return torch.nn.functional.gelu(x, approximate="tanh")
def _silu(x):
    return torch.nn.functional.silu(x)
def _sigmoid(x):
    return torch.sigmoid(x)
def _layernorm(x, axis=-1, eps=1e-5):
    m = x.mean(dim=axis, keepdim=True)
    v = x.var(dim=axis, keepdim=True, unbiased=False)
    return (x - m) / torch.sqrt(v + eps)
def _scatter_add(tgt, idx, src, axis=0):
    return tgt.clone().index_add_(axis, idx, src)
def _segment_sum(src, seg, n):
    out = torch.zeros((n,) + src.shape[1:], dtype=src.dtype)
    return out.index_add_(0, seg, src)
def _pad(x, pw):
    flat = tuple(v for pair in reversed(pw) for v in pair)
    return torch.nn.functional.pad(x, flat)

kernel_name = 'concat_heads__gqa_block_cached__mha_block_cached__near_ridge'

def setup_inputs():

    _w = (lambda a: (lambda t: t.to(torch.bfloat16) if t.is_floating_point() else t)(torch.as_tensor(a)))
    def _A_setup():
        B, Sq, D = 32, 32, 640
        Hq, Hkv, Sk, Dh = 32, 32, 32, 128
        assert Hq % Hkv == 0, (Hq, Hkv)
        return {
            "x": _w((lambda *s: torch.randn(*s, dtype=torch.bfloat16) * 0.8)(B, Sq, D)),
            "k_cache": _w((lambda *s: torch.randn(*s, dtype=torch.bfloat16) * 0.8)(B, Hkv, Sk, Dh)),
            "v_cache": _w((lambda *s: torch.randn(*s, dtype=torch.bfloat16) * 0.05)(B, Hkv, Sk, Dh)),
            "wq": _w((lambda *s: torch.randn(*s, dtype=torch.bfloat16) * 0.8)(D, Hq * Dh) * (D ** -0.5)),
            "wo": _w((lambda *s: torch.randn(*s, dtype=torch.bfloat16) * 0.05)(Hq * Dh, D) * ((Hq * Dh) ** -0.5)),
        }
    _A_in = _A_setup()

    def _B_setup():
        B, Sq, D = 32, 32, 640
        H, Sk, Dh = 32, 32, 128
        return {
            "x": _w((lambda *s: torch.randn(*s, dtype=torch.bfloat16) * 0.8)(B, Sq, D)),
            "k_cache": _w((lambda *s: torch.randn(*s, dtype=torch.bfloat16) * 0.8)(B, H, Sk, Dh)),
            "v_cache": _w((lambda *s: torch.randn(*s, dtype=torch.bfloat16) * 0.05)(B, H, Sk, Dh)),
            "wq": _w((lambda *s: torch.randn(*s, dtype=torch.bfloat16) * 0.8)(D, H * Dh) * (D ** -0.5)),
            "wo": _w((lambda *s: torch.randn(*s, dtype=torch.bfloat16) * 0.05)(H * Dh, D) * ((H * Dh) ** -0.5)),
        }
    _B_in = _B_setup()

    return {
        "A_x": _A_in["x"],
        "A_k_cache": _A_in["k_cache"],
        "A_v_cache": _A_in["v_cache"],
        "A_wq": _A_in["wq"],
        "A_wo": _A_in["wo"],
        "B_x": _B_in["x"],
        "B_k_cache": _B_in["k_cache"],
        "B_v_cache": _B_in["v_cache"],
        "B_wq": _B_in["wq"],
        "B_wo": _B_in["wo"],
    }

def reference(A_x, A_k_cache, A_v_cache, A_wq, A_wo, B_x, B_k_cache, B_v_cache, B_wq, B_wo):
    def _A_ref(x, k_cache, v_cache, wq, wo):
        B, Sq, D = x.shape
        Hq, Dh = 32, 128
        Hkv = k_cache.shape[1]
        rep = Hq // Hkv
        q = (lambda x, *d: x.permute(*d))((x @ wq).reshape(B, Sq, Hq, Dh), 0, 2, 1, 3)
        k = (lambda x, n, axis: torch.repeat_interleave(x, n, dim=axis))(k_cache, rep, axis=1)
        v = (lambda x, n, axis: torch.repeat_interleave(x, n, dim=axis))(v_cache, rep, axis=1)
        scores = torch.einsum("bhqd,bhkd->bhqk", q, k) * (Dh ** -0.5)
        p = _softmax(scores, axis=-1)
        o = torch.einsum("bhqk,bhkd->bhqd", p, v)
        return (lambda x, *d: x.permute(*d))(o, 0, 2, 1, 3).reshape(B, Sq, Hq * Dh) @ wo

    def _B_ref(x, k_cache, v_cache, wq, wo):
        B, Sq, D = x.shape
        H, Dh = 32, 128
        q = (lambda x, *d: x.permute(*d))((x @ wq).reshape(B, Sq, H, Dh), 0, 2, 1, 3)
        scores = torch.einsum("bhqd,bhkd->bhqk", q, k_cache) * (Dh ** -0.5)
        p = _softmax(scores, axis=-1)
        o = torch.einsum("bhqk,bhkd->bhqd", p, v_cache)
        return (lambda x, *d: x.permute(*d))(o, 0, 2, 1, 3).reshape(B, Sq, H * Dh) @ wo

    a = _A_ref(A_x, A_k_cache, A_v_cache, A_wq, A_wo)
    b = _B_ref(B_x, B_k_cache, B_v_cache, B_wq, B_wo)
    return torch.concatenate([a, b], axis=-1)
```

```asm
; @launch grid=(256,1,1) block=(256,1,1) lds=163840
.amdgcn_target "amdgcn-amd-amdhsa--gfx950"
.text
.globl concat_heads__gqa_block_cached__mha_block_cached__near_ridge_kernel
.p2align 8
.type concat_heads__gqa_block_cached__mha_block_cached__near_ridge_kernel,@function
concat_heads__gqa_block_cached__mha_block_cached__near_ridge_kernel:
    s_cmp_ge_u32 s2, 256
    s_cbranch_scc1 L_main_end
    s_load_dwordx16 s[32:47], s[0:1], 0
    s_load_dwordx4 s[48:51], s[0:1], 64
    s_load_dwordx2 s[28:29], s[0:1], 96
    v_lshrrev_b32 v1, 6, v0
    v_and_b32 v0, 63, v0
    v_readfirstlane_b32 s3, v1
    s_lshr_b32 s6, s2, 3
    s_getpc_b64 s[52:53]
L_pc:
    s_sub_u32 s52, s52, L_pc-concat_heads__gqa_block_cached__mha_block_cached__near_ridge_kernel
    s_subb_u32 s53, s53, 0
    s_lshl_b32 s7, s6, 2
    s_add_u32 s7, s7, s3
    s_min_u32 s7, s7, (L_code_end-concat_heads__gqa_block_cached__mha_block_cached__near_ridge_kernel)/1024-1
    s_lshl_b32 s7, s7, 10
    v_lshl_add_u32 v1, v0, 4, s7
    global_load_dwordx4 v[16:19], v1, s[52:53]
    s_lshr_b32 s4, s6, 1
    s_and_b32 s6, s6, 1
    s_and_b32 s5, s2, 3
    s_lshl_b32 s5, s5, 1
    s_add_u32 s5, s5, s6
    s_movk_i32 s95, 0x78
    v_and_b32 v20, 15, v0
    v_lshrrev_b32 v21, 4, v0
    v_xor_b32 v22, v21, v0
    v_and_b32 v22, 7, v22
    v_lshlrev_b32 v22, 4, v22
    v_lshrrev_b32 v23, 3, v0
    v_mul_u32_u24 v23, 1280, v23
    v_add_u32 v10, v22, v23
    v_xor_b32 v22, 64, v22
    v_add_u32 v23, 10240, v23
    v_add_u32 v11, v22, v23
    v_lshlrev_b32 v22, 4, v20
    v_lshl_add_u32 v2, v21, 16, v22
    v_add_u32 v3, 8192, v2
    v_add_u32 v4, 16384, v2
    v_add_u32 v5, 24576, v2
    v_add_u32 v6, 32768, v2
    v_add_u32 v7, 40960, v2
    v_add_u32 v8, 49152, v2
    v_add_u32 v9, 57344, v2
    s_mov_b32 s10, 1310720
    s_mov_b32 s11, 0x20000
    s_mov_b32 s14, 8388608
    s_mov_b32 s15, 0x20000
    s_mov_b32 s18, 8388608
    s_mov_b32 s19, 0x20000
    s_mov_b32 s22, 5242880
    s_mov_b32 s23, 0x20000
    s_mov_b32 s26, 5242880
    s_mov_b32 s27, 0x20000
    s_mov_b32 s30, 268435456
    s_mov_b32 s31, 0x20000
    s_lshl_b32 s98, s5, 2
    s_add_u32 s98, s98, s3
    s_lshl_b32 s7, s98, 8
    v_add_u32 v2, s7, v2
    v_add_u32 v3, s7, v3
    v_add_u32 v4, s7, v4
    v_add_u32 v5, s7, v5
    v_add_u32 v6, s7, v6
    v_add_u32 v7, s7, v7
    v_add_u32 v8, s7, v8
    v_add_u32 v9, s7, v9
    s_lshl_b32 s95, s4, 2
    s_add_u32 s95, s95, s3
    s_mul_i32 s95, s95, 20480
    s_lshl_b32 s97, s3, 11
    s_add_u32 s97, s97, 65536
    s_mul_i32 s7, s4, 5
    s_lshr_b32 vcc_lo, s7, 3
    s_lshl_b32 vcc_lo, vcc_lo, 7
    s_lshr_b32 s7, s7, 2
    s_lshl_b32 s7, s7, 18
    s_bitcmp1_b32 s2, 2
    s_waitcnt lgkmcnt(0)
    s_cselect_b32 s8, s42, s32
    s_cselect_b32 s9, s43, s33
    s_cselect_b32 s12, s44, s34
    s_cselect_b32 s13, s45, s35
    s_cselect_b32 s16, s46, s36
    s_cselect_b32 s17, s47, s37
    s_cselect_b32 s20, s48, s38
    s_cselect_b32 s21, s49, s39
    s_cselect_b32 s24, s50, s40
    s_cselect_b32 s25, s51, s41
    s_mov_b32 s32, s7
    s_lshl_b32 s99, vcc_lo, 6
    s_add_u32 m0, s99, s97
    s_add_u32 s99, s95, vcc_lo
    buffer_load_dwordx4 v10, s[8:11], s99 offen  lds
    s_add_u32 m0, m0, 1024
    s_add_u32 vcc_lo, vcc_lo, 128
    buffer_load_dwordx4 v11, s[8:11], s99 offen  lds
    s_cmp_eq_u32 vcc_lo, 1280
    s_cselect_b32 vcc_lo, 0, vcc_lo
    s_lshl_b32 s99, vcc_lo, 6
    s_add_u32 m0, s99, s97
    s_add_u32 s99, s95, vcc_lo
    buffer_load_dwordx4 v10, s[8:11], s99 offen  lds
    s_add_u32 m0, m0, 1024
    s_add_u32 vcc_lo, vcc_lo, 128
    buffer_load_dwordx4 v11, s[8:11], s99 offen  lds
    s_cmp_eq_u32 vcc_lo, 1280
    s_cselect_b32 vcc_lo, 0, vcc_lo
    s_lshl_b32 s99, vcc_lo, 6
    s_add_u32 m0, s99, s97
    s_add_u32 s99, s95, vcc_lo
    buffer_load_dwordx4 v10, s[8:11], s99 offen  lds
    s_add_u32 m0, m0, 1024
    s_add_u32 vcc_lo, vcc_lo, 128
    buffer_load_dwordx4 v11, s[8:11], s99 offen  lds
    s_cmp_eq_u32 vcc_lo, 1280
    s_cselect_b32 vcc_lo, 0, vcc_lo
    buffer_load_dwordx4 v[32:35], v2, s[20:23], s32 offen
    buffer_load_dwordx4 v[36:39], v3, s[20:23], s32 offen
    buffer_load_dwordx4 v[40:43], v4, s[20:23], s32 offen
    buffer_load_dwordx4 v[44:47], v5, s[20:23], s32 offen
    buffer_load_dwordx4 v[48:51], v6, s[20:23], s32 offen
    buffer_load_dwordx4 v[52:55], v7, s[20:23], s32 offen
    buffer_load_dwordx4 v[56:59], v8, s[20:23], s32 offen
    buffer_load_dwordx4 v[60:63], v9, s[20:23], s32 offen
    s_add_u32 s33, s32, 262144
    s_cmp_eq_u32 s33, 5242880
    s_cselect_b32 s33, 0, s33
    s_add_u32 s34, s33, 262144
    s_cmp_eq_u32 s34, 5242880
    s_cselect_b32 s34, 0, s34
    s_add_u32 s35, s34, 262144
    s_cmp_eq_u32 s35, 5242880
    s_cselect_b32 s35, 0, s35
    s_add_u32 s36, s35, 262144
    s_cmp_eq_u32 s36, 5242880
    s_cselect_b32 s36, 0, s36
    s_add_u32 s37, s36, 262144
    s_cmp_eq_u32 s37, 5242880
    s_cselect_b32 s37, 0, s37
    s_add_u32 s38, s37, 262144
    s_cmp_eq_u32 s38, 5242880
    s_cselect_b32 s38, 0, s38
    s_add_u32 s39, s38, 262144
    s_cmp_eq_u32 s39, 5242880
    s_cselect_b32 s39, 0, s39
    s_add_u32 s40, s39, 262144
    s_cmp_eq_u32 s40, 5242880
    s_cselect_b32 s40, 0, s40
    s_add_u32 s41, s40, 262144
    s_cmp_eq_u32 s41, 5242880
    s_cselect_b32 s41, 0, s41
    s_add_u32 s42, s41, 262144
    s_cmp_eq_u32 s42, 5242880
    s_cselect_b32 s42, 0, s42
    s_add_u32 s43, s42, 262144
    s_cmp_eq_u32 s43, 5242880
    s_cselect_b32 s43, 0, s43
    s_add_u32 s44, s43, 262144
    s_cmp_eq_u32 s44, 5242880
    s_cselect_b32 s44, 0, s44
    s_add_u32 s45, s44, 262144
    s_cmp_eq_u32 s45, 5242880
    s_cselect_b32 s45, 0, s45
    s_add_u32 s46, s45, 262144
    s_cmp_eq_u32 s46, 5242880
    s_cselect_b32 s46, 0, s46
    s_add_u32 s47, s46, 262144
    s_cmp_eq_u32 s47, 5242880
    s_cselect_b32 s47, 0, s47
    s_add_u32 s48, s47, 262144
    s_cmp_eq_u32 s48, 5242880
    s_cselect_b32 s48, 0, s48
    s_add_u32 s49, s48, 262144
    s_cmp_eq_u32 s49, 5242880
    s_cselect_b32 s49, 0, s49
    s_add_u32 s50, s49, 262144
    s_cmp_eq_u32 s50, 5242880
    s_cselect_b32 s50, 0, s50
    s_add_u32 s51, s50, 262144
    s_cmp_eq_u32 s51, 5242880
    s_cselect_b32 s51, 0, s51
    s_mov_b32 s6, s98
    s_mov_b32 s93, 0x05040100
    s_mov_b32 s94, 0x07060302
    s_mul_i32 s6, s5, 655360
    s_lshl_b32 s7, s3, 8
    s_add_u32 s7, s7, s6
    s_add_u32 s99, s4, 0
    s_and_b32 s99, s99, 15
    s_and_b32 s98, s99, 3
    s_lshr_b32 s99, s99, 2
    s_lshl_b32 s99, s99, 4
    s_add_u32 s99, s99, s98
    s_mul_i32 s99, s99, 10240
    s_add_u32 s52, s99, s7
    s_add_u32 s99, s4, 1
    s_and_b32 s99, s99, 15
    s_and_b32 s98, s99, 3
    s_lshr_b32 s99, s99, 2
    s_lshl_b32 s99, s99, 4
    s_add_u32 s99, s99, s98
    s_mul_i32 s99, s99, 10240
    s_add_u32 s53, s99, s7
    s_add_u32 s99, s4, 2
    s_and_b32 s99, s99, 15
    s_and_b32 s98, s99, 3
    s_lshr_b32 s99, s99, 2
    s_lshl_b32 s99, s99, 4
    s_add_u32 s99, s99, s98
    s_mul_i32 s99, s99, 10240
    s_add_u32 s54, s99, s7
    s_add_u32 s99, s4, 3
    s_and_b32 s99, s99, 15
    s_and_b32 s98, s99, 3
    s_lshr_b32 s99, s99, 2
    s_lshl_b32 s99, s99, 4
    s_add_u32 s99, s99, s98
    s_mul_i32 s99, s99, 10240
    s_add_u32 s55, s99, s7
    s_add_u32 s99, s4, 4
    s_and_b32 s99, s99, 15
    s_and_b32 s98, s99, 3
    s_lshr_b32 s99, s99, 2
    s_lshl_b32 s99, s99, 4
    s_add_u32 s99, s99, s98
    s_mul_i32 s99, s99, 10240
    s_add_u32 s56, s99, s7
    s_add_u32 s99, s4, 5
    s_and_b32 s99, s99, 15
    s_and_b32 s98, s99, 3
    s_lshr_b32 s99, s99, 2
    s_lshl_b32 s99, s99, 4
    s_add_u32 s99, s99, s98
    s_mul_i32 s99, s99, 10240
    s_add_u32 s57, s99, s7
    s_add_u32 s99, s4, 6
    s_and_b32 s99, s99, 15
    s_and_b32 s98, s99, 3
    s_lshr_b32 s99, s99, 2
    s_lshl_b32 s99, s99, 4
    s_add_u32 s99, s99, s98
    s_mul_i32 s99, s99, 10240
    s_add_u32 s58, s99, s7
    s_add_u32 s99, s4, 7
    s_and_b32 s99, s99, 15
    s_and_b32 s98, s99, 3
    s_lshr_b32 s99, s99, 2
    s_lshl_b32 s99, s99, 4
    s_add_u32 s99, s99, s98
    s_mul_i32 s99, s99, 10240
    s_add_u32 s59, s99, s7
    s_add_u32 s99, s4, 8
    s_and_b32 s99, s99, 15
    s_and_b32 s98, s99, 3
    s_lshr_b32 s99, s99, 2
    s_lshl_b32 s99, s99, 4
    s_add_u32 s99, s99, s98
    s_mul_i32 s99, s99, 10240
    s_add_u32 s60, s99, s7
    s_add_u32 s99, s4, 9
    s_and_b32 s99, s99, 15
    s_and_b32 s98, s99, 3
    s_lshr_b32 s99, s99, 2
    s_lshl_b32 s99, s99, 4
    s_add_u32 s99, s99, s98
    s_mul_i32 s99, s99, 10240
    s_add_u32 s61, s99, s7
    s_add_u32 s99, s4, 10
    s_and_b32 s99, s99, 15
    s_and_b32 s98, s99, 3
    s_lshr_b32 s99, s99, 2
    s_lshl_b32 s99, s99, 4
    s_add_u32 s99, s99, s98
    s_mul_i32 s99, s99, 10240
    s_add_u32 s62, s99, s7
    s_add_u32 s99, s4, 11
    s_and_b32 s99, s99, 15
    s_and_b32 s98, s99, 3
    s_lshr_b32 s99, s99, 2
    s_lshl_b32 s99, s99, 4
    s_add_u32 s99, s99, s98
    s_mul_i32 s99, s99, 10240
    s_add_u32 s63, s99, s7
    s_add_u32 s99, s4, 12
    s_and_b32 s99, s99, 15
    s_and_b32 s98, s99, 3
    s_lshr_b32 s99, s99, 2
    s_lshl_b32 s99, s99, 4
    s_add_u32 s99, s99, s98
    s_mul_i32 s99, s99, 10240
    s_add_u32 s64, s99, s7
    s_add_u32 s99, s4, 13
    s_and_b32 s99, s99, 15
    s_and_b32 s98, s99, 3
    s_lshr_b32 s99, s99, 2
    s_lshl_b32 s99, s99, 4
    s_add_u32 s99, s99, s98
    s_mul_i32 s99, s99, 10240
    s_add_u32 s65, s99, s7
    s_add_u32 s99, s4, 14
    s_and_b32 s99, s99, 15
    s_and_b32 s98, s99, 3
    s_lshr_b32 s99, s99, 2
    s_lshl_b32 s99, s99, 4
    s_add_u32 s99, s99, s98
    s_mul_i32 s99, s99, 10240
    s_add_u32 s66, s99, s7
    s_add_u32 s99, s4, 15
    s_and_b32 s99, s99, 15
    s_and_b32 s98, s99, 3
    s_lshr_b32 s99, s99, 2
    s_lshl_b32 s99, s99, 4
    s_add_u32 s99, s99, s98
    s_mul_i32 s99, s99, 10240
    s_add_u32 s67, s99, s7
    s_mul_i32 s7, s3, 163840
    s_add_u32 s7, s7, s6
    s_add_u32 s7, s7, 1024
    s_add_u32 s68, s7, 0
    s_add_u32 s69, s7, 10240
    s_add_u32 s70, s7, 20480
    s_add_u32 s71, s7, 30720
    s_lshr_b32 s6, s2, 2
    s_and_b32 s6, s6, 1
    s_lshl_b32 s6, s6, 4
    s_add_u32 s6, s6, s4
    s_lshl_b32 s6, s6, 3
    s_add_u32 s6, s6, s5
    s_mul_i32 s92, s6, 81920
    s_mov_b32 s2, s6
    v_xor_b32 v22, v20, v21
    v_lshlrev_b32 v22, 4, v22
    v_lshl_add_u32 v12, v21, 8, v22
    v_lshlrev_b32 v22, 4, v20
    v_lshl_add_u32 v13, v21, 10, v22
    v_mul_u32_u24 v14, 40960, v21
    v_add_u32 v14, v14, v22
    v_add_u32 v15, 5120, v14
    s_lshr_b32 s99, s32, 19
    s_lshl_b32 s99, s99, 13
    s_bfe_u32 s98, s32, 0x10012
    s_lshl_b32 s98, s98, 6
    s_add_u32 s99, s99, 65536
    s_or_b32 s72, s99, s98
    s_lshr_b32 s99, s33, 19
    s_lshl_b32 s99, s99, 13
    s_bfe_u32 s98, s33, 0x10012
    s_lshl_b32 s98, s98, 6
    s_add_u32 s99, s99, 65536
    s_or_b32 s73, s99, s98
    s_lshr_b32 s99, s34, 19
    s_lshl_b32 s99, s99, 13
    s_bfe_u32 s98, s34, 0x10012
    s_lshl_b32 s98, s98, 6
    s_add_u32 s99, s99, 65536
    s_or_b32 s74, s99, s98
    s_lshr_b32 s99, s35, 19
    s_lshl_b32 s99, s99, 13
    s_bfe_u32 s98, s35, 0x10012
    s_lshl_b32 s98, s98, 6
    s_add_u32 s99, s99, 65536
    s_or_b32 s75, s99, s98
    s_lshr_b32 s99, s36, 19
    s_lshl_b32 s99, s99, 13
    s_bfe_u32 s98, s36, 0x10012
    s_lshl_b32 s98, s98, 6
    s_add_u32 s99, s99, 65536
    s_or_b32 s76, s99, s98
    s_lshr_b32 s99, s37, 19
    s_lshl_b32 s99, s99, 13
    s_bfe_u32 s98, s37, 0x10012
    s_lshl_b32 s98, s98, 6
    s_add_u32 s99, s99, 65536
    s_or_b32 s77, s99, s98
    s_lshr_b32 s99, s38, 19
    s_lshl_b32 s99, s99, 13
    s_bfe_u32 s98, s38, 0x10012
    s_lshl_b32 s98, s98, 6
    s_add_u32 s99, s99, 65536
    s_or_b32 s78, s99, s98
    s_lshr_b32 s99, s39, 19
    s_lshl_b32 s99, s99, 13
    s_bfe_u32 s98, s39, 0x10012
    s_lshl_b32 s98, s98, 6
    s_add_u32 s99, s99, 65536
    s_or_b32 s79, s99, s98
    s_lshr_b32 s99, s40, 19
    s_lshl_b32 s99, s99, 13
    s_bfe_u32 s98, s40, 0x10012
    s_lshl_b32 s98, s98, 6
    s_add_u32 s99, s99, 65536
    s_or_b32 s80, s99, s98
    s_lshr_b32 s99, s41, 19
    s_lshl_b32 s99, s99, 13
    s_bfe_u32 s98, s41, 0x10012
    s_lshl_b32 s98, s98, 6
    s_add_u32 s99, s99, 65536
    s_or_b32 s81, s99, s98
    s_lshr_b32 s99, s42, 19
    s_lshl_b32 s99, s99, 13
    s_bfe_u32 s98, s42, 0x10012
    s_lshl_b32 s98, s98, 6
    s_add_u32 s99, s99, 65536
    s_or_b32 s82, s99, s98
    s_lshr_b32 s99, s43, 19
    s_lshl_b32 s99, s99, 13
    s_bfe_u32 s98, s43, 0x10012
    s_lshl_b32 s98, s98, 6
    s_add_u32 s99, s99, 65536
    s_or_b32 s83, s99, s98
    s_lshr_b32 s99, s44, 19
    s_lshl_b32 s99, s99, 13
    s_bfe_u32 s98, s44, 0x10012
    s_lshl_b32 s98, s98, 6
    s_add_u32 s99, s99, 65536
    s_or_b32 s84, s99, s98
    s_lshr_b32 s99, s45, 19
    s_lshl_b32 s99, s99, 13
    s_bfe_u32 s98, s45, 0x10012
    s_lshl_b32 s98, s98, 6
    s_add_u32 s99, s99, 65536
    s_or_b32 s85, s99, s98
    s_lshr_b32 s99, s46, 19
    s_lshl_b32 s99, s99, 13
    s_bfe_u32 s98, s46, 0x10012
    s_lshl_b32 s98, s98, 6
    s_add_u32 s99, s99, 65536
    s_or_b32 s86, s99, s98
    s_lshr_b32 s99, s47, 19
    s_lshl_b32 s99, s99, 13
    s_bfe_u32 s98, s47, 0x10012
    s_lshl_b32 s98, s98, 6
    s_add_u32 s99, s99, 65536
    s_or_b32 s87, s99, s98
    s_lshr_b32 s99, s48, 19
    s_lshl_b32 s99, s99, 13
    s_bfe_u32 s98, s48, 0x10012
    s_lshl_b32 s98, s98, 6
    s_add_u32 s99, s99, 65536
    s_or_b32 s88, s99, s98
    s_lshr_b32 s99, s49, 19
    s_lshl_b32 s99, s99, 13
    s_bfe_u32 s98, s49, 0x10012
    s_lshl_b32 s98, s98, 6
    s_add_u32 s99, s99, 65536
    s_or_b32 s89, s99, s98
    s_lshr_b32 s99, s50, 19
    s_lshl_b32 s99, s99, 13
    s_bfe_u32 s98, s50, 0x10012
    s_lshl_b32 s98, s98, 6
    s_add_u32 s99, s99, 65536
    s_or_b32 s90, s99, s98
    s_lshr_b32 s99, s51, 19
    s_lshl_b32 s99, s99, 13
    s_bfe_u32 s98, s51, 0x10012
    s_lshl_b32 s98, s98, 6
    s_add_u32 s99, s99, 65536
    s_or_b32 s91, s99, s98
    buffer_load_dwordx4 v[64:67], v2, s[20:23], s33 offen
    buffer_load_dwordx4 v[68:71], v3, s[20:23], s33 offen
    buffer_load_dwordx4 v[72:75], v4, s[20:23], s33 offen
    buffer_load_dwordx4 v[76:79], v5, s[20:23], s33 offen
    buffer_load_dwordx4 v[80:83], v6, s[20:23], s33 offen
    buffer_load_dwordx4 v[84:87], v7, s[20:23], s33 offen
    buffer_load_dwordx4 v[88:91], v8, s[20:23], s33 offen
    buffer_load_dwordx4 v[92:95], v9, s[20:23], s33 offen
    buffer_load_dwordx4 v[96:99], v2, s[20:23], s34 offen
    buffer_load_dwordx4 v[100:103], v3, s[20:23], s34 offen
    buffer_load_dwordx4 v[104:107], v4, s[20:23], s34 offen
    buffer_load_dwordx4 v[108:111], v5, s[20:23], s34 offen
    buffer_load_dwordx4 v[112:115], v6, s[20:23], s34 offen
    buffer_load_dwordx4 v[116:119], v7, s[20:23], s34 offen
    buffer_load_dwordx4 v[120:123], v8, s[20:23], s34 offen
    buffer_load_dwordx4 v[124:127], v9, s[20:23], s34 offen
    s_lshl_b32 s99, vcc_lo, 6
    s_add_u32 m0, s99, s97
    s_add_u32 s99, s95, vcc_lo
    buffer_load_dwordx4 v10, s[8:11], s99 offen  lds
    s_add_u32 m0, m0, 1024
    s_add_u32 vcc_lo, vcc_lo, 128
    buffer_load_dwordx4 v11, s[8:11], s99 offen  lds
    s_cmp_eq_u32 vcc_lo, 1280
    s_cselect_b32 vcc_lo, 0, vcc_lo
    s_lshl_b32 s99, vcc_lo, 6
    s_add_u32 m0, s99, s97
    s_add_u32 s99, s95, vcc_lo
    buffer_load_dwordx4 v10, s[8:11], s99 offen  lds
    s_add_u32 m0, m0, 1024
    s_add_u32 vcc_lo, vcc_lo, 128
    buffer_load_dwordx4 v11, s[8:11], s99 offen  lds
    s_cmp_eq_u32 vcc_lo, 1280
    s_cselect_b32 vcc_lo, 0, vcc_lo
    s_lshl_b32 s99, vcc_lo, 6
    s_add_u32 m0, s99, s97
    s_add_u32 s99, s95, vcc_lo
    buffer_load_dwordx4 v10, s[8:11], s99 offen  lds
    s_add_u32 m0, m0, 1024
    s_add_u32 vcc_lo, vcc_lo, 128
    buffer_load_dwordx4 v11, s[8:11], s99 offen  lds
    s_cmp_eq_u32 vcc_lo, 1280
    s_cselect_b32 vcc_lo, 0, vcc_lo
    s_lshl_b32 s99, vcc_lo, 6
    s_add_u32 m0, s99, s97
    s_add_u32 s99, s95, vcc_lo
    buffer_load_dwordx4 v10, s[8:11], s99 offen  lds
    s_add_u32 m0, m0, 1024
    s_add_u32 vcc_lo, vcc_lo, 128
    buffer_load_dwordx4 v11, s[8:11], s99 offen  lds
    s_cmp_eq_u32 vcc_lo, 1280
    s_cselect_b32 vcc_lo, 0, vcc_lo
    s_lshl_b32 s99, vcc_lo, 6
    s_add_u32 m0, s99, s97
    s_add_u32 s99, s95, vcc_lo
    buffer_load_dwordx4 v10, s[8:11], s99 offen  lds
    s_add_u32 m0, m0, 1024
    s_add_u32 vcc_lo, vcc_lo, 128
    buffer_load_dwordx4 v11, s[8:11], s99 offen  lds
    s_cmp_eq_u32 vcc_lo, 1280
    s_cselect_b32 vcc_lo, 0, vcc_lo
    s_lshl_b32 s99, vcc_lo, 6
    s_add_u32 m0, s99, s97
    s_add_u32 s99, s95, vcc_lo
    buffer_load_dwordx4 v10, s[8:11], s99 offen  lds
    s_add_u32 m0, m0, 1024
    s_add_u32 vcc_lo, vcc_lo, 128
    buffer_load_dwordx4 v11, s[8:11], s99 offen  lds
    s_cmp_eq_u32 vcc_lo, 1280
    s_cselect_b32 vcc_lo, 0, vcc_lo
    s_lshl_b32 s99, vcc_lo, 6
    s_add_u32 m0, s99, s97
    s_add_u32 s99, s95, vcc_lo
    buffer_load_dwordx4 v10, s[8:11], s99 offen  lds
    s_add_u32 m0, m0, 1024
    s_add_u32 vcc_lo, vcc_lo, 128
    buffer_load_dwordx4 v11, s[8:11], s99 offen  lds
    s_cmp_eq_u32 vcc_lo, 1280
    s_cselect_b32 vcc_lo, 0, vcc_lo
    s_lshl_b32 s6, s5, 2
    s_add_u32 s6, s6, s3
    s_lshl_b32 s8, s4, 6
    s_add_u32 s8, s8, s6
    s_lshl_b32 s8, s8, 13
    s_add_u32 s9, s8, 4096
    s_add_u32 s10, s8, 262144
    s_add_u32 s11, s8, 266240
    s_lshl_b32 s96, s3, 14
    s_mov_b32 s97, 0x3e0293ee
    s_cmp_lg_u32 s3, 0
    s_cbranch_scc1 L_noclr
    s_lshr_b32 s6, s2, 3
    s_lshl_b32 s6, s6, 9
    s_and_b32 s99, s2, 7
    s_lshl_b32 s99, s99, 2
    s_add_u32 s6, s6, s99
    s_add_u32 s6, s6, 33554432
    v_mov_b32 v1, 0
    v_lshlrev_b32 v22, 7, v20
    s_mov_b64 exec, 15
    buffer_store_dword v1, v22, s[28:31], s6 offen sc1
    s_mov_b64 exec, -1
L_noclr:
    v_lshrrev_b32 v22, 1, v20
    v_xor_b32 v22, v22, v21
    v_lshlrev_b32 v22, 4, v22
    v_lshl_add_u32 v11, v20, 7, v22
    s_and_b32 s7, s4, 3
    s_waitcnt vmcnt(38)
    s_barrier
    v_xor_b32 v10, s72, v11
    ds_read_b128 a[64:67], v10 offset:0
    ds_read_b128 a[68:71], v10 offset:2048
    ds_read_b128 a[72:75], v10 offset:4096
    ds_read_b128 a[76:79], v10 offset:6144
    s_waitcnt vmcnt(30)
    v_perm_b32 v16, v36, v32, s93
    v_perm_b32 v17, v44, v40, s93
    v_perm_b32 v18, v52, v48, s93
    v_perm_b32 v19, v60, v56, s93
    v_perm_b32 v20, v36, v32, s94
    v_perm_b32 v21, v44, v40, s94
    v_perm_b32 v22, v52, v48, s94
    v_perm_b32 v23, v60, v56, s94
    s_waitcnt lgkmcnt(0)
    v_mfma_f32_16x16x32_bf16 v[128:131], v[16:19], a[64:67], 0
    v_perm_b32 v24, v37, v33, s93
    v_perm_b32 v25, v45, v41, s93
    v_mfma_f32_16x16x32_bf16 v[160:163], v[16:19], a[68:71], 0
    v_xor_b32 v10, s73, v11
    v_mfma_f32_16x16x32_bf16 v[192:195], v[16:19], a[72:75], 0
    v_perm_b32 v26, v53, v49, s93
    v_perm_b32 v27, v61, v57, s93
    v_mfma_f32_16x16x32_bf16 v[224:227], v[16:19], a[76:79], 0
    ds_read_b128 a[80:83], v10 offset:0
    v_mfma_f32_16x16x32_bf16 v[132:135], v[20:23], a[64:67], 0
    v_perm_b32 v28, v37, v33, s94
    v_perm_b32 v29, v45, v41, s94
    v_mfma_f32_16x16x32_bf16 v[164:167], v[20:23], a[68:71], 0
    ds_read_b128 a[84:87], v10 offset:2048
    v_mfma_f32_16x16x32_bf16 v[196:199], v[20:23], a[72:75], 0
    v_perm_b32 v30, v53, v49, s94
    v_perm_b32 v31, v61, v57, s94
    v_mfma_f32_16x16x32_bf16 v[228:231], v[20:23], a[76:79], 0
    ds_read_b128 a[88:91], v10 offset:4096
    v_mfma_f32_16x16x32_bf16 v[136:139], v[24:27], a[64:67], 0
    v_perm_b32 v16, v38, v34, s93
    v_perm_b32 v17, v46, v42, s93
    v_mfma_f32_16x16x32_bf16 v[168:171], v[24:27], a[68:71], 0
    ds_read_b128 a[92:95], v10 offset:6144
    v_mfma_f32_16x16x32_bf16 v[200:203], v[24:27], a[72:75], 0
    v_perm_b32 v18, v54, v50, s93
    v_perm_b32 v19, v62, v58, s93
    v_mfma_f32_16x16x32_bf16 v[232:235], v[24:27], a[76:79], 0
    v_mfma_f32_16x16x32_bf16 v[140:143], v[28:31], a[64:67], 0
    v_perm_b32 v20, v38, v34, s94
    v_perm_b32 v21, v46, v42, s94
    v_mfma_f32_16x16x32_bf16 v[172:175], v[28:31], a[68:71], 0
    v_mfma_f32_16x16x32_bf16 v[204:207], v[28:31], a[72:75], 0
    v_perm_b32 v22, v54, v50, s94
    v_perm_b32 v23, v62, v58, s94
    v_mfma_f32_16x16x32_bf16 v[236:239], v[28:31], a[76:79], 0
    v_mfma_f32_16x16x32_bf16 v[144:147], v[16:19], a[64:67], 0
    v_perm_b32 v24, v39, v35, s93
    v_perm_b32 v25, v47, v43, s93
    v_mfma_f32_16x16x32_bf16 v[176:179], v[16:19], a[68:71], 0
    v_mfma_f32_16x16x32_bf16 v[208:211], v[16:19], a[72:75], 0
    v_perm_b32 v26, v55, v51, s93
    v_perm_b32 v27, v63, v59, s93
    v_mfma_f32_16x16x32_bf16 v[240:243], v[16:19], a[76:79], 0
    s_waitcnt lgkmcnt(0)
    v_mfma_f32_16x16x32_bf16 v[148:151], v[20:23], a[64:67], 0
    v_perm_b32 v28, v39, v35, s94
    v_perm_b32 v29, v47, v43, s94
    v_mfma_f32_16x16x32_bf16 v[180:183], v[20:23], a[68:71], 0
    s_waitcnt vmcnt(22)
    v_mfma_f32_16x16x32_bf16 v[212:215], v[20:23], a[72:75], 0
    v_perm_b32 v30, v55, v51, s94
    v_perm_b32 v31, v63, v59, s94
    v_mfma_f32_16x16x32_bf16 v[244:247], v[20:23], a[76:79], 0
    buffer_load_dwordx4 v[32:35], v2, s[20:23], s35 offen
    v_mfma_f32_16x16x32_bf16 v[152:155], v[24:27], a[64:67], 0
    v_perm_b32 v16, v68, v64, s93
    v_perm_b32 v17, v76, v72, s93
    v_mfma_f32_16x16x32_bf16 v[184:187], v[24:27], a[68:71], 0
    buffer_load_dwordx4 v[36:39], v3, s[20:23], s35 offen
    v_mfma_f32_16x16x32_bf16 v[216:219], v[24:27], a[72:75], 0
    v_perm_b32 v18, v84, v80, s93
    v_perm_b32 v19, v92, v88, s93
    v_mfma_f32_16x16x32_bf16 v[248:251], v[24:27], a[76:79], 0
    buffer_load_dwordx4 v[40:43], v4, s[20:23], s35 offen
    v_mfma_f32_16x16x32_bf16 v[156:159], v[28:31], a[64:67], 0
    v_perm_b32 v20, v68, v64, s94
    v_perm_b32 v21, v76, v72, s94
    v_mfma_f32_16x16x32_bf16 v[188:191], v[28:31], a[68:71], 0
    buffer_load_dwordx4 v[44:47], v5, s[20:23], s35 offen
    v_mfma_f32_16x16x32_bf16 v[220:223], v[28:31], a[72:75], 0
    v_perm_b32 v22, v84, v80, s94
    v_perm_b32 v23, v92, v88, s94
    v_mfma_f32_16x16x32_bf16 v[252:255], v[28:31], a[76:79], 0
    buffer_load_dwordx4 v[48:51], v6, s[20:23], s35 offen
    v_mfma_f32_16x16x32_bf16 v[128:131], v[16:19], a[80:83], v[128:131]
    v_perm_b32 v24, v69, v65, s93
    v_perm_b32 v25, v77, v73, s93
    v_mfma_f32_16x16x32_bf16 v[160:163], v[16:19], a[84:87], v[160:163]
    v_xor_b32 v10, s74, v11
    v_mfma_f32_16x16x32_bf16 v[192:195], v[16:19], a[88:91], v[192:195]
    v_perm_b32 v26, v85, v81, s93
    v_perm_b32 v27, v93, v89, s93
    v_mfma_f32_16x16x32_bf16 v[224:227], v[16:19], a[92:95], v[224:227]
    ds_read_b128 a[64:67], v10 offset:0
    v_mfma_f32_16x16x32_bf16 v[132:135], v[20:23], a[80:83], v[132:135]
    v_perm_b32 v28, v69, v65, s94
    v_perm_b32 v29, v77, v73, s94
    v_mfma_f32_16x16x32_bf16 v[164:167], v[20:23], a[84:87], v[164:167]
    ds_read_b128 a[68:71], v10 offset:2048
    v_mfma_f32_16x16x32_bf16 v[196:199], v[20:23], a[88:91], v[196:199]
    v_perm_b32 v30, v85, v81, s94
    v_perm_b32 v31, v93, v89, s94
    v_mfma_f32_16x16x32_bf16 v[228:231], v[20:23], a[92:95], v[228:231]
    ds_read_b128 a[72:75], v10 offset:4096
    v_mfma_f32_16x16x32_bf16 v[136:139], v[24:27], a[80:83], v[136:139]
    v_perm_b32 v16, v70, v66, s93
    v_perm_b32 v17, v78, v74, s93
    v_mfma_f32_16x16x32_bf16 v[168:171], v[24:27], a[84:87], v[168:171]
    ds_read_b128 a[76:79], v10 offset:6144
    v_mfma_f32_16x16x32_bf16 v[200:203], v[24:27], a[88:91], v[200:203]
    v_perm_b32 v18, v86, v82, s93
    v_perm_b32 v19, v94, v90, s93
    v_mfma_f32_16x16x32_bf16 v[232:235], v[24:27], a[92:95], v[232:235]
    buffer_load_dwordx4 v[52:55], v7, s[20:23], s35 offen
    v_mfma_f32_16x16x32_bf16 v[140:143], v[28:31], a[80:83], v[140:143]
    v_perm_b32 v20, v70, v66, s94
    v_perm_b32 v21, v78, v74, s94
    v_mfma_f32_16x16x32_bf16 v[172:175], v[28:31], a[84:87], v[172:175]
    buffer_load_dwordx4 v[56:59], v8, s[20:23], s35 offen
    v_mfma_f32_16x16x32_bf16 v[204:207], v[28:31], a[88:91], v[204:207]
    v_perm_b32 v22, v86, v82, s94
    v_perm_b32 v23, v94, v90, s94
    v_mfma_f32_16x16x32_bf16 v[236:239], v[28:31], a[92:95], v[236:239]
    buffer_load_dwordx4 v[60:63], v9, s[20:23], s35 offen
    v_mfma_f32_16x16x32_bf16 v[144:147], v[16:19], a[80:83], v[144:147]
    v_perm_b32 v24, v71, v67, s93
    v_perm_b32 v25, v79, v75, s93
    v_mfma_f32_16x16x32_bf16 v[176:179], v[16:19], a[84:87], v[176:179]
    v_mfma_f32_16x16x32_bf16 v[208:211], v[16:19], a[88:91], v[208:211]
    v_perm_b32 v26, v87, v83, s93
    v_perm_b32 v27, v95, v91, s93
    v_mfma_f32_16x16x32_bf16 v[240:243], v[16:19], a[92:95], v[240:243]
    s_waitcnt lgkmcnt(0)
    v_mfma_f32_16x16x32_bf16 v[148:151], v[20:23], a[80:83], v[148:151]
    v_perm_b32 v28, v71, v67, s94
    v_perm_b32 v29, v79, v75, s94
    v_mfma_f32_16x16x32_bf16 v[180:183], v[20:23], a[84:87], v[180:183]
    s_waitcnt vmcnt(22)
    v_mfma_f32_16x16x32_bf16 v[212:215], v[20:23], a[88:91], v[212:215]
    v_perm_b32 v30, v87, v83, s94
    v_perm_b32 v31, v95, v91, s94
    v_mfma_f32_16x16x32_bf16 v[244:247], v[20:23], a[92:95], v[244:247]
    buffer_load_dwordx4 v[64:67], v2, s[20:23], s36 offen
    v_mfma_f32_16x16x32_bf16 v[152:155], v[24:27], a[80:83], v[152:155]
    v_perm_b32 v16, v100, v96, s93
    v_perm_b32 v17, v108, v104, s93
    v_mfma_f32_16x16x32_bf16 v[184:187], v[24:27], a[84:87], v[184:187]
    buffer_load_dwordx4 v[68:71], v3, s[20:23], s36 offen
    v_mfma_f32_16x16x32_bf16 v[216:219], v[24:27], a[88:91], v[216:219]
    v_perm_b32 v18, v116, v112, s93
    v_perm_b32 v19, v124, v120, s93
    v_mfma_f32_16x16x32_bf16 v[248:251], v[24:27], a[92:95], v[248:251]
    buffer_load_dwordx4 v[72:75], v4, s[20:23], s36 offen
    v_mfma_f32_16x16x32_bf16 v[156:159], v[28:31], a[80:83], v[156:159]
    v_perm_b32 v20, v100, v96, s94
    v_perm_b32 v21, v108, v104, s94
    v_mfma_f32_16x16x32_bf16 v[188:191], v[28:31], a[84:87], v[188:191]
    buffer_load_dwordx4 v[76:79], v5, s[20:23], s36 offen
    v_mfma_f32_16x16x32_bf16 v[220:223], v[28:31], a[88:91], v[220:223]
    v_perm_b32 v22, v116, v112, s94
    v_perm_b32 v23, v124, v120, s94
    v_mfma_f32_16x16x32_bf16 v[252:255], v[28:31], a[92:95], v[252:255]
    buffer_load_dwordx4 v[80:83], v6, s[20:23], s36 offen
    s_cmp_lg_u32 s7, 0
    s_cbranch_scc1 L_kb0
    s_add_u32 m0, s96, 0
    v_xor_b32 v1, 0, v12
    buffer_load_dwordx4 v1, s[12:15], s8 offen offset:0 nt lds
    v_xor_b32 v1, 128, v12
    buffer_load_dwordx4 v1, s[12:15], s8 offen offset:1024 nt lds
    v_xor_b32 v1, 192, v12
    buffer_load_dwordx4 v1, s[12:15], s8 offen offset:2048 nt lds
    v_xor_b32 v1, 64, v12
    buffer_load_dwordx4 v1, s[12:15], s8 offen offset:3072 nt lds
    s_add_u32 m0, s96, 4096
    v_xor_b32 v1, 0, v12
    buffer_load_dwordx4 v1, s[12:15], s9 offen offset:0 nt lds
    v_xor_b32 v1, 128, v12
    buffer_load_dwordx4 v1, s[12:15], s9 offen offset:1024 nt lds
    v_xor_b32 v1, 192, v12
    buffer_load_dwordx4 v1, s[12:15], s9 offen offset:2048 nt lds
    v_xor_b32 v1, 64, v12
    buffer_load_dwordx4 v1, s[12:15], s9 offen offset:3072 nt lds
    s_add_u32 m0, s96, 8192
    v_xor_b32 v1, 0, v12
    buffer_load_dwordx4 v1, s[12:15], s10 offen offset:0 nt lds
    v_xor_b32 v1, 128, v12
    buffer_load_dwordx4 v1, s[12:15], s10 offen offset:1024 nt lds
    v_xor_b32 v1, 192, v12
    buffer_load_dwordx4 v1, s[12:15], s10 offen offset:2048 nt lds
    v_xor_b32 v1, 64, v12
    buffer_load_dwordx4 v1, s[12:15], s10 offen offset:3072 nt lds
    s_add_u32 m0, s96, 12288
    v_xor_b32 v1, 0, v12
    buffer_load_dwordx4 v1, s[12:15], s11 offen offset:0 nt lds
    v_xor_b32 v1, 128, v12
    buffer_load_dwordx4 v1, s[12:15], s11 offen offset:1024 nt lds
    v_xor_b32 v1, 192, v12
    buffer_load_dwordx4 v1, s[12:15], s11 offen offset:2048 nt lds
    v_xor_b32 v1, 64, v12
    buffer_load_dwordx4 v1, s[12:15], s11 offen offset:3072 nt lds
L_kb0:
    s_cmp_lg_u32 s7, 0
    s_cbranch_scc1 L_vb0
    buffer_load_dwordx4 a[0:3], v13, s[16:19], s8 offen offset:0 nt
    buffer_load_dwordx4 a[4:7], v13, s[16:19], s8 offen offset:256 nt
    buffer_load_dwordx4 a[8:11], v13, s[16:19], s8 offen offset:512 nt
    buffer_load_dwordx4 a[12:15], v13, s[16:19], s8 offen offset:768 nt
    buffer_load_dwordx4 a[16:19], v13, s[16:19], s9 offen offset:0 nt
    buffer_load_dwordx4 a[20:23], v13, s[16:19], s9 offen offset:256 nt
    buffer_load_dwordx4 a[24:27], v13, s[16:19], s9 offen offset:512 nt
    buffer_load_dwordx4 a[28:31], v13, s[16:19], s9 offen offset:768 nt
    buffer_load_dwordx4 a[32:35], v13, s[16:19], s10 offen offset:0 nt
    buffer_load_dwordx4 a[36:39], v13, s[16:19], s10 offen offset:256 nt
    buffer_load_dwordx4 a[40:43], v13, s[16:19], s10 offen offset:512 nt
    buffer_load_dwordx4 a[44:47], v13, s[16:19], s10 offen offset:768 nt
    buffer_load_dwordx4 a[48:51], v13, s[16:19], s11 offen offset:0 nt
    buffer_load_dwordx4 a[52:55], v13, s[16:19], s11 offen offset:256 nt
    buffer_load_dwordx4 a[56:59], v13, s[16:19], s11 offen offset:512 nt
    buffer_load_dwordx4 a[60:63], v13, s[16:19], s11 offen offset:768 nt
L_vb0:
    v_mfma_f32_16x16x32_bf16 v[128:131], v[16:19], a[64:67], v[128:131]
    v_perm_b32 v24, v101, v97, s93
    v_perm_b32 v25, v109, v105, s93
    v_mfma_f32_16x16x32_bf16 v[160:163], v[16:19], a[68:71], v[160:163]
    v_xor_b32 v10, s75, v11
    v_mfma_f32_16x16x32_bf16 v[192:195], v[16:19], a[72:75], v[192:195]
    v_perm_b32 v26, v117, v113, s93
    v_perm_b32 v27, v125, v121, s93
    v_mfma_f32_16x16x32_bf16 v[224:227], v[16:19], a[76:79], v[224:227]
    ds_read_b128 a[80:83], v10 offset:0
    v_mfma_f32_16x16x32_bf16 v[132:135], v[20:23], a[64:67], v[132:135]
    v_perm_b32 v28, v101, v97, s94
    v_perm_b32 v29, v109, v105, s94
    v_mfma_f32_16x16x32_bf16 v[164:167], v[20:23], a[68:71], v[164:167]
    ds_read_b128 a[84:87], v10 offset:2048
    v_mfma_f32_16x16x32_bf16 v[196:199], v[20:23], a[72:75], v[196:199]
    v_perm_b32 v30, v117, v113, s94
    v_perm_b32 v31, v125, v121, s94
    v_mfma_f32_16x16x32_bf16 v[228:231], v[20:23], a[76:79], v[228:231]
    ds_read_b128 a[88:91], v10 offset:4096
    v_mfma_f32_16x16x32_bf16 v[136:139], v[24:27], a[64:67], v[136:139]
    v_perm_b32 v16, v102, v98, s93
    v_perm_b32 v17, v110, v106, s93
    v_mfma_f32_16x16x32_bf16 v[168:171], v[24:27], a[68:71], v[168:171]
    ds_read_b128 a[92:95], v10 offset:6144
    v_mfma_f32_16x16x32_bf16 v[200:203], v[24:27], a[72:75], v[200:203]
    v_perm_b32 v18, v118, v114, s93
    v_perm_b32 v19, v126, v122, s93
    v_mfma_f32_16x16x32_bf16 v[232:235], v[24:27], a[76:79], v[232:235]
    buffer_load_dwordx4 v[84:87], v7, s[20:23], s36 offen
    v_mfma_f32_16x16x32_bf16 v[140:143], v[28:31], a[64:67], v[140:143]
    v_perm_b32 v20, v102, v98, s94
    v_perm_b32 v21, v110, v106, s94
    v_mfma_f32_16x16x32_bf16 v[172:175], v[28:31], a[68:71], v[172:175]
    buffer_load_dwordx4 v[88:91], v8, s[20:23], s36 offen
    v_mfma_f32_16x16x32_bf16 v[204:207], v[28:31], a[72:75], v[204:207]
    v_perm_b32 v22, v118, v114, s94
    v_perm_b32 v23, v126, v122, s94
    v_mfma_f32_16x16x32_bf16 v[236:239], v[28:31], a[76:79], v[236:239]
    buffer_load_dwordx4 v[92:95], v9, s[20:23], s36 offen
    v_mfma_f32_16x16x32_bf16 v[144:147], v[16:19], a[64:67], v[144:147]
    v_perm_b32 v24, v103, v99, s93
    v_perm_b32 v25, v111, v107, s93
    v_mfma_f32_16x16x32_bf16 v[176:179], v[16:19], a[68:71], v[176:179]
    v_mfma_f32_16x16x32_bf16 v[208:211], v[16:19], a[72:75], v[208:211]
    v_perm_b32 v26, v119, v115, s93
    v_perm_b32 v27, v127, v123, s93
    v_mfma_f32_16x16x32_bf16 v[240:243], v[16:19], a[76:79], v[240:243]
    s_waitcnt lgkmcnt(0)
    v_mfma_f32_16x16x32_bf16 v[148:151], v[20:23], a[64:67], v[148:151]
    v_perm_b32 v28, v103, v99, s94
    v_perm_b32 v29, v111, v107, s94
    v_mfma_f32_16x16x32_bf16 v[180:183], v[20:23], a[68:71], v[180:183]
    s_cmp_eq_u32 s7, 0
    s_cbranch_scc1 L_w1
    s_waitcnt vmcnt(8)
L_w1:
    s_waitcnt vmcnt(40)
    v_mfma_f32_16x16x32_bf16 v[212:215], v[20:23], a[72:75], v[212:215]
    v_perm_b32 v30, v119, v115, s94
    v_perm_b32 v31, v127, v123, s94
    v_mfma_f32_16x16x32_bf16 v[244:247], v[20:23], a[76:79], v[244:247]
    buffer_load_dwordx4 v[96:99], v2, s[20:23], s37 offen
    v_mfma_f32_16x16x32_bf16 v[152:155], v[24:27], a[64:67], v[152:155]
    v_perm_b32 v16, v36, v32, s93
    v_perm_b32 v17, v44, v40, s93
    v_mfma_f32_16x16x32_bf16 v[184:187], v[24:27], a[68:71], v[184:187]
    buffer_load_dwordx4 v[100:103], v3, s[20:23], s37 offen
    v_mfma_f32_16x16x32_bf16 v[216:219], v[24:27], a[72:75], v[216:219]
    v_perm_b32 v18, v52, v48, s93
    v_perm_b32 v19, v60, v56, s93
    v_mfma_f32_16x16x32_bf16 v[248:251], v[24:27], a[76:79], v[248:251]
    buffer_load_dwordx4 v[104:107], v4, s[20:23], s37 offen
    v_mfma_f32_16x16x32_bf16 v[156:159], v[28:31], a[64:67], v[156:159]
    v_perm_b32 v20, v36, v32, s94
    v_perm_b32 v21, v44, v40, s94
    v_mfma_f32_16x16x32_bf16 v[188:191], v[28:31], a[68:71], v[188:191]
    buffer_load_dwordx4 v[108:111], v5, s[20:23], s37 offen
    s_barrier
    v_mfma_f32_16x16x32_bf16 v[220:223], v[28:31], a[72:75], v[220:223]
    v_perm_b32 v22, v52, v48, s94
    v_perm_b32 v23, v60, v56, s94
    v_mfma_f32_16x16x32_bf16 v[252:255], v[28:31], a[76:79], v[252:255]
    buffer_load_dwordx4 v[112:115], v6, s[20:23], s37 offen
    v_mfma_f32_16x16x32_bf16 v[128:131], v[16:19], a[80:83], v[128:131]
    v_perm_b32 v24, v37, v33, s93
    v_perm_b32 v25, v45, v41, s93
    v_mfma_f32_16x16x32_bf16 v[160:163], v[16:19], a[84:87], v[160:163]
    v_xor_b32 v10, s76, v11
    v_mfma_f32_16x16x32_bf16 v[192:195], v[16:19], a[88:91], v[192:195]
    v_perm_b32 v26, v53, v49, s93
    v_perm_b32 v27, v61, v57, s93
    v_mfma_f32_16x16x32_bf16 v[224:227], v[16:19], a[92:95], v[224:227]
    ds_read_b128 a[64:67], v10 offset:0
    v_mfma_f32_16x16x32_bf16 v[132:135], v[20:23], a[80:83], v[132:135]
    v_perm_b32 v28, v37, v33, s94
    v_perm_b32 v29, v45, v41, s94
    v_mfma_f32_16x16x32_bf16 v[164:167], v[20:23], a[84:87], v[164:167]
    ds_read_b128 a[68:71], v10 offset:2048
    v_mfma_f32_16x16x32_bf16 v[196:199], v[20:23], a[88:91], v[196:199]
    v_perm_b32 v30, v53, v49, s94
    v_perm_b32 v31, v61, v57, s94
    v_mfma_f32_16x16x32_bf16 v[228:231], v[20:23], a[92:95], v[228:231]
    ds_read_b128 a[72:75], v10 offset:4096
    v_mfma_f32_16x16x32_bf16 v[136:139], v[24:27], a[80:83], v[136:139]
    v_perm_b32 v16, v38, v34, s93
    v_perm_b32 v17, v46, v42, s93
    v_mfma_f32_16x16x32_bf16 v[168:171], v[24:27], a[84:87], v[168:171]
    ds_read_b128 a[76:79], v10 offset:6144
    v_mfma_f32_16x16x32_bf16 v[200:203], v[24:27], a[88:91], v[200:203]
    v_perm_b32 v18, v54, v50, s93
    v_perm_b32 v19, v62, v58, s93
    v_mfma_f32_16x16x32_bf16 v[232:235], v[24:27], a[92:95], v[232:235]
    buffer_load_dwordx4 v[116:119], v7, s[20:23], s37 offen
    v_mfma_f32_16x16x32_bf16 v[140:143], v[28:31], a[80:83], v[140:143]
    v_perm_b32 v20, v38, v34, s94
    v_perm_b32 v21, v46, v42, s94
    v_mfma_f32_16x16x32_bf16 v[172:175], v[28:31], a[84:87], v[172:175]
    buffer_load_dwordx4 v[120:123], v8, s[20:23], s37 offen
    v_mfma_f32_16x16x32_bf16 v[204:207], v[28:31], a[88:91], v[204:207]
    v_perm_b32 v22, v54, v50, s94
    v_perm_b32 v23, v62, v58, s94
    v_mfma_f32_16x16x32_bf16 v[236:239], v[28:31], a[92:95], v[236:239]
    buffer_load_dwordx4 v[124:127], v9, s[20:23], s37 offen
    v_mfma_f32_16x16x32_bf16 v[144:147], v[16:19], a[80:83], v[144:147]
    v_perm_b32 v24, v39, v35, s93
    v_perm_b32 v25, v47, v43, s93
    v_mfma_f32_16x16x32_bf16 v[176:179], v[16:19], a[84:87], v[176:179]
    v_mfma_f32_16x16x32_bf16 v[208:211], v[16:19], a[88:91], v[208:211]
    v_perm_b32 v26, v55, v51, s93
    v_perm_b32 v27, v63, v59, s93
    v_mfma_f32_16x16x32_bf16 v[240:243], v[16:19], a[92:95], v[240:243]
    s_waitcnt lgkmcnt(0)
    v_mfma_f32_16x16x32_bf16 v[148:151], v[20:23], a[80:83], v[148:151]
    v_perm_b32 v28, v39, v35, s94
    v_perm_b32 v29, v47, v43, s94
    v_mfma_f32_16x16x32_bf16 v[180:183], v[20:23], a[84:87], v[180:183]
    s_waitcnt vmcnt(8)
    v_mfma_f32_16x16x32_bf16 v[212:215], v[20:23], a[88:91], v[212:215]
    v_perm_b32 v30, v55, v51, s94
    v_perm_b32 v31, v63, v59, s94
    v_mfma_f32_16x16x32_bf16 v[244:247], v[20:23], a[92:95], v[244:247]
    buffer_load_dwordx4 v[32:35], v2, s[20:23], s38 offen
    v_mfma_f32_16x16x32_bf16 v[152:155], v[24:27], a[80:83], v[152:155]
    v_perm_b32 v16, v68, v64, s93
    v_perm_b32 v17, v76, v72, s93
    v_mfma_f32_16x16x32_bf16 v[184:187], v[24:27], a[84:87], v[184:187]
    buffer_load_dwordx4 v[36:39], v3, s[20:23], s38 offen
    v_mfma_f32_16x16x32_bf16 v[216:219], v[24:27], a[88:91], v[216:219]
    v_perm_b32 v18, v84, v80, s93
    v_perm_b32 v19, v92, v88, s93
    v_mfma_f32_16x16x32_bf16 v[248:251], v[24:27], a[92:95], v[248:251]
    buffer_load_dwordx4 v[40:43], v4, s[20:23], s38 offen
    v_mfma_f32_16x16x32_bf16 v[156:159], v[28:31], a[80:83], v[156:159]
    v_perm_b32 v20, v68, v64, s94
    v_perm_b32 v21, v76, v72, s94
    v_mfma_f32_16x16x32_bf16 v[188:191], v[28:31], a[84:87], v[188:191]
    buffer_load_dwordx4 v[44:47], v5, s[20:23], s38 offen
    v_mfma_f32_16x16x32_bf16 v[220:223], v[28:31], a[88:91], v[220:223]
    v_perm_b32 v22, v84, v80, s94
    v_perm_b32 v23, v92, v88, s94
    v_mfma_f32_16x16x32_bf16 v[252:255], v[28:31], a[92:95], v[252:255]
    buffer_load_dwordx4 v[48:51], v6, s[20:23], s38 offen
    v_mfma_f32_16x16x32_bf16 v[128:131], v[16:19], a[64:67], v[128:131]
    v_perm_b32 v24, v69, v65, s93
    v_perm_b32 v25, v77, v73, s93
    v_mfma_f32_16x16x32_bf16 v[160:163], v[16:19], a[68:71], v[160:163]
    v_xor_b32 v10, s77, v11
    v_mfma_f32_16x16x32_bf16 v[192:195], v[16:19], a[72:75], v[192:195]
    v_perm_b32 v26, v85, v81, s93
    v_perm_b32 v27, v93, v89, s93
    v_mfma_f32_16x16x32_bf16 v[224:227], v[16:19], a[76:79], v[224:227]
    ds_read_b128 a[80:83], v10 offset:0
    v_mfma_f32_16x16x32_bf16 v[132:135], v[20:23], a[64:67], v[132:135]
    v_perm_b32 v28, v69, v65, s94
    v_perm_b32 v29, v77, v73, s94
    v_mfma_f32_16x16x32_bf16 v[164:167], v[20:23], a[68:71], v[164:167]
    ds_read_b128 a[84:87], v10 offset:2048
    v_mfma_f32_16x16x32_bf16 v[196:199], v[20:23], a[72:75], v[196:199]
    v_perm_b32 v30, v85, v81, s94
    v_perm_b32 v31, v93, v89, s94
    v_mfma_f32_16x16x32_bf16 v[228:231], v[20:23], a[76:79], v[228:231]
    ds_read_b128 a[88:91], v10 offset:4096
    v_mfma_f32_16x16x32_bf16 v[136:139], v[24:27], a[64:67], v[136:139]
    v_perm_b32 v16, v70, v66, s93
    v_perm_b32 v17, v78, v74, s93
    v_mfma_f32_16x16x32_bf16 v[168:171], v[24:27], a[68:71], v[168:171]
    ds_read_b128 a[92:95], v10 offset:6144
    v_mfma_f32_16x16x32_bf16 v[200:203], v[24:27], a[72:75], v[200:203]
    v_perm_b32 v18, v86, v82, s93
    v_perm_b32 v19, v94, v90, s93
    v_mfma_f32_16x16x32_bf16 v[232:235], v[24:27], a[76:79], v[232:235]
    buffer_load_dwordx4 v[52:55], v7, s[20:23], s38 offen
    v_mfma_f32_16x16x32_bf16 v[140:143], v[28:31], a[64:67], v[140:143]
    v_perm_b32 v20, v70, v66, s94
    v_perm_b32 v21, v78, v74, s94
    v_mfma_f32_16x16x32_bf16 v[172:175], v[28:31], a[68:71], v[172:175]
    buffer_load_dwordx4 v[56:59], v8, s[20:23], s38 offen
    v_mfma_f32_16x16x32_bf16 v[204:207], v[28:31], a[72:75], v[204:207]
    v_perm_b32 v22, v86, v82, s94
    v_perm_b32 v23, v94, v90, s94
    v_mfma_f32_16x16x32_bf16 v[236:239], v[28:31], a[76:79], v[236:239]
    buffer_load_dwordx4 v[60:63], v9, s[20:23], s38 offen
    v_mfma_f32_16x16x32_bf16 v[144:147], v[16:19], a[64:67], v[144:147]
    v_perm_b32 v24, v71, v67, s93
    v_perm_b32 v25, v79, v75, s93
    v_mfma_f32_16x16x32_bf16 v[176:179], v[16:19], a[68:71], v[176:179]
    v_mfma_f32_16x16x32_bf16 v[208:211], v[16:19], a[72:75], v[208:211]
    v_perm_b32 v26, v87, v83, s93
    v_perm_b32 v27, v95, v91, s93
    v_mfma_f32_16x16x32_bf16 v[240:243], v[16:19], a[76:79], v[240:243]
    s_waitcnt lgkmcnt(0)
    v_mfma_f32_16x16x32_bf16 v[148:151], v[20:23], a[64:67], v[148:151]
    v_perm_b32 v28, v71, v67, s94
    v_perm_b32 v29, v79, v75, s94
    v_mfma_f32_16x16x32_bf16 v[180:183], v[20:23], a[68:71], v[180:183]
    s_waitcnt vmcnt(8)
    v_mfma_f32_16x16x32_bf16 v[212:215], v[20:23], a[72:75], v[212:215]
    v_perm_b32 v30, v87, v83, s94
    v_perm_b32 v31, v95, v91, s94
    v_mfma_f32_16x16x32_bf16 v[244:247], v[20:23], a[76:79], v[244:247]
    buffer_load_dwordx4 v[64:67], v2, s[20:23], s39 offen
    v_mfma_f32_16x16x32_bf16 v[152:155], v[24:27], a[64:67], v[152:155]
    v_perm_b32 v16, v100, v96, s93
    v_perm_b32 v17, v108, v104, s93
    v_mfma_f32_16x16x32_bf16 v[184:187], v[24:27], a[68:71], v[184:187]
    buffer_load_dwordx4 v[68:71], v3, s[20:23], s39 offen
    v_mfma_f32_16x16x32_bf16 v[216:219], v[24:27], a[72:75], v[216:219]
    v_perm_b32 v18, v116, v112, s93
    v_perm_b32 v19, v124, v120, s93
    v_mfma_f32_16x16x32_bf16 v[248:251], v[24:27], a[76:79], v[248:251]
    buffer_load_dwordx4 v[72:75], v4, s[20:23], s39 offen
    v_mfma_f32_16x16x32_bf16 v[156:159], v[28:31], a[64:67], v[156:159]
    v_perm_b32 v20, v100, v96, s94
    v_perm_b32 v21, v108, v104, s94
    v_mfma_f32_16x16x32_bf16 v[188:191], v[28:31], a[68:71], v[188:191]
    buffer_load_dwordx4 v[76:79], v5, s[20:23], s39 offen
    v_mfma_f32_16x16x32_bf16 v[220:223], v[28:31], a[72:75], v[220:223]
    v_perm_b32 v22, v116, v112, s94
    v_perm_b32 v23, v124, v120, s94
    v_mfma_f32_16x16x32_bf16 v[252:255], v[28:31], a[76:79], v[252:255]
    buffer_load_dwordx4 v[80:83], v6, s[20:23], s39 offen
    v_mfma_f32_16x16x32_bf16 v[128:131], v[16:19], a[80:83], v[128:131]
    v_perm_b32 v24, v101, v97, s93
    v_perm_b32 v25, v109, v105, s93
    v_mfma_f32_16x16x32_bf16 v[160:163], v[16:19], a[84:87], v[160:163]
    v_xor_b32 v10, s78, v11
    v_mfma_f32_16x16x32_bf16 v[192:195], v[16:19], a[88:91], v[192:195]
    v_perm_b32 v26, v117, v113, s93
    v_perm_b32 v27, v125, v121, s93
    v_mfma_f32_16x16x32_bf16 v[224:227], v[16:19], a[92:95], v[224:227]
    ds_read_b128 a[64:67], v10 offset:0
    v_mfma_f32_16x16x32_bf16 v[132:135], v[20:23], a[80:83], v[132:135]
    v_perm_b32 v28, v101, v97, s94
    v_perm_b32 v29, v109, v105, s94
    v_mfma_f32_16x16x32_bf16 v[164:167], v[20:23], a[84:87], v[164:167]
    ds_read_b128 a[68:71], v10 offset:2048
    v_mfma_f32_16x16x32_bf16 v[196:199], v[20:23], a[88:91], v[196:199]
    v_perm_b32 v30, v117, v113, s94
    v_perm_b32 v31, v125, v121, s94
    v_mfma_f32_16x16x32_bf16 v[228:231], v[20:23], a[92:95], v[228:231]
    ds_read_b128 a[72:75], v10 offset:4096
    v_mfma_f32_16x16x32_bf16 v[136:139], v[24:27], a[80:83], v[136:139]
    v_perm_b32 v16, v102, v98, s93
    v_perm_b32 v17, v110, v106, s93
    v_mfma_f32_16x16x32_bf16 v[168:171], v[24:27], a[84:87], v[168:171]
    ds_read_b128 a[76:79], v10 offset:6144
    v_mfma_f32_16x16x32_bf16 v[200:203], v[24:27], a[88:91], v[200:203]
    v_perm_b32 v18, v118, v114, s93
    v_perm_b32 v19, v126, v122, s93
    v_mfma_f32_16x16x32_bf16 v[232:235], v[24:27], a[92:95], v[232:235]
    buffer_load_dwordx4 v[84:87], v7, s[20:23], s39 offen
    v_mfma_f32_16x16x32_bf16 v[140:143], v[28:31], a[80:83], v[140:143]
    v_perm_b32 v20, v102, v98, s94
    v_perm_b32 v21, v110, v106, s94
    v_mfma_f32_16x16x32_bf16 v[172:175], v[28:31], a[84:87], v[172:175]
    buffer_load_dwordx4 v[88:91], v8, s[20:23], s39 offen
    v_mfma_f32_16x16x32_bf16 v[204:207], v[28:31], a[88:91], v[204:207]
    v_perm_b32 v22, v118, v114, s94
    v_perm_b32 v23, v126, v122, s94
    v_mfma_f32_16x16x32_bf16 v[236:239], v[28:31], a[92:95], v[236:239]
    buffer_load_dwordx4 v[92:95], v9, s[20:23], s39 offen
    v_mfma_f32_16x16x32_bf16 v[144:147], v[16:19], a[80:83], v[144:147]
    v_perm_b32 v24, v103, v99, s93
    v_perm_b32 v25, v111, v107, s93
    v_mfma_f32_16x16x32_bf16 v[176:179], v[16:19], a[84:87], v[176:179]
    v_mfma_f32_16x16x32_bf16 v[208:211], v[16:19], a[88:91], v[208:211]
    v_perm_b32 v26, v119, v115, s93
    v_perm_b32 v27, v127, v123, s93
    v_mfma_f32_16x16x32_bf16 v[240:243], v[16:19], a[92:95], v[240:243]
    s_waitcnt lgkmcnt(0)
    v_mfma_f32_16x16x32_bf16 v[148:151], v[20:23], a[80:83], v[148:151]
    v_perm_b32 v28, v103, v99, s94
    v_perm_b32 v29, v111, v107, s94
    v_mfma_f32_16x16x32_bf16 v[180:183], v[20:23], a[84:87], v[180:183]
    s_waitcnt vmcnt(8)
    v_mfma_f32_16x16x32_bf16 v[212:215], v[20:23], a[88:91], v[212:215]
    v_perm_b32 v30, v119, v115, s94
    v_perm_b32 v31, v127, v123, s94
    v_mfma_f32_16x16x32_bf16 v[244:247], v[20:23], a[92:95], v[244:247]
    buffer_load_dwordx4 v[96:99], v2, s[20:23], s40 offen
    v_mfma_f32_16x16x32_bf16 v[152:155], v[24:27], a[80:83], v[152:155]
    v_perm_b32 v16, v36, v32, s93
    v_perm_b32 v17, v44, v40, s93
    v_mfma_f32_16x16x32_bf16 v[184:187], v[24:27], a[84:87], v[184:187]
    buffer_load_dwordx4 v[100:103], v3, s[20:23], s40 offen
    v_mfma_f32_16x16x32_bf16 v[216:219], v[24:27], a[88:91], v[216:219]
    v_perm_b32 v18, v52, v48, s93
    v_perm_b32 v19, v60, v56, s93
    v_mfma_f32_16x16x32_bf16 v[248:251], v[24:27], a[92:95], v[248:251]
    buffer_load_dwordx4 v[104:107], v4, s[20:23], s40 offen
    v_mfma_f32_16x16x32_bf16 v[156:159], v[28:31], a[80:83], v[156:159]
    v_perm_b32 v20, v36, v32, s94
    v_perm_b32 v21, v44, v40, s94
    v_mfma_f32_16x16x32_bf16 v[188:191], v[28:31], a[84:87], v[188:191]
    buffer_load_dwordx4 v[108:111], v5, s[20:23], s40 offen
    v_mfma_f32_16x16x32_bf16 v[220:223], v[28:31], a[88:91], v[220:223]
    v_perm_b32 v22, v52, v48, s94
    v_perm_b32 v23, v60, v56, s94
    v_mfma_f32_16x16x32_bf16 v[252:255], v[28:31], a[92:95], v[252:255]
    buffer_load_dwordx4 v[112:115], v6, s[20:23], s40 offen
    v_mfma_f32_16x16x32_bf16 v[128:131], v[16:19], a[64:67], v[128:131]
    v_perm_b32 v24, v37, v33, s93
    v_perm_b32 v25, v45, v41, s93
    v_mfma_f32_16x16x32_bf16 v[160:163], v[16:19], a[68:71], v[160:163]
    v_xor_b32 v10, s79, v11
    v_mfma_f32_16x16x32_bf16 v[192:195], v[16:19], a[72:75], v[192:195]
    v_perm_b32 v26, v53, v49, s93
    v_perm_b32 v27, v61, v57, s93
    v_mfma_f32_16x16x32_bf16 v[224:227], v[16:19], a[76:79], v[224:227]
    ds_read_b128 a[80:83], v10 offset:0
    v_mfma_f32_16x16x32_bf16 v[132:135], v[20:23], a[64:67], v[132:135]
    v_perm_b32 v28, v37, v33, s94
    v_perm_b32 v29, v45, v41, s94
    v_mfma_f32_16x16x32_bf16 v[164:167], v[20:23], a[68:71], v[164:167]
    ds_read_b128 a[84:87], v10 offset:2048
    v_mfma_f32_16x16x32_bf16 v[196:199], v[20:23], a[72:75], v[196:199]
    v_perm_b32 v30, v53, v49, s94
    v_perm_b32 v31, v61, v57, s94
    v_mfma_f32_16x16x32_bf16 v[228:231], v[20:23], a[76:79], v[228:231]
    ds_read_b128 a[88:91], v10 offset:4096
    v_mfma_f32_16x16x32_bf16 v[136:139], v[24:27], a[64:67], v[136:139]
    v_perm_b32 v16, v38, v34, s93
    v_perm_b32 v17, v46, v42, s93
    v_mfma_f32_16x16x32_bf16 v[168:171], v[24:27], a[68:71], v[168:171]
    ds_read_b128 a[92:95], v10 offset:6144
    v_mfma_f32_16x16x32_bf16 v[200:203], v[24:27], a[72:75], v[200:203]
    v_perm_b32 v18, v54, v50, s93
    v_perm_b32 v19, v62, v58, s93
    v_mfma_f32_16x16x32_bf16 v[232:235], v[24:27], a[76:79], v[232:235]
    buffer_load_dwordx4 v[116:119], v7, s[20:23], s40 offen
    v_mfma_f32_16x16x32_bf16 v[140:143], v[28:31], a[64:67], v[140:143]
    v_perm_b32 v20, v38, v34, s94
    v_perm_b32 v21, v46, v42, s94
    v_mfma_f32_16x16x32_bf16 v[172:175], v[28:31], a[68:71], v[172:175]
    buffer_load_dwordx4 v[120:123], v8, s[20:23], s40 offen
    v_mfma_f32_16x16x32_bf16 v[204:207], v[28:31], a[72:75], v[204:207]
    v_perm_b32 v22, v54, v50, s94
    v_perm_b32 v23, v62, v58, s94
    v_mfma_f32_16x16x32_bf16 v[236:239], v[28:31], a[76:79], v[236:239]
    buffer_load_dwordx4 v[124:127], v9, s[20:23], s40 offen
    v_mfma_f32_16x16x32_bf16 v[144:147], v[16:19], a[64:67], v[144:147]
    v_perm_b32 v24, v39, v35, s93
    v_perm_b32 v25, v47, v43, s93
    v_mfma_f32_16x16x32_bf16 v[176:179], v[16:19], a[68:71], v[176:179]
    v_mfma_f32_16x16x32_bf16 v[208:211], v[16:19], a[72:75], v[208:211]
    v_perm_b32 v26, v55, v51, s93
    v_perm_b32 v27, v63, v59, s93
    v_mfma_f32_16x16x32_bf16 v[240:243], v[16:19], a[76:79], v[240:243]
    s_waitcnt lgkmcnt(0)
    v_mfma_f32_16x16x32_bf16 v[148:151], v[20:23], a[64:67], v[148:151]
    v_perm_b32 v28, v39, v35, s94
    v_perm_b32 v29, v47, v43, s94
    v_mfma_f32_16x16x32_bf16 v[180:183], v[20:23], a[68:71], v[180:183]
    s_waitcnt vmcnt(8)
    v_mfma_f32_16x16x32_bf16 v[212:215], v[20:23], a[72:75], v[212:215]
    v_perm_b32 v30, v55, v51, s94
    v_perm_b32 v31, v63, v59, s94
    v_mfma_f32_16x16x32_bf16 v[244:247], v[20:23], a[76:79], v[244:247]
    buffer_load_dwordx4 v[32:35], v2, s[20:23], s41 offen
    v_mfma_f32_16x16x32_bf16 v[152:155], v[24:27], a[64:67], v[152:155]
    v_perm_b32 v16, v68, v64, s93
    v_perm_b32 v17, v76, v72, s93
    v_mfma_f32_16x16x32_bf16 v[184:187], v[24:27], a[68:71], v[184:187]
    buffer_load_dwordx4 v[36:39], v3, s[20:23], s41 offen
    v_mfma_f32_16x16x32_bf16 v[216:219], v[24:27], a[72:75], v[216:219]
    v_perm_b32 v18, v84, v80, s93
    v_perm_b32 v19, v92, v88, s93
    v_mfma_f32_16x16x32_bf16 v[248:251], v[24:27], a[76:79], v[248:251]
    buffer_load_dwordx4 v[40:43], v4, s[20:23], s41 offen
    v_mfma_f32_16x16x32_bf16 v[156:159], v[28:31], a[64:67], v[156:159]
    v_perm_b32 v20, v68, v64, s94
    v_perm_b32 v21, v76, v72, s94
    v_mfma_f32_16x16x32_bf16 v[188:191], v[28:31], a[68:71], v[188:191]
    buffer_load_dwordx4 v[44:47], v5, s[20:23], s41 offen
    v_mfma_f32_16x16x32_bf16 v[220:223], v[28:31], a[72:75], v[220:223]
    v_perm_b32 v22, v84, v80, s94
    v_perm_b32 v23, v92, v88, s94
    v_mfma_f32_16x16x32_bf16 v[252:255], v[28:31], a[76:79], v[252:255]
    buffer_load_dwordx4 v[48:51], v6, s[20:23], s41 offen
    s_cmp_lg_u32 s7, 1
    s_cbranch_scc1 L_kb1
    s_add_u32 m0, s96, 0
    v_xor_b32 v1, 0, v12
    buffer_load_dwordx4 v1, s[12:15], s8 offen offset:0 nt lds
    v_xor_b32 v1, 128, v12
    buffer_load_dwordx4 v1, s[12:15], s8 offen offset:1024 nt lds
    v_xor_b32 v1, 192, v12
    buffer_load_dwordx4 v1, s[12:15], s8 offen offset:2048 nt lds
    v_xor_b32 v1, 64, v12
    buffer_load_dwordx4 v1, s[12:15], s8 offen offset:3072 nt lds
    s_add_u32 m0, s96, 4096
    v_xor_b32 v1, 0, v12
    buffer_load_dwordx4 v1, s[12:15], s9 offen offset:0 nt lds
    v_xor_b32 v1, 128, v12
    buffer_load_dwordx4 v1, s[12:15], s9 offen offset:1024 nt lds
    v_xor_b32 v1, 192, v12
    buffer_load_dwordx4 v1, s[12:15], s9 offen offset:2048 nt lds
    v_xor_b32 v1, 64, v12
    buffer_load_dwordx4 v1, s[12:15], s9 offen offset:3072 nt lds
    s_add_u32 m0, s96, 8192
    v_xor_b32 v1, 0, v12
    buffer_load_dwordx4 v1, s[12:15], s10 offen offset:0 nt lds
    v_xor_b32 v1, 128, v12
    buffer_load_dwordx4 v1, s[12:15], s10 offen offset:1024 nt lds
    v_xor_b32 v1, 192, v12
    buffer_load_dwordx4 v1, s[12:15], s10 offen offset:2048 nt lds
    v_xor_b32 v1, 64, v12
    buffer_load_dwordx4 v1, s[12:15], s10 offen offset:3072 nt lds
    s_add_u32 m0, s96, 12288
    v_xor_b32 v1, 0, v12
    buffer_load_dwordx4 v1, s[12:15], s11 offen offset:0 nt lds
    v_xor_b32 v1, 128, v12
    buffer_load_dwordx4 v1, s[12:15], s11 offen offset:1024 nt lds
    v_xor_b32 v1, 192, v12
    buffer_load_dwordx4 v1, s[12:15], s11 offen offset:2048 nt lds
    v_xor_b32 v1, 64, v12
    buffer_load_dwordx4 v1, s[12:15], s11 offen offset:3072 nt lds
L_kb1:
    s_cmp_lg_u32 s7, 1
    s_cbranch_scc1 L_vb1
    buffer_load_dwordx4 a[0:3], v13, s[16:19], s8 offen offset:0 nt
    buffer_load_dwordx4 a[4:7], v13, s[16:19], s8 offen offset:256 nt
    buffer_load_dwordx4 a[8:11], v13, s[16:19], s8 offen offset:512 nt
    buffer_load_dwordx4 a[12:15], v13, s[16:19], s8 offen offset:768 nt
    buffer_load_dwordx4 a[16:19], v13, s[16:19], s9 offen offset:0 nt
    buffer_load_dwordx4 a[20:23], v13, s[16:19], s9 offen offset:256 nt
    buffer_load_dwordx4 a[24:27], v13, s[16:19], s9 offen offset:512 nt
    buffer_load_dwordx4 a[28:31], v13, s[16:19], s9 offen offset:768 nt
    buffer_load_dwordx4 a[32:35], v13, s[16:19], s10 offen offset:0 nt
    buffer_load_dwordx4 a[36:39], v13, s[16:19], s10 offen offset:256 nt
    buffer_load_dwordx4 a[40:43], v13, s[16:19], s10 offen offset:512 nt
    buffer_load_dwordx4 a[44:47], v13, s[16:19], s10 offen offset:768 nt
    buffer_load_dwordx4 a[48:51], v13, s[16:19], s11 offen offset:0 nt
    buffer_load_dwordx4 a[52:55], v13, s[16:19], s11 offen offset:256 nt
    buffer_load_dwordx4 a[56:59], v13, s[16:19], s11 offen offset:512 nt
    buffer_load_dwordx4 a[60:63], v13, s[16:19], s11 offen offset:768 nt
L_vb1:
    v_mfma_f32_16x16x32_bf16 v[128:131], v[16:19], a[80:83], v[128:131]
    v_perm_b32 v24, v69, v65, s93
    v_perm_b32 v25, v77, v73, s93
    v_mfma_f32_16x16x32_bf16 v[160:163], v[16:19], a[84:87], v[160:163]
    v_xor_b32 v10, s80, v11
    v_mfma_f32_16x16x32_bf16 v[192:195], v[16:19], a[88:91], v[192:195]
    v_perm_b32 v26, v85, v81, s93
    v_perm_b32 v27, v93, v89, s93
    v_mfma_f32_16x16x32_bf16 v[224:227], v[16:19], a[92:95], v[224:227]
    ds_read_b128 a[64:67], v10 offset:0
    v_mfma_f32_16x16x32_bf16 v[132:135], v[20:23], a[80:83], v[132:135]
    v_perm_b32 v28, v69, v65, s94
    v_perm_b32 v29, v77, v73, s94
    v_mfma_f32_16x16x32_bf16 v[164:167], v[20:23], a[84:87], v[164:167]
    ds_read_b128 a[68:71], v10 offset:2048
    v_mfma_f32_16x16x32_bf16 v[196:199], v[20:23], a[88:91], v[196:199]
    v_perm_b32 v30, v85, v81, s94
    v_perm_b32 v31, v93, v89, s94
    v_mfma_f32_16x16x32_bf16 v[228:231], v[20:23], a[92:95], v[228:231]
    ds_read_b128 a[72:75], v10 offset:4096
    v_mfma_f32_16x16x32_bf16 v[136:139], v[24:27], a[80:83], v[136:139]
    v_perm_b32 v16, v70, v66, s93
    v_perm_b32 v17, v78, v74, s93
    v_mfma_f32_16x16x32_bf16 v[168:171], v[24:27], a[84:87], v[168:171]
    ds_read_b128 a[76:79], v10 offset:6144
    v_mfma_f32_16x16x32_bf16 v[200:203], v[24:27], a[88:91], v[200:203]
    v_perm_b32 v18, v86, v82, s93
    v_perm_b32 v19, v94, v90, s93
    v_mfma_f32_16x16x32_bf16 v[232:235], v[24:27], a[92:95], v[232:235]
    buffer_load_dwordx4 v[52:55], v7, s[20:23], s41 offen
    v_mfma_f32_16x16x32_bf16 v[140:143], v[28:31], a[80:83], v[140:143]
    v_perm_b32 v20, v70, v66, s94
    v_perm_b32 v21, v78, v74, s94
    v_mfma_f32_16x16x32_bf16 v[172:175], v[28:31], a[84:87], v[172:175]
    buffer_load_dwordx4 v[56:59], v8, s[20:23], s41 offen
    v_mfma_f32_16x16x32_bf16 v[204:207], v[28:31], a[88:91], v[204:207]
    v_perm_b32 v22, v86, v82, s94
    v_perm_b32 v23, v94, v90, s94
    v_mfma_f32_16x16x32_bf16 v[236:239], v[28:31], a[92:95], v[236:239]
    buffer_load_dwordx4 v[60:63], v9, s[20:23], s41 offen
    v_mfma_f32_16x16x32_bf16 v[144:147], v[16:19], a[80:83], v[144:147]
    v_perm_b32 v24, v71, v67, s93
    v_perm_b32 v25, v79, v75, s93
    v_mfma_f32_16x16x32_bf16 v[176:179], v[16:19], a[84:87], v[176:179]
    v_mfma_f32_16x16x32_bf16 v[208:211], v[16:19], a[88:91], v[208:211]
    v_perm_b32 v26, v87, v83, s93
    v_perm_b32 v27, v95, v91, s93
    v_mfma_f32_16x16x32_bf16 v[240:243], v[16:19], a[92:95], v[240:243]
    s_waitcnt lgkmcnt(0)
    v_mfma_f32_16x16x32_bf16 v[148:151], v[20:23], a[80:83], v[148:151]
    v_perm_b32 v28, v71, v67, s94
    v_perm_b32 v29, v79, v75, s94
    v_mfma_f32_16x16x32_bf16 v[180:183], v[20:23], a[84:87], v[180:183]
    s_cmp_eq_u32 s7, 1
    s_cbranch_scc1 L_w2
    s_waitcnt vmcnt(8)
L_w2:
    s_waitcnt vmcnt(40)
    v_mfma_f32_16x16x32_bf16 v[212:215], v[20:23], a[88:91], v[212:215]
    v_perm_b32 v30, v87, v83, s94
    v_perm_b32 v31, v95, v91, s94
    v_mfma_f32_16x16x32_bf16 v[244:247], v[20:23], a[92:95], v[244:247]
    buffer_load_dwordx4 v[64:67], v2, s[20:23], s42 offen
    v_mfma_f32_16x16x32_bf16 v[152:155], v[24:27], a[80:83], v[152:155]
    v_perm_b32 v16, v100, v96, s93
    v_perm_b32 v17, v108, v104, s93
    v_mfma_f32_16x16x32_bf16 v[184:187], v[24:27], a[84:87], v[184:187]
    buffer_load_dwordx4 v[68:71], v3, s[20:23], s42 offen
    v_mfma_f32_16x16x32_bf16 v[216:219], v[24:27], a[88:91], v[216:219]
    v_perm_b32 v18, v116, v112, s93
    v_perm_b32 v19, v124, v120, s93
    v_mfma_f32_16x16x32_bf16 v[248:251], v[24:27], a[92:95], v[248:251]
    buffer_load_dwordx4 v[72:75], v4, s[20:23], s42 offen
    v_mfma_f32_16x16x32_bf16 v[156:159], v[28:31], a[80:83], v[156:159]
    v_perm_b32 v20, v100, v96, s94
    v_perm_b32 v21, v108, v104, s94
    v_mfma_f32_16x16x32_bf16 v[188:191], v[28:31], a[84:87], v[188:191]
    buffer_load_dwordx4 v[76:79], v5, s[20:23], s42 offen
    v_mfma_f32_16x16x32_bf16 v[220:223], v[28:31], a[88:91], v[220:223]
    v_perm_b32 v22, v116, v112, s94
    v_perm_b32 v23, v124, v120, s94
    v_mfma_f32_16x16x32_bf16 v[252:255], v[28:31], a[92:95], v[252:255]
    buffer_load_dwordx4 v[80:83], v6, s[20:23], s42 offen
    v_mfma_f32_16x16x32_bf16 v[128:131], v[16:19], a[64:67], v[128:131]
    v_perm_b32 v24, v101, v97, s93
    v_perm_b32 v25, v109, v105, s93
    v_mfma_f32_16x16x32_bf16 v[160:163], v[16:19], a[68:71], v[160:163]
    v_xor_b32 v10, s81, v11
    v_mfma_f32_16x16x32_bf16 v[192:195], v[16:19], a[72:75], v[192:195]
    v_perm_b32 v26, v117, v113, s93
    v_perm_b32 v27, v125, v121, s93
    v_mfma_f32_16x16x32_bf16 v[224:227], v[16:19], a[76:79], v[224:227]
    ds_read_b128 a[80:83], v10 offset:0
    v_mfma_f32_16x16x32_bf16 v[132:135], v[20:23], a[64:67], v[132:135]
    v_perm_b32 v28, v101, v97, s94
    v_perm_b32 v29, v109, v105, s94
    v_mfma_f32_16x16x32_bf16 v[164:167], v[20:23], a[68:71], v[164:167]
    ds_read_b128 a[84:87], v10 offset:2048
    v_mfma_f32_16x16x32_bf16 v[196:199], v[20:23], a[72:75], v[196:199]
    v_perm_b32 v30, v117, v113, s94
    v_perm_b32 v31, v125, v121, s94
    v_mfma_f32_16x16x32_bf16 v[228:231], v[20:23], a[76:79], v[228:231]
    ds_read_b128 a[88:91], v10 offset:4096
    v_mfma_f32_16x16x32_bf16 v[136:139], v[24:27], a[64:67], v[136:139]
    v_perm_b32 v16, v102, v98, s93
    v_perm_b32 v17, v110, v106, s93
    v_mfma_f32_16x16x32_bf16 v[168:171], v[24:27], a[68:71], v[168:171]
    ds_read_b128 a[92:95], v10 offset:6144
    v_mfma_f32_16x16x32_bf16 v[200:203], v[24:27], a[72:75], v[200:203]
    v_perm_b32 v18, v118, v114, s93
    v_perm_b32 v19, v126, v122, s93
    v_mfma_f32_16x16x32_bf16 v[232:235], v[24:27], a[76:79], v[232:235]
    buffer_load_dwordx4 v[84:87], v7, s[20:23], s42 offen
    v_mfma_f32_16x16x32_bf16 v[140:143], v[28:31], a[64:67], v[140:143]
    v_perm_b32 v20, v102, v98, s94
    v_perm_b32 v21, v110, v106, s94
    v_mfma_f32_16x16x32_bf16 v[172:175], v[28:31], a[68:71], v[172:175]
    buffer_load_dwordx4 v[88:91], v8, s[20:23], s42 offen
    v_mfma_f32_16x16x32_bf16 v[204:207], v[28:31], a[72:75], v[204:207]
    v_perm_b32 v22, v118, v114, s94
    v_perm_b32 v23, v126, v122, s94
    v_mfma_f32_16x16x32_bf16 v[236:239], v[28:31], a[76:79], v[236:239]
    buffer_load_dwordx4 v[92:95], v9, s[20:23], s42 offen
    v_mfma_f32_16x16x32_bf16 v[144:147], v[16:19], a[64:67], v[144:147]
    v_perm_b32 v24, v103, v99, s93
    v_perm_b32 v25, v111, v107, s93
    v_mfma_f32_16x16x32_bf16 v[176:179], v[16:19], a[68:71], v[176:179]
    v_mfma_f32_16x16x32_bf16 v[208:211], v[16:19], a[72:75], v[208:211]
    v_perm_b32 v26, v119, v115, s93
    v_perm_b32 v27, v127, v123, s93
    v_mfma_f32_16x16x32_bf16 v[240:243], v[16:19], a[76:79], v[240:243]
    s_waitcnt lgkmcnt(0)
    v_mfma_f32_16x16x32_bf16 v[148:151], v[20:23], a[64:67], v[148:151]
    v_perm_b32 v28, v103, v99, s94
    v_perm_b32 v29, v111, v107, s94
    v_mfma_f32_16x16x32_bf16 v[180:183], v[20:23], a[68:71], v[180:183]
    s_waitcnt vmcnt(8)
    v_mfma_f32_16x16x32_bf16 v[212:215], v[20:23], a[72:75], v[212:215]
    v_perm_b32 v30, v119, v115, s94
    v_perm_b32 v31, v127, v123, s94
    v_mfma_f32_16x16x32_bf16 v[244:247], v[20:23], a[76:79], v[244:247]
    buffer_load_dwordx4 v[96:99], v2, s[20:23], s43 offen
    v_mfma_f32_16x16x32_bf16 v[152:155], v[24:27], a[64:67], v[152:155]
    v_perm_b32 v16, v36, v32, s93
    v_perm_b32 v17, v44, v40, s93
    v_mfma_f32_16x16x32_bf16 v[184:187], v[24:27], a[68:71], v[184:187]
    buffer_load_dwordx4 v[100:103], v3, s[20:23], s43 offen
    v_mfma_f32_16x16x32_bf16 v[216:219], v[24:27], a[72:75], v[216:219]
    v_perm_b32 v18, v52, v48, s93
    v_perm_b32 v19, v60, v56, s93
    v_mfma_f32_16x16x32_bf16 v[248:251], v[24:27], a[76:79], v[248:251]
    buffer_load_dwordx4 v[104:107], v4, s[20:23], s43 offen
    v_mfma_f32_16x16x32_bf16 v[156:159], v[28:31], a[64:67], v[156:159]
    v_perm_b32 v20, v36, v32, s94
    v_perm_b32 v21, v44, v40, s94
    v_mfma_f32_16x16x32_bf16 v[188:191], v[28:31], a[68:71], v[188:191]
    buffer_load_dwordx4 v[108:111], v5, s[20:23], s43 offen
    v_mfma_f32_16x16x32_bf16 v[220:223], v[28:31], a[72:75], v[220:223]
    v_perm_b32 v22, v52, v48, s94
    v_perm_b32 v23, v60, v56, s94
    v_mfma_f32_16x16x32_bf16 v[252:255], v[28:31], a[76:79], v[252:255]
    buffer_load_dwordx4 v[112:115], v6, s[20:23], s43 offen
    v_mfma_f32_16x16x32_bf16 v[128:131], v[16:19], a[80:83], v[128:131]
    v_perm_b32 v24, v37, v33, s93
    v_perm_b32 v25, v45, v41, s93
    v_mfma_f32_16x16x32_bf16 v[160:163], v[16:19], a[84:87], v[160:163]
    v_xor_b32 v10, s82, v11
    v_mfma_f32_16x16x32_bf16 v[192:195], v[16:19], a[88:91], v[192:195]
    v_perm_b32 v26, v53, v49, s93
    v_perm_b32 v27, v61, v57, s93
    v_mfma_f32_16x16x32_bf16 v[224:227], v[16:19], a[92:95], v[224:227]
    ds_read_b128 a[64:67], v10 offset:0
    v_mfma_f32_16x16x32_bf16 v[132:135], v[20:23], a[80:83], v[132:135]
    v_perm_b32 v28, v37, v33, s94
    v_perm_b32 v29, v45, v41, s94
    v_mfma_f32_16x16x32_bf16 v[164:167], v[20:23], a[84:87], v[164:167]
    ds_read_b128 a[68:71], v10 offset:2048
    v_mfma_f32_16x16x32_bf16 v[196:199], v[20:23], a[88:91], v[196:199]
    v_perm_b32 v30, v53, v49, s94
    v_perm_b32 v31, v61, v57, s94
    v_mfma_f32_16x16x32_bf16 v[228:231], v[20:23], a[92:95], v[228:231]
    ds_read_b128 a[72:75], v10 offset:4096
    v_mfma_f32_16x16x32_bf16 v[136:139], v[24:27], a[80:83], v[136:139]
    v_perm_b32 v16, v38, v34, s93
    v_perm_b32 v17, v46, v42, s93
    v_mfma_f32_16x16x32_bf16 v[168:171], v[24:27], a[84:87], v[168:171]
    ds_read_b128 a[76:79], v10 offset:6144
    v_mfma_f32_16x16x32_bf16 v[200:203], v[24:27], a[88:91], v[200:203]
    v_perm_b32 v18, v54, v50, s93
    v_perm_b32 v19, v62, v58, s93
    v_mfma_f32_16x16x32_bf16 v[232:235], v[24:27], a[92:95], v[232:235]
    buffer_load_dwordx4 v[116:119], v7, s[20:23], s43 offen
    v_mfma_f32_16x16x32_bf16 v[140:143], v[28:31], a[80:83], v[140:143]
    v_perm_b32 v20, v38, v34, s94
    v_perm_b32 v21, v46, v42, s94
    v_mfma_f32_16x16x32_bf16 v[172:175], v[28:31], a[84:87], v[172:175]
    buffer_load_dwordx4 v[120:123], v8, s[20:23], s43 offen
    v_mfma_f32_16x16x32_bf16 v[204:207], v[28:31], a[88:91], v[204:207]
    v_perm_b32 v22, v54, v50, s94
    v_perm_b32 v23, v62, v58, s94
    v_mfma_f32_16x16x32_bf16 v[236:239], v[28:31], a[92:95], v[236:239]
    buffer_load_dwordx4 v[124:127], v9, s[20:23], s43 offen
    v_mfma_f32_16x16x32_bf16 v[144:147], v[16:19], a[80:83], v[144:147]
    v_perm_b32 v24, v39, v35, s93
    v_perm_b32 v25, v47, v43, s93
    v_mfma_f32_16x16x32_bf16 v[176:179], v[16:19], a[84:87], v[176:179]
    v_mfma_f32_16x16x32_bf16 v[208:211], v[16:19], a[88:91], v[208:211]
    v_perm_b32 v26, v55, v51, s93
    v_perm_b32 v27, v63, v59, s93
    v_mfma_f32_16x16x32_bf16 v[240:243], v[16:19], a[92:95], v[240:243]
    s_waitcnt lgkmcnt(0)
    v_mfma_f32_16x16x32_bf16 v[148:151], v[20:23], a[80:83], v[148:151]
    v_perm_b32 v28, v39, v35, s94
    v_perm_b32 v29, v47, v43, s94
    v_mfma_f32_16x16x32_bf16 v[180:183], v[20:23], a[84:87], v[180:183]
    s_waitcnt vmcnt(8)
    v_mfma_f32_16x16x32_bf16 v[212:215], v[20:23], a[88:91], v[212:215]
    v_perm_b32 v30, v55, v51, s94
    v_perm_b32 v31, v63, v59, s94
    v_mfma_f32_16x16x32_bf16 v[244:247], v[20:23], a[92:95], v[244:247]
    buffer_load_dwordx4 v[32:35], v2, s[20:23], s44 offen
    v_mfma_f32_16x16x32_bf16 v[152:155], v[24:27], a[80:83], v[152:155]
    v_perm_b32 v16, v68, v64, s93
    v_perm_b32 v17, v76, v72, s93
    v_mfma_f32_16x16x32_bf16 v[184:187], v[24:27], a[84:87], v[184:187]
    buffer_load_dwordx4 v[36:39], v3, s[20:23], s44 offen
    v_mfma_f32_16x16x32_bf16 v[216:219], v[24:27], a[88:91], v[216:219]
    v_perm_b32 v18, v84, v80, s93
    v_perm_b32 v19, v92, v88, s93
    v_mfma_f32_16x16x32_bf16 v[248:251], v[24:27], a[92:95], v[248:251]
    buffer_load_dwordx4 v[40:43], v4, s[20:23], s44 offen
    v_mfma_f32_16x16x32_bf16 v[156:159], v[28:31], a[80:83], v[156:159]
    v_perm_b32 v20, v68, v64, s94
    v_perm_b32 v21, v76, v72, s94
    v_mfma_f32_16x16x32_bf16 v[188:191], v[28:31], a[84:87], v[188:191]
    buffer_load_dwordx4 v[44:47], v5, s[20:23], s44 offen
    v_mfma_f32_16x16x32_bf16 v[220:223], v[28:31], a[88:91], v[220:223]
    v_perm_b32 v22, v84, v80, s94
    v_perm_b32 v23, v92, v88, s94
    v_mfma_f32_16x16x32_bf16 v[252:255], v[28:31], a[92:95], v[252:255]
    buffer_load_dwordx4 v[48:51], v6, s[20:23], s44 offen
    v_mfma_f32_16x16x32_bf16 v[128:131], v[16:19], a[64:67], v[128:131]
    v_perm_b32 v24, v69, v65, s93
    v_perm_b32 v25, v77, v73, s93
    v_mfma_f32_16x16x32_bf16 v[160:163], v[16:19], a[68:71], v[160:163]
    v_xor_b32 v10, s83, v11
    v_mfma_f32_16x16x32_bf16 v[192:195], v[16:19], a[72:75], v[192:195]
    v_perm_b32 v26, v85, v81, s93
    v_perm_b32 v27, v93, v89, s93
    v_mfma_f32_16x16x32_bf16 v[224:227], v[16:19], a[76:79], v[224:227]
    ds_read_b128 a[80:83], v10 offset:0
    v_mfma_f32_16x16x32_bf16 v[132:135], v[20:23], a[64:67], v[132:135]
    v_perm_b32 v28, v69, v65, s94
    v_perm_b32 v29, v77, v73, s94
    v_mfma_f32_16x16x32_bf16 v[164:167], v[20:23], a[68:71], v[164:167]
    ds_read_b128 a[84:87], v10 offset:2048
    v_mfma_f32_16x16x32_bf16 v[196:199], v[20:23], a[72:75], v[196:199]
    v_perm_b32 v30, v85, v81, s94
    v_perm_b32 v31, v93, v89, s94
    v_mfma_f32_16x16x32_bf16 v[228:231], v[20:23], a[76:79], v[228:231]
    ds_read_b128 a[88:91], v10 offset:4096
    v_mfma_f32_16x16x32_bf16 v[136:139], v[24:27], a[64:67], v[136:139]
    v_perm_b32 v16, v70, v66, s93
    v_perm_b32 v17, v78, v74, s93
    v_mfma_f32_16x16x32_bf16 v[168:171], v[24:27], a[68:71], v[168:171]
    ds_read_b128 a[92:95], v10 offset:6144
    v_mfma_f32_16x16x32_bf16 v[200:203], v[24:27], a[72:75], v[200:203]
    v_perm_b32 v18, v86, v82, s93
    v_perm_b32 v19, v94, v90, s93
    v_mfma_f32_16x16x32_bf16 v[232:235], v[24:27], a[76:79], v[232:235]
    buffer_load_dwordx4 v[52:55], v7, s[20:23], s44 offen
    v_mfma_f32_16x16x32_bf16 v[140:143], v[28:31], a[64:67], v[140:143]
    v_perm_b32 v20, v70, v66, s94
    v_perm_b32 v21, v78, v74, s94
    v_mfma_f32_16x16x32_bf16 v[172:175], v[28:31], a[68:71], v[172:175]
    buffer_load_dwordx4 v[56:59], v8, s[20:23], s44 offen
    v_mfma_f32_16x16x32_bf16 v[204:207], v[28:31], a[72:75], v[204:207]
    v_perm_b32 v22, v86, v82, s94
    v_perm_b32 v23, v94, v90, s94
    v_mfma_f32_16x16x32_bf16 v[236:239], v[28:31], a[76:79], v[236:239]
    buffer_load_dwordx4 v[60:63], v9, s[20:23], s44 offen
    v_mfma_f32_16x16x32_bf16 v[144:147], v[16:19], a[64:67], v[144:147]
    v_perm_b32 v24, v71, v67, s93
    v_perm_b32 v25, v79, v75, s93
    v_mfma_f32_16x16x32_bf16 v[176:179], v[16:19], a[68:71], v[176:179]
    v_mfma_f32_16x16x32_bf16 v[208:211], v[16:19], a[72:75], v[208:211]
    v_perm_b32 v26, v87, v83, s93
    v_perm_b32 v27, v95, v91, s93
    v_mfma_f32_16x16x32_bf16 v[240:243], v[16:19], a[76:79], v[240:243]
    s_waitcnt lgkmcnt(0)
    v_mfma_f32_16x16x32_bf16 v[148:151], v[20:23], a[64:67], v[148:151]
    v_perm_b32 v28, v71, v67, s94
    v_perm_b32 v29, v79, v75, s94
    v_mfma_f32_16x16x32_bf16 v[180:183], v[20:23], a[68:71], v[180:183]
    s_waitcnt vmcnt(8)
    v_mfma_f32_16x16x32_bf16 v[212:215], v[20:23], a[72:75], v[212:215]
    v_perm_b32 v30, v87, v83, s94
    v_perm_b32 v31, v95, v91, s94
    v_mfma_f32_16x16x32_bf16 v[244:247], v[20:23], a[76:79], v[244:247]
    buffer_load_dwordx4 v[64:67], v2, s[20:23], s45 offen
    v_mfma_f32_16x16x32_bf16 v[152:155], v[24:27], a[64:67], v[152:155]
    v_perm_b32 v16, v100, v96, s93
    v_perm_b32 v17, v108, v104, s93
    v_mfma_f32_16x16x32_bf16 v[184:187], v[24:27], a[68:71], v[184:187]
    buffer_load_dwordx4 v[68:71], v3, s[20:23], s45 offen
    v_mfma_f32_16x16x32_bf16 v[216:219], v[24:27], a[72:75], v[216:219]
    v_perm_b32 v18, v116, v112, s93
    v_perm_b32 v19, v124, v120, s93
    v_mfma_f32_16x16x32_bf16 v[248:251], v[24:27], a[76:79], v[248:251]
    buffer_load_dwordx4 v[72:75], v4, s[20:23], s45 offen
    v_mfma_f32_16x16x32_bf16 v[156:159], v[28:31], a[64:67], v[156:159]
    v_perm_b32 v20, v100, v96, s94
    v_perm_b32 v21, v108, v104, s94
    v_mfma_f32_16x16x32_bf16 v[188:191], v[28:31], a[68:71], v[188:191]
    buffer_load_dwordx4 v[76:79], v5, s[20:23], s45 offen
    v_mfma_f32_16x16x32_bf16 v[220:223], v[28:31], a[72:75], v[220:223]
    v_perm_b32 v22, v116, v112, s94
    v_perm_b32 v23, v124, v120, s94
    v_mfma_f32_16x16x32_bf16 v[252:255], v[28:31], a[76:79], v[252:255]
    buffer_load_dwordx4 v[80:83], v6, s[20:23], s45 offen
    v_mfma_f32_16x16x32_bf16 v[128:131], v[16:19], a[80:83], v[128:131]
    v_perm_b32 v24, v101, v97, s93
    v_perm_b32 v25, v109, v105, s93
    v_mfma_f32_16x16x32_bf16 v[160:163], v[16:19], a[84:87], v[160:163]
    v_xor_b32 v10, s84, v11
    v_mfma_f32_16x16x32_bf16 v[192:195], v[16:19], a[88:91], v[192:195]
    v_perm_b32 v26, v117, v113, s93
    v_perm_b32 v27, v125, v121, s93
    v_mfma_f32_16x16x32_bf16 v[224:227], v[16:19], a[92:95], v[224:227]
    ds_read_b128 a[64:67], v10 offset:0
    v_mfma_f32_16x16x32_bf16 v[132:135], v[20:23], a[80:83], v[132:135]
    v_perm_b32 v28, v101, v97, s94
    v_perm_b32 v29, v109, v105, s94
    v_mfma_f32_16x16x32_bf16 v[164:167], v[20:23], a[84:87], v[164:167]
    ds_read_b128 a[68:71], v10 offset:2048
    v_mfma_f32_16x16x32_bf16 v[196:199], v[20:23], a[88:91], v[196:199]
    v_perm_b32 v30, v117, v113, s94
    v_perm_b32 v31, v125, v121, s94
    v_mfma_f32_16x16x32_bf16 v[228:231], v[20:23], a[92:95], v[228:231]
    ds_read_b128 a[72:75], v10 offset:4096
    v_mfma_f32_16x16x32_bf16 v[136:139], v[24:27], a[80:83], v[136:139]
    v_perm_b32 v16, v102, v98, s93
    v_perm_b32 v17, v110, v106, s93
    v_mfma_f32_16x16x32_bf16 v[168:171], v[24:27], a[84:87], v[168:171]
    ds_read_b128 a[76:79], v10 offset:6144
    v_mfma_f32_16x16x32_bf16 v[200:203], v[24:27], a[88:91], v[200:203]
    v_perm_b32 v18, v118, v114, s93
    v_perm_b32 v19, v126, v122, s93
    v_mfma_f32_16x16x32_bf16 v[232:235], v[24:27], a[92:95], v[232:235]
    buffer_load_dwordx4 v[84:87], v7, s[20:23], s45 offen
    v_mfma_f32_16x16x32_bf16 v[140:143], v[28:31], a[80:83], v[140:143]
    v_perm_b32 v20, v102, v98, s94
    v_perm_b32 v21, v110, v106, s94
    v_mfma_f32_16x16x32_bf16 v[172:175], v[28:31], a[84:87], v[172:175]
    buffer_load_dwordx4 v[88:91], v8, s[20:23], s45 offen
    v_mfma_f32_16x16x32_bf16 v[204:207], v[28:31], a[88:91], v[204:207]
    v_perm_b32 v22, v118, v114, s94
    v_perm_b32 v23, v126, v122, s94
    v_mfma_f32_16x16x32_bf16 v[236:239], v[28:31], a[92:95], v[236:239]
    buffer_load_dwordx4 v[92:95], v9, s[20:23], s45 offen
    v_mfma_f32_16x16x32_bf16 v[144:147], v[16:19], a[80:83], v[144:147]
    v_perm_b32 v24, v103, v99, s93
    v_perm_b32 v25, v111, v107, s93
    v_mfma_f32_16x16x32_bf16 v[176:179], v[16:19], a[84:87], v[176:179]
    v_mfma_f32_16x16x32_bf16 v[208:211], v[16:19], a[88:91], v[208:211]
    v_perm_b32 v26, v119, v115, s93
    v_perm_b32 v27, v127, v123, s93
    v_mfma_f32_16x16x32_bf16 v[240:243], v[16:19], a[92:95], v[240:243]
    s_waitcnt lgkmcnt(0)
    v_mfma_f32_16x16x32_bf16 v[148:151], v[20:23], a[80:83], v[148:151]
    v_perm_b32 v28, v103, v99, s94
    v_perm_b32 v29, v111, v107, s94
    v_mfma_f32_16x16x32_bf16 v[180:183], v[20:23], a[84:87], v[180:183]
    s_waitcnt vmcnt(8)
    v_mfma_f32_16x16x32_bf16 v[212:215], v[20:23], a[88:91], v[212:215]
    v_perm_b32 v30, v119, v115, s94
    v_perm_b32 v31, v127, v123, s94
    v_mfma_f32_16x16x32_bf16 v[244:247], v[20:23], a[92:95], v[244:247]
    buffer_load_dwordx4 v[96:99], v2, s[20:23], s46 offen
    v_mfma_f32_16x16x32_bf16 v[152:155], v[24:27], a[80:83], v[152:155]
    v_perm_b32 v16, v36, v32, s93
    v_perm_b32 v17, v44, v40, s93
    v_mfma_f32_16x16x32_bf16 v[184:187], v[24:27], a[84:87], v[184:187]
    buffer_load_dwordx4 v[100:103], v3, s[20:23], s46 offen
    v_mfma_f32_16x16x32_bf16 v[216:219], v[24:27], a[88:91], v[216:219]
    v_perm_b32 v18, v52, v48, s93
    v_perm_b32 v19, v60, v56, s93
    v_mfma_f32_16x16x32_bf16 v[248:251], v[24:27], a[92:95], v[248:251]
    buffer_load_dwordx4 v[104:107], v4, s[20:23], s46 offen
    v_mfma_f32_16x16x32_bf16 v[156:159], v[28:31], a[80:83], v[156:159]
    v_perm_b32 v20, v36, v32, s94
    v_perm_b32 v21, v44, v40, s94
    v_mfma_f32_16x16x32_bf16 v[188:191], v[28:31], a[84:87], v[188:191]
    buffer_load_dwordx4 v[108:111], v5, s[20:23], s46 offen
    v_mfma_f32_16x16x32_bf16 v[220:223], v[28:31], a[88:91], v[220:223]
    v_perm_b32 v22, v52, v48, s94
    v_perm_b32 v23, v60, v56, s94
    v_mfma_f32_16x16x32_bf16 v[252:255], v[28:31], a[92:95], v[252:255]
    buffer_load_dwordx4 v[112:115], v6, s[20:23], s46 offen
    s_cmp_lg_u32 s7, 2
    s_cbranch_scc1 L_kb2
    s_add_u32 m0, s96, 0
    v_xor_b32 v1, 0, v12
    buffer_load_dwordx4 v1, s[12:15], s8 offen offset:0 nt lds
    v_xor_b32 v1, 128, v12
    buffer_load_dwordx4 v1, s[12:15], s8 offen offset:1024 nt lds
    v_xor_b32 v1, 192, v12
    buffer_load_dwordx4 v1, s[12:15], s8 offen offset:2048 nt lds
    v_xor_b32 v1, 64, v12
    buffer_load_dwordx4 v1, s[12:15], s8 offen offset:3072 nt lds
    s_add_u32 m0, s96, 4096
    v_xor_b32 v1, 0, v12
    buffer_load_dwordx4 v1, s[12:15], s9 offen offset:0 nt lds
    v_xor_b32 v1, 128, v12
    buffer_load_dwordx4 v1, s[12:15], s9 offen offset:1024 nt lds
    v_xor_b32 v1, 192, v12
    buffer_load_dwordx4 v1, s[12:15], s9 offen offset:2048 nt lds
    v_xor_b32 v1, 64, v12
    buffer_load_dwordx4 v1, s[12:15], s9 offen offset:3072 nt lds
    s_add_u32 m0, s96, 8192
    v_xor_b32 v1, 0, v12
    buffer_load_dwordx4 v1, s[12:15], s10 offen offset:0 nt lds
    v_xor_b32 v1, 128, v12
    buffer_load_dwordx4 v1, s[12:15], s10 offen offset:1024 nt lds
    v_xor_b32 v1, 192, v12
    buffer_load_dwordx4 v1, s[12:15], s10 offen offset:2048 nt lds
    v_xor_b32 v1, 64, v12
    buffer_load_dwordx4 v1, s[12:15], s10 offen offset:3072 nt lds
    s_add_u32 m0, s96, 12288
    v_xor_b32 v1, 0, v12
    buffer_load_dwordx4 v1, s[12:15], s11 offen offset:0 nt lds
    v_xor_b32 v1, 128, v12
    buffer_load_dwordx4 v1, s[12:15], s11 offen offset:1024 nt lds
    v_xor_b32 v1, 192, v12
    buffer_load_dwordx4 v1, s[12:15], s11 offen offset:2048 nt lds
    v_xor_b32 v1, 64, v12
    buffer_load_dwordx4 v1, s[12:15], s11 offen offset:3072 nt lds
L_kb2:
    s_cmp_lg_u32 s7, 2
    s_cbranch_scc1 L_vb2
    buffer_load_dwordx4 a[0:3], v13, s[16:19], s8 offen offset:0 nt
    buffer_load_dwordx4 a[4:7], v13, s[16:19], s8 offen offset:256 nt
    buffer_load_dwordx4 a[8:11], v13, s[16:19], s8 offen offset:512 nt
    buffer_load_dwordx4 a[12:15], v13, s[16:19], s8 offen offset:768 nt
    buffer_load_dwordx4 a[16:19], v13, s[16:19], s9 offen offset:0 nt
    buffer_load_dwordx4 a[20:23], v13, s[16:19], s9 offen offset:256 nt
    buffer_load_dwordx4 a[24:27], v13, s[16:19], s9 offen offset:512 nt
    buffer_load_dwordx4 a[28:31], v13, s[16:19], s9 offen offset:768 nt
    buffer_load_dwordx4 a[32:35], v13, s[16:19], s10 offen offset:0 nt
    buffer_load_dwordx4 a[36:39], v13, s[16:19], s10 offen offset:256 nt
    buffer_load_dwordx4 a[40:43], v13, s[16:19], s10 offen offset:512 nt
    buffer_load_dwordx4 a[44:47], v13, s[16:19], s10 offen offset:768 nt
    buffer_load_dwordx4 a[48:51], v13, s[16:19], s11 offen offset:0 nt
    buffer_load_dwordx4 a[52:55], v13, s[16:19], s11 offen offset:256 nt
    buffer_load_dwordx4 a[56:59], v13, s[16:19], s11 offen offset:512 nt
    buffer_load_dwordx4 a[60:63], v13, s[16:19], s11 offen offset:768 nt
L_vb2:
    v_mfma_f32_16x16x32_bf16 v[128:131], v[16:19], a[64:67], v[128:131]
    v_perm_b32 v24, v37, v33, s93
    v_perm_b32 v25, v45, v41, s93
    v_mfma_f32_16x16x32_bf16 v[160:163], v[16:19], a[68:71], v[160:163]
    v_xor_b32 v10, s85, v11
    v_mfma_f32_16x16x32_bf16 v[192:195], v[16:19], a[72:75], v[192:195]
    v_perm_b32 v26, v53, v49, s93
    v_perm_b32 v27, v61, v57, s93
    v_mfma_f32_16x16x32_bf16 v[224:227], v[16:19], a[76:79], v[224:227]
    ds_read_b128 a[80:83], v10 offset:0
    v_mfma_f32_16x16x32_bf16 v[132:135], v[20:23], a[64:67], v[132:135]
    v_perm_b32 v28, v37, v33, s94
    v_perm_b32 v29, v45, v41, s94
    v_mfma_f32_16x16x32_bf16 v[164:167], v[20:23], a[68:71], v[164:167]
    ds_read_b128 a[84:87], v10 offset:2048
    v_mfma_f32_16x16x32_bf16 v[196:199], v[20:23], a[72:75], v[196:199]
    v_perm_b32 v30, v53, v49, s94
    v_perm_b32 v31, v61, v57, s94
    v_mfma_f32_16x16x32_bf16 v[228:231], v[20:23], a[76:79], v[228:231]
    ds_read_b128 a[88:91], v10 offset:4096
    v_mfma_f32_16x16x32_bf16 v[136:139], v[24:27], a[64:67], v[136:139]
    v_perm_b32 v16, v38, v34, s93
    v_perm_b32 v17, v46, v42, s93
    v_mfma_f32_16x16x32_bf16 v[168:171], v[24:27], a[68:71], v[168:171]
    ds_read_b128 a[92:95], v10 offset:6144
    v_mfma_f32_16x16x32_bf16 v[200:203], v[24:27], a[72:75], v[200:203]
    v_perm_b32 v18, v54, v50, s93
    v_perm_b32 v19, v62, v58, s93
    v_mfma_f32_16x16x32_bf16 v[232:235], v[24:27], a[76:79], v[232:235]
    buffer_load_dwordx4 v[116:119], v7, s[20:23], s46 offen
    v_mfma_f32_16x16x32_bf16 v[140:143], v[28:31], a[64:67], v[140:143]
    v_perm_b32 v20, v38, v34, s94
    v_perm_b32 v21, v46, v42, s94
    v_mfma_f32_16x16x32_bf16 v[172:175], v[28:31], a[68:71], v[172:175]
    buffer_load_dwordx4 v[120:123], v8, s[20:23], s46 offen
    v_mfma_f32_16x16x32_bf16 v[204:207], v[28:31], a[72:75], v[204:207]
    v_perm_b32 v22, v54, v50, s94
    v_perm_b32 v23, v62, v58, s94
    v_mfma_f32_16x16x32_bf16 v[236:239], v[28:31], a[76:79], v[236:239]
    buffer_load_dwordx4 v[124:127], v9, s[20:23], s46 offen
    v_mfma_f32_16x16x32_bf16 v[144:147], v[16:19], a[64:67], v[144:147]
    v_perm_b32 v24, v39, v35, s93
    v_perm_b32 v25, v47, v43, s93
    v_mfma_f32_16x16x32_bf16 v[176:179], v[16:19], a[68:71], v[176:179]
    v_mfma_f32_16x16x32_bf16 v[208:211], v[16:19], a[72:75], v[208:211]
    v_perm_b32 v26, v55, v51, s93
    v_perm_b32 v27, v63, v59, s93
    v_mfma_f32_16x16x32_bf16 v[240:243], v[16:19], a[76:79], v[240:243]
    s_waitcnt lgkmcnt(0)
    v_mfma_f32_16x16x32_bf16 v[148:151], v[20:23], a[64:67], v[148:151]
    v_perm_b32 v28, v39, v35, s94
    v_perm_b32 v29, v47, v43, s94
    v_mfma_f32_16x16x32_bf16 v[180:183], v[20:23], a[68:71], v[180:183]
    s_cmp_eq_u32 s7, 2
    s_cbranch_scc1 L_w3
    s_waitcnt vmcnt(8)
L_w3:
    s_waitcnt vmcnt(40)
    v_mfma_f32_16x16x32_bf16 v[212:215], v[20:23], a[72:75], v[212:215]
    v_perm_b32 v30, v55, v51, s94
    v_perm_b32 v31, v63, v59, s94
    v_mfma_f32_16x16x32_bf16 v[244:247], v[20:23], a[76:79], v[244:247]
    buffer_load_dwordx4 v[32:35], v2, s[20:23], s47 offen
    v_mfma_f32_16x16x32_bf16 v[152:155], v[24:27], a[64:67], v[152:155]
    v_perm_b32 v16, v68, v64, s93
    v_perm_b32 v17, v76, v72, s93
    v_mfma_f32_16x16x32_bf16 v[184:187], v[24:27], a[68:71], v[184:187]
    buffer_load_dwordx4 v[36:39], v3, s[20:23], s47 offen
    v_mfma_f32_16x16x32_bf16 v[216:219], v[24:27], a[72:75], v[216:219]
    v_perm_b32 v18, v84, v80, s93
    v_perm_b32 v19, v92, v88, s93
    v_mfma_f32_16x16x32_bf16 v[248:251], v[24:27], a[76:79], v[248:251]
    buffer_load_dwordx4 v[40:43], v4, s[20:23], s47 offen
    v_mfma_f32_16x16x32_bf16 v[156:159], v[28:31], a[64:67], v[156:159]
    v_perm_b32 v20, v68, v64, s94
    v_perm_b32 v21, v76, v72, s94
    v_mfma_f32_16x16x32_bf16 v[188:191], v[28:31], a[68:71], v[188:191]
    buffer_load_dwordx4 v[44:47], v5, s[20:23], s47 offen
    v_mfma_f32_16x16x32_bf16 v[220:223], v[28:31], a[72:75], v[220:223]
    v_perm_b32 v22, v84, v80, s94
    v_perm_b32 v23, v92, v88, s94
    v_mfma_f32_16x16x32_bf16 v[252:255], v[28:31], a[76:79], v[252:255]
    buffer_load_dwordx4 v[48:51], v6, s[20:23], s47 offen
    v_mfma_f32_16x16x32_bf16 v[128:131], v[16:19], a[80:83], v[128:131]
    v_perm_b32 v24, v69, v65, s93
    v_perm_b32 v25, v77, v73, s93
    v_mfma_f32_16x16x32_bf16 v[160:163], v[16:19], a[84:87], v[160:163]
    v_xor_b32 v10, s86, v11
    v_mfma_f32_16x16x32_bf16 v[192:195], v[16:19], a[88:91], v[192:195]
    v_perm_b32 v26, v85, v81, s93
    v_perm_b32 v27, v93, v89, s93
    v_mfma_f32_16x16x32_bf16 v[224:227], v[16:19], a[92:95], v[224:227]
    ds_read_b128 a[64:67], v10 offset:0
    v_mfma_f32_16x16x32_bf16 v[132:135], v[20:23], a[80:83], v[132:135]
    v_perm_b32 v28, v69, v65, s94
    v_perm_b32 v29, v77, v73, s94
    v_mfma_f32_16x16x32_bf16 v[164:167], v[20:23], a[84:87], v[164:167]
    ds_read_b128 a[68:71], v10 offset:2048
    v_mfma_f32_16x16x32_bf16 v[196:199], v[20:23], a[88:91], v[196:199]
    v_perm_b32 v30, v85, v81, s94
    v_perm_b32 v31, v93, v89, s94
    v_mfma_f32_16x16x32_bf16 v[228:231], v[20:23], a[92:95], v[228:231]
    ds_read_b128 a[72:75], v10 offset:4096
    v_mfma_f32_16x16x32_bf16 v[136:139], v[24:27], a[80:83], v[136:139]
    v_perm_b32 v16, v70, v66, s93
    v_perm_b32 v17, v78, v74, s93
    v_mfma_f32_16x16x32_bf16 v[168:171], v[24:27], a[84:87], v[168:171]
    ds_read_b128 a[76:79], v10 offset:6144
    v_mfma_f32_16x16x32_bf16 v[200:203], v[24:27], a[88:91], v[200:203]
    v_perm_b32 v18, v86, v82, s93
    v_perm_b32 v19, v94, v90, s93
    v_mfma_f32_16x16x32_bf16 v[232:235], v[24:27], a[92:95], v[232:235]
    buffer_load_dwordx4 v[52:55], v7, s[20:23], s47 offen
    v_mfma_f32_16x16x32_bf16 v[140:143], v[28:31], a[80:83], v[140:143]
    v_perm_b32 v20, v70, v66, s94
    v_perm_b32 v21, v78, v74, s94
    v_mfma_f32_16x16x32_bf16 v[172:175], v[28:31], a[84:87], v[172:175]
    buffer_load_dwordx4 v[56:59], v8, s[20:23], s47 offen
    v_mfma_f32_16x16x32_bf16 v[204:207], v[28:31], a[88:91], v[204:207]
    v_perm_b32 v22, v86, v82, s94
    v_perm_b32 v23, v94, v90, s94
    v_mfma_f32_16x16x32_bf16 v[236:239], v[28:31], a[92:95], v[236:239]
    buffer_load_dwordx4 v[60:63], v9, s[20:23], s47 offen
    v_mfma_f32_16x16x32_bf16 v[144:147], v[16:19], a[80:83], v[144:147]
    v_perm_b32 v24, v71, v67, s93
    v_perm_b32 v25, v79, v75, s93
    v_mfma_f32_16x16x32_bf16 v[176:179], v[16:19], a[84:87], v[176:179]
    v_mfma_f32_16x16x32_bf16 v[208:211], v[16:19], a[88:91], v[208:211]
    v_perm_b32 v26, v87, v83, s93
    v_perm_b32 v27, v95, v91, s93
    v_mfma_f32_16x16x32_bf16 v[240:243], v[16:19], a[92:95], v[240:243]
    s_waitcnt lgkmcnt(0)
    v_mfma_f32_16x16x32_bf16 v[148:151], v[20:23], a[80:83], v[148:151]
    v_perm_b32 v28, v71, v67, s94
    v_perm_b32 v29, v79, v75, s94
    v_mfma_f32_16x16x32_bf16 v[180:183], v[20:23], a[84:87], v[180:183]
    s_waitcnt vmcnt(8)
    v_mfma_f32_16x16x32_bf16 v[212:215], v[20:23], a[88:91], v[212:215]
    v_perm_b32 v30, v87, v83, s94
    v_perm_b32 v31, v95, v91, s94
    v_mfma_f32_16x16x32_bf16 v[244:247], v[20:23], a[92:95], v[244:247]
    buffer_load_dwordx4 v[64:67], v2, s[20:23], s48 offen
    v_mfma_f32_16x16x32_bf16 v[152:155], v[24:27], a[80:83], v[152:155]
    v_perm_b32 v16, v100, v96, s93
    v_perm_b32 v17, v108, v104, s93
    v_mfma_f32_16x16x32_bf16 v[184:187], v[24:27], a[84:87], v[184:187]
    buffer_load_dwordx4 v[68:71], v3, s[20:23], s48 offen
    v_mfma_f32_16x16x32_bf16 v[216:219], v[24:27], a[88:91], v[216:219]
    v_perm_b32 v18, v116, v112, s93
    v_perm_b32 v19, v124, v120, s93
    v_mfma_f32_16x16x32_bf16 v[248:251], v[24:27], a[92:95], v[248:251]
    buffer_load_dwordx4 v[72:75], v4, s[20:23], s48 offen
    v_mfma_f32_16x16x32_bf16 v[156:159], v[28:31], a[80:83], v[156:159]
    v_perm_b32 v20, v100, v96, s94
    v_perm_b32 v21, v108, v104, s94
    v_mfma_f32_16x16x32_bf16 v[188:191], v[28:31], a[84:87], v[188:191]
    buffer_load_dwordx4 v[76:79], v5, s[20:23], s48 offen
    v_mfma_f32_16x16x32_bf16 v[220:223], v[28:31], a[88:91], v[220:223]
    v_perm_b32 v22, v116, v112, s94
    v_perm_b32 v23, v124, v120, s94
    v_mfma_f32_16x16x32_bf16 v[252:255], v[28:31], a[92:95], v[252:255]
    buffer_load_dwordx4 v[80:83], v6, s[20:23], s48 offen
    v_mfma_f32_16x16x32_bf16 v[128:131], v[16:19], a[64:67], v[128:131]
    v_perm_b32 v24, v101, v97, s93
    v_perm_b32 v25, v109, v105, s93
    v_mfma_f32_16x16x32_bf16 v[160:163], v[16:19], a[68:71], v[160:163]
    v_xor_b32 v10, s87, v11
    v_mfma_f32_16x16x32_bf16 v[192:195], v[16:19], a[72:75], v[192:195]
    v_perm_b32 v26, v117, v113, s93
    v_perm_b32 v27, v125, v121, s93
    v_mfma_f32_16x16x32_bf16 v[224:227], v[16:19], a[76:79], v[224:227]
    ds_read_b128 a[80:83], v10 offset:0
    v_mfma_f32_16x16x32_bf16 v[132:135], v[20:23], a[64:67], v[132:135]
    v_perm_b32 v28, v101, v97, s94
    v_perm_b32 v29, v109, v105, s94
    v_mfma_f32_16x16x32_bf16 v[164:167], v[20:23], a[68:71], v[164:167]
    ds_read_b128 a[84:87], v10 offset:2048
    v_mfma_f32_16x16x32_bf16 v[196:199], v[20:23], a[72:75], v[196:199]
    v_perm_b32 v30, v117, v113, s94
    v_perm_b32 v31, v125, v121, s94
    v_mfma_f32_16x16x32_bf16 v[228:231], v[20:23], a[76:79], v[228:231]
    ds_read_b128 a[88:91], v10 offset:4096
    v_mfma_f32_16x16x32_bf16 v[136:139], v[24:27], a[64:67], v[136:139]
    v_perm_b32 v16, v102, v98, s93
    v_perm_b32 v17, v110, v106, s93
    v_mfma_f32_16x16x32_bf16 v[168:171], v[24:27], a[68:71], v[168:171]
    ds_read_b128 a[92:95], v10 offset:6144
    v_mfma_f32_16x16x32_bf16 v[200:203], v[24:27], a[72:75], v[200:203]
    v_perm_b32 v18, v118, v114, s93
    v_perm_b32 v19, v126, v122, s93
    v_mfma_f32_16x16x32_bf16 v[232:235], v[24:27], a[76:79], v[232:235]
    buffer_load_dwordx4 v[84:87], v7, s[20:23], s48 offen
    v_mfma_f32_16x16x32_bf16 v[140:143], v[28:31], a[64:67], v[140:143]
    v_perm_b32 v20, v102, v98, s94
    v_perm_b32 v21, v110, v106, s94
    v_mfma_f32_16x16x32_bf16 v[172:175], v[28:31], a[68:71], v[172:175]
    buffer_load_dwordx4 v[88:91], v8, s[20:23], s48 offen
    v_mfma_f32_16x16x32_bf16 v[204:207], v[28:31], a[72:75], v[204:207]
    v_perm_b32 v22, v118, v114, s94
    v_perm_b32 v23, v126, v122, s94
    v_mfma_f32_16x16x32_bf16 v[236:239], v[28:31], a[76:79], v[236:239]
    buffer_load_dwordx4 v[92:95], v9, s[20:23], s48 offen
    v_mfma_f32_16x16x32_bf16 v[144:147], v[16:19], a[64:67], v[144:147]
    v_perm_b32 v24, v103, v99, s93
    v_perm_b32 v25, v111, v107, s93
    v_mfma_f32_16x16x32_bf16 v[176:179], v[16:19], a[68:71], v[176:179]
    v_mfma_f32_16x16x32_bf16 v[208:211], v[16:19], a[72:75], v[208:211]
    v_perm_b32 v26, v119, v115, s93
    v_perm_b32 v27, v127, v123, s93
    v_mfma_f32_16x16x32_bf16 v[240:243], v[16:19], a[76:79], v[240:243]
    s_waitcnt lgkmcnt(0)
    v_mfma_f32_16x16x32_bf16 v[148:151], v[20:23], a[64:67], v[148:151]
    v_perm_b32 v28, v103, v99, s94
    v_perm_b32 v29, v111, v107, s94
    v_mfma_f32_16x16x32_bf16 v[180:183], v[20:23], a[68:71], v[180:183]
    s_waitcnt vmcnt(8)
    v_mfma_f32_16x16x32_bf16 v[212:215], v[20:23], a[72:75], v[212:215]
    v_perm_b32 v30, v119, v115, s94
    v_perm_b32 v31, v127, v123, s94
    v_mfma_f32_16x16x32_bf16 v[244:247], v[20:23], a[76:79], v[244:247]
    buffer_load_dwordx4 v[96:99], v2, s[20:23], s49 offen
    v_mfma_f32_16x16x32_bf16 v[152:155], v[24:27], a[64:67], v[152:155]
    v_perm_b32 v16, v36, v32, s93
    v_perm_b32 v17, v44, v40, s93
    v_mfma_f32_16x16x32_bf16 v[184:187], v[24:27], a[68:71], v[184:187]
    buffer_load_dwordx4 v[100:103], v3, s[20:23], s49 offen
    v_mfma_f32_16x16x32_bf16 v[216:219], v[24:27], a[72:75], v[216:219]
    v_perm_b32 v18, v52, v48, s93
    v_perm_b32 v19, v60, v56, s93
    v_mfma_f32_16x16x32_bf16 v[248:251], v[24:27], a[76:79], v[248:251]
    buffer_load_dwordx4 v[104:107], v4, s[20:23], s49 offen
    v_mfma_f32_16x16x32_bf16 v[156:159], v[28:31], a[64:67], v[156:159]
    v_perm_b32 v20, v36, v32, s94
    v_perm_b32 v21, v44, v40, s94
    v_mfma_f32_16x16x32_bf16 v[188:191], v[28:31], a[68:71], v[188:191]
    buffer_load_dwordx4 v[108:111], v5, s[20:23], s49 offen
    v_mfma_f32_16x16x32_bf16 v[220:223], v[28:31], a[72:75], v[220:223]
    v_perm_b32 v22, v52, v48, s94
    v_perm_b32 v23, v60, v56, s94
    v_mfma_f32_16x16x32_bf16 v[252:255], v[28:31], a[76:79], v[252:255]
    buffer_load_dwordx4 v[112:115], v6, s[20:23], s49 offen
    v_mfma_f32_16x16x32_bf16 v[128:131], v[16:19], a[80:83], v[128:131]
    v_perm_b32 v24, v37, v33, s93
    v_perm_b32 v25, v45, v41, s93
    v_mfma_f32_16x16x32_bf16 v[160:163], v[16:19], a[84:87], v[160:163]
    v_xor_b32 v10, s88, v11
    v_mfma_f32_16x16x32_bf16 v[192:195], v[16:19], a[88:91], v[192:195]
    v_perm_b32 v26, v53, v49, s93
    v_perm_b32 v27, v61, v57, s93
    v_mfma_f32_16x16x32_bf16 v[224:227], v[16:19], a[92:95], v[224:227]
    ds_read_b128 a[64:67], v10 offset:0
    v_mfma_f32_16x16x32_bf16 v[132:135], v[20:23], a[80:83], v[132:135]
    v_perm_b32 v28, v37, v33, s94
    v_perm_b32 v29, v45, v41, s94
    v_mfma_f32_16x16x32_bf16 v[164:167], v[20:23], a[84:87], v[164:167]
    ds_read_b128 a[68:71], v10 offset:2048
    v_mfma_f32_16x16x32_bf16 v[196:199], v[20:23], a[88:91], v[196:199]
    v_perm_b32 v30, v53, v49, s94
    v_perm_b32 v31, v61, v57, s94
    v_mfma_f32_16x16x32_bf16 v[228:231], v[20:23], a[92:95], v[228:231]
    ds_read_b128 a[72:75], v10 offset:4096
    v_mfma_f32_16x16x32_bf16 v[136:139], v[24:27], a[80:83], v[136:139]
    v_perm_b32 v16, v38, v34, s93
    v_perm_b32 v17, v46, v42, s93
    v_mfma_f32_16x16x32_bf16 v[168:171], v[24:27], a[84:87], v[168:171]
    ds_read_b128 a[76:79], v10 offset:6144
    v_mfma_f32_16x16x32_bf16 v[200:203], v[24:27], a[88:91], v[200:203]
    v_perm_b32 v18, v54, v50, s93
    v_perm_b32 v19, v62, v58, s93
    v_mfma_f32_16x16x32_bf16 v[232:235], v[24:27], a[92:95], v[232:235]
    buffer_load_dwordx4 v[116:119], v7, s[20:23], s49 offen
    v_mfma_f32_16x16x32_bf16 v[140:143], v[28:31], a[80:83], v[140:143]
    v_perm_b32 v20, v38, v34, s94
    v_perm_b32 v21, v46, v42, s94
    v_mfma_f32_16x16x32_bf16 v[172:175], v[28:31], a[84:87], v[172:175]
    buffer_load_dwordx4 v[120:123], v8, s[20:23], s49 offen
    v_mfma_f32_16x16x32_bf16 v[204:207], v[28:31], a[88:91], v[204:207]
    v_perm_b32 v22, v54, v50, s94
    v_perm_b32 v23, v62, v58, s94
    v_mfma_f32_16x16x32_bf16 v[236:239], v[28:31], a[92:95], v[236:239]
    buffer_load_dwordx4 v[124:127], v9, s[20:23], s49 offen
    v_mfma_f32_16x16x32_bf16 v[144:147], v[16:19], a[80:83], v[144:147]
    v_perm_b32 v24, v39, v35, s93
    v_perm_b32 v25, v47, v43, s93
    v_mfma_f32_16x16x32_bf16 v[176:179], v[16:19], a[84:87], v[176:179]
    v_mfma_f32_16x16x32_bf16 v[208:211], v[16:19], a[88:91], v[208:211]
    v_perm_b32 v26, v55, v51, s93
    v_perm_b32 v27, v63, v59, s93
    v_mfma_f32_16x16x32_bf16 v[240:243], v[16:19], a[92:95], v[240:243]
    s_waitcnt lgkmcnt(0)
    v_mfma_f32_16x16x32_bf16 v[148:151], v[20:23], a[80:83], v[148:151]
    v_perm_b32 v28, v39, v35, s94
    v_perm_b32 v29, v47, v43, s94
    v_mfma_f32_16x16x32_bf16 v[180:183], v[20:23], a[84:87], v[180:183]
    s_waitcnt vmcnt(8)
    v_mfma_f32_16x16x32_bf16 v[212:215], v[20:23], a[88:91], v[212:215]
    v_perm_b32 v30, v55, v51, s94
    v_perm_b32 v31, v63, v59, s94
    v_mfma_f32_16x16x32_bf16 v[244:247], v[20:23], a[92:95], v[244:247]
    buffer_load_dwordx4 v[32:35], v2, s[20:23], s50 offen
    v_mfma_f32_16x16x32_bf16 v[152:155], v[24:27], a[80:83], v[152:155]
    v_perm_b32 v16, v68, v64, s93
    v_perm_b32 v17, v76, v72, s93
    v_mfma_f32_16x16x32_bf16 v[184:187], v[24:27], a[84:87], v[184:187]
    buffer_load_dwordx4 v[36:39], v3, s[20:23], s50 offen
    v_mfma_f32_16x16x32_bf16 v[216:219], v[24:27], a[88:91], v[216:219]
    v_perm_b32 v18, v84, v80, s93
    v_perm_b32 v19, v92, v88, s93
    v_mfma_f32_16x16x32_bf16 v[248:251], v[24:27], a[92:95], v[248:251]
    buffer_load_dwordx4 v[40:43], v4, s[20:23], s50 offen
    v_mfma_f32_16x16x32_bf16 v[156:159], v[28:31], a[80:83], v[156:159]
    v_perm_b32 v20, v68, v64, s94
    v_perm_b32 v21, v76, v72, s94
    v_mfma_f32_16x16x32_bf16 v[188:191], v[28:31], a[84:87], v[188:191]
    buffer_load_dwordx4 v[44:47], v5, s[20:23], s50 offen
    v_mfma_f32_16x16x32_bf16 v[220:223], v[28:31], a[88:91], v[220:223]
    v_perm_b32 v22, v84, v80, s94
    v_perm_b32 v23, v92, v88, s94
    v_mfma_f32_16x16x32_bf16 v[252:255], v[28:31], a[92:95], v[252:255]
    buffer_load_dwordx4 v[48:51], v6, s[20:23], s50 offen
    v_mfma_f32_16x16x32_bf16 v[128:131], v[16:19], a[64:67], v[128:131]
    v_perm_b32 v24, v69, v65, s93
    v_perm_b32 v25, v77, v73, s93
    v_mfma_f32_16x16x32_bf16 v[160:163], v[16:19], a[68:71], v[160:163]
    v_xor_b32 v10, s89, v11
    v_mfma_f32_16x16x32_bf16 v[192:195], v[16:19], a[72:75], v[192:195]
    v_perm_b32 v26, v85, v81, s93
    v_perm_b32 v27, v93, v89, s93
    v_mfma_f32_16x16x32_bf16 v[224:227], v[16:19], a[76:79], v[224:227]
    ds_read_b128 a[80:83], v10 offset:0
    v_mfma_f32_16x16x32_bf16 v[132:135], v[20:23], a[64:67], v[132:135]
    v_perm_b32 v28, v69, v65, s94
    v_perm_b32 v29, v77, v73, s94
    v_mfma_f32_16x16x32_bf16 v[164:167], v[20:23], a[68:71], v[164:167]
    ds_read_b128 a[84:87], v10 offset:2048
    v_mfma_f32_16x16x32_bf16 v[196:199], v[20:23], a[72:75], v[196:199]
    v_perm_b32 v30, v85, v81, s94
    v_perm_b32 v31, v93, v89, s94
    v_mfma_f32_16x16x32_bf16 v[228:231], v[20:23], a[76:79], v[228:231]
    ds_read_b128 a[88:91], v10 offset:4096
    v_mfma_f32_16x16x32_bf16 v[136:139], v[24:27], a[64:67], v[136:139]
    v_perm_b32 v16, v70, v66, s93
    v_perm_b32 v17, v78, v74, s93
    v_mfma_f32_16x16x32_bf16 v[168:171], v[24:27], a[68:71], v[168:171]
    ds_read_b128 a[92:95], v10 offset:6144
    v_mfma_f32_16x16x32_bf16 v[200:203], v[24:27], a[72:75], v[200:203]
    v_perm_b32 v18, v86, v82, s93
    v_perm_b32 v19, v94, v90, s93
    v_mfma_f32_16x16x32_bf16 v[232:235], v[24:27], a[76:79], v[232:235]
    buffer_load_dwordx4 v[52:55], v7, s[20:23], s50 offen
    v_mfma_f32_16x16x32_bf16 v[140:143], v[28:31], a[64:67], v[140:143]
    v_perm_b32 v20, v70, v66, s94
    v_perm_b32 v21, v78, v74, s94
    v_mfma_f32_16x16x32_bf16 v[172:175], v[28:31], a[68:71], v[172:175]
    buffer_load_dwordx4 v[56:59], v8, s[20:23], s50 offen
    v_mfma_f32_16x16x32_bf16 v[204:207], v[28:31], a[72:75], v[204:207]
    v_perm_b32 v22, v86, v82, s94
    v_perm_b32 v23, v94, v90, s94
    v_mfma_f32_16x16x32_bf16 v[236:239], v[28:31], a[76:79], v[236:239]
    buffer_load_dwordx4 v[60:63], v9, s[20:23], s50 offen
    v_mfma_f32_16x16x32_bf16 v[144:147], v[16:19], a[64:67], v[144:147]
    v_perm_b32 v24, v71, v67, s93
    v_perm_b32 v25, v79, v75, s93
    v_mfma_f32_16x16x32_bf16 v[176:179], v[16:19], a[68:71], v[176:179]
    v_mfma_f32_16x16x32_bf16 v[208:211], v[16:19], a[72:75], v[208:211]
    v_perm_b32 v26, v87, v83, s93
    v_perm_b32 v27, v95, v91, s93
    v_mfma_f32_16x16x32_bf16 v[240:243], v[16:19], a[76:79], v[240:243]
    s_waitcnt lgkmcnt(0)
    v_mfma_f32_16x16x32_bf16 v[148:151], v[20:23], a[64:67], v[148:151]
    v_perm_b32 v28, v71, v67, s94
    v_perm_b32 v29, v79, v75, s94
    v_mfma_f32_16x16x32_bf16 v[180:183], v[20:23], a[68:71], v[180:183]
    s_waitcnt vmcnt(8)
    v_mfma_f32_16x16x32_bf16 v[212:215], v[20:23], a[72:75], v[212:215]
    v_perm_b32 v30, v87, v83, s94
    v_perm_b32 v31, v95, v91, s94
    v_mfma_f32_16x16x32_bf16 v[244:247], v[20:23], a[76:79], v[244:247]
    buffer_load_dwordx4 v[64:67], v2, s[20:23], s51 offen
    v_mfma_f32_16x16x32_bf16 v[152:155], v[24:27], a[64:67], v[152:155]
    v_perm_b32 v16, v100, v96, s93
    v_perm_b32 v17, v108, v104, s93
    v_mfma_f32_16x16x32_bf16 v[184:187], v[24:27], a[68:71], v[184:187]
    buffer_load_dwordx4 v[68:71], v3, s[20:23], s51 offen
    v_mfma_f32_16x16x32_bf16 v[216:219], v[24:27], a[72:75], v[216:219]
    v_perm_b32 v18, v116, v112, s93
    v_perm_b32 v19, v124, v120, s93
    v_mfma_f32_16x16x32_bf16 v[248:251], v[24:27], a[76:79], v[248:251]
    buffer_load_dwordx4 v[72:75], v4, s[20:23], s51 offen
    v_mfma_f32_16x16x32_bf16 v[156:159], v[28:31], a[64:67], v[156:159]
    v_perm_b32 v20, v100, v96, s94
    v_perm_b32 v21, v108, v104, s94
    v_mfma_f32_16x16x32_bf16 v[188:191], v[28:31], a[68:71], v[188:191]
    buffer_load_dwordx4 v[76:79], v5, s[20:23], s51 offen
    v_mfma_f32_16x16x32_bf16 v[220:223], v[28:31], a[72:75], v[220:223]
    v_perm_b32 v22, v116, v112, s94
    v_perm_b32 v23, v124, v120, s94
    v_mfma_f32_16x16x32_bf16 v[252:255], v[28:31], a[76:79], v[252:255]
    buffer_load_dwordx4 v[80:83], v6, s[20:23], s51 offen
    s_cmp_lg_u32 s7, 3
    s_cbranch_scc1 L_kb3
    s_add_u32 m0, s96, 0
    v_xor_b32 v1, 0, v12
    buffer_load_dwordx4 v1, s[12:15], s8 offen offset:0 nt lds
    v_xor_b32 v1, 128, v12
    buffer_load_dwordx4 v1, s[12:15], s8 offen offset:1024 nt lds
    v_xor_b32 v1, 192, v12
    buffer_load_dwordx4 v1, s[12:15], s8 offen offset:2048 nt lds
    v_xor_b32 v1, 64, v12
    buffer_load_dwordx4 v1, s[12:15], s8 offen offset:3072 nt lds
    s_add_u32 m0, s96, 4096
    v_xor_b32 v1, 0, v12
    buffer_load_dwordx4 v1, s[12:15], s9 offen offset:0 nt lds
    v_xor_b32 v1, 128, v12
    buffer_load_dwordx4 v1, s[12:15], s9 offen offset:1024 nt lds
    v_xor_b32 v1, 192, v12
    buffer_load_dwordx4 v1, s[12:15], s9 offen offset:2048 nt lds
    v_xor_b32 v1, 64, v12
    buffer_load_dwordx4 v1, s[12:15], s9 offen offset:3072 nt lds
    s_add_u32 m0, s96, 8192
    v_xor_b32 v1, 0, v12
    buffer_load_dwordx4 v1, s[12:15], s10 offen offset:0 nt lds
    v_xor_b32 v1, 128, v12
    buffer_load_dwordx4 v1, s[12:15], s10 offen offset:1024 nt lds
    v_xor_b32 v1, 192, v12
    buffer_load_dwordx4 v1, s[12:15], s10 offen offset:2048 nt lds
    v_xor_b32 v1, 64, v12
    buffer_load_dwordx4 v1, s[12:15], s10 offen offset:3072 nt lds
    s_add_u32 m0, s96, 12288
    v_xor_b32 v1, 0, v12
    buffer_load_dwordx4 v1, s[12:15], s11 offen offset:0 nt lds
    v_xor_b32 v1, 128, v12
    buffer_load_dwordx4 v1, s[12:15], s11 offen offset:1024 nt lds
    v_xor_b32 v1, 192, v12
    buffer_load_dwordx4 v1, s[12:15], s11 offen offset:2048 nt lds
    v_xor_b32 v1, 64, v12
    buffer_load_dwordx4 v1, s[12:15], s11 offen offset:3072 nt lds
L_kb3:
    s_cmp_lg_u32 s7, 3
    s_cbranch_scc1 L_vb3
    buffer_load_dwordx4 a[0:3], v13, s[16:19], s8 offen offset:0 nt
    buffer_load_dwordx4 a[4:7], v13, s[16:19], s8 offen offset:256 nt
    buffer_load_dwordx4 a[8:11], v13, s[16:19], s8 offen offset:512 nt
    buffer_load_dwordx4 a[12:15], v13, s[16:19], s8 offen offset:768 nt
    buffer_load_dwordx4 a[16:19], v13, s[16:19], s9 offen offset:0 nt
    buffer_load_dwordx4 a[20:23], v13, s[16:19], s9 offen offset:256 nt
    buffer_load_dwordx4 a[24:27], v13, s[16:19], s9 offen offset:512 nt
    buffer_load_dwordx4 a[28:31], v13, s[16:19], s9 offen offset:768 nt
    buffer_load_dwordx4 a[32:35], v13, s[16:19], s10 offen offset:0 nt
    buffer_load_dwordx4 a[36:39], v13, s[16:19], s10 offen offset:256 nt
    buffer_load_dwordx4 a[40:43], v13, s[16:19], s10 offen offset:512 nt
    buffer_load_dwordx4 a[44:47], v13, s[16:19], s10 offen offset:768 nt
    buffer_load_dwordx4 a[48:51], v13, s[16:19], s11 offen offset:0 nt
    buffer_load_dwordx4 a[52:55], v13, s[16:19], s11 offen offset:256 nt
    buffer_load_dwordx4 a[56:59], v13, s[16:19], s11 offen offset:512 nt
    buffer_load_dwordx4 a[60:63], v13, s[16:19], s11 offen offset:768 nt
L_vb3:
    v_mfma_f32_16x16x32_bf16 v[128:131], v[16:19], a[80:83], v[128:131]
    v_perm_b32 v24, v101, v97, s93
    v_perm_b32 v25, v109, v105, s93
    v_mfma_f32_16x16x32_bf16 v[160:163], v[16:19], a[84:87], v[160:163]
    v_xor_b32 v10, s90, v11
    v_mfma_f32_16x16x32_bf16 v[192:195], v[16:19], a[88:91], v[192:195]
    v_perm_b32 v26, v117, v113, s93
    v_perm_b32 v27, v125, v121, s93
    v_mfma_f32_16x16x32_bf16 v[224:227], v[16:19], a[92:95], v[224:227]
    ds_read_b128 a[64:67], v10 offset:0
    v_mfma_f32_16x16x32_bf16 v[132:135], v[20:23], a[80:83], v[132:135]
    v_perm_b32 v28, v101, v97, s94
    v_perm_b32 v29, v109, v105, s94
    v_mfma_f32_16x16x32_bf16 v[164:167], v[20:23], a[84:87], v[164:167]
    ds_read_b128 a[68:71], v10 offset:2048
    v_mfma_f32_16x16x32_bf16 v[196:199], v[20:23], a[88:91], v[196:199]
    v_perm_b32 v30, v117, v113, s94
    v_perm_b32 v31, v125, v121, s94
    v_mfma_f32_16x16x32_bf16 v[228:231], v[20:23], a[92:95], v[228:231]
    ds_read_b128 a[72:75], v10 offset:4096
    v_mfma_f32_16x16x32_bf16 v[136:139], v[24:27], a[80:83], v[136:139]
    v_perm_b32 v16, v102, v98, s93
    v_perm_b32 v17, v110, v106, s93
    v_mfma_f32_16x16x32_bf16 v[168:171], v[24:27], a[84:87], v[168:171]
    ds_read_b128 a[76:79], v10 offset:6144
    v_mfma_f32_16x16x32_bf16 v[200:203], v[24:27], a[88:91], v[200:203]
    v_perm_b32 v18, v118, v114, s93
    v_perm_b32 v19, v126, v122, s93
    v_mfma_f32_16x16x32_bf16 v[232:235], v[24:27], a[92:95], v[232:235]
    buffer_load_dwordx4 v[84:87], v7, s[20:23], s51 offen
    v_mfma_f32_16x16x32_bf16 v[140:143], v[28:31], a[80:83], v[140:143]
    v_perm_b32 v20, v102, v98, s94
    v_perm_b32 v21, v110, v106, s94
    v_mfma_f32_16x16x32_bf16 v[172:175], v[28:31], a[84:87], v[172:175]
    buffer_load_dwordx4 v[88:91], v8, s[20:23], s51 offen
    v_mfma_f32_16x16x32_bf16 v[204:207], v[28:31], a[88:91], v[204:207]
    v_perm_b32 v22, v118, v114, s94
    v_perm_b32 v23, v126, v122, s94
    v_mfma_f32_16x16x32_bf16 v[236:239], v[28:31], a[92:95], v[236:239]
    buffer_load_dwordx4 v[92:95], v9, s[20:23], s51 offen
    v_mfma_f32_16x16x32_bf16 v[144:147], v[16:19], a[80:83], v[144:147]
    v_perm_b32 v24, v103, v99, s93
    v_perm_b32 v25, v111, v107, s93
    v_mfma_f32_16x16x32_bf16 v[176:179], v[16:19], a[84:87], v[176:179]
    v_mfma_f32_16x16x32_bf16 v[208:211], v[16:19], a[88:91], v[208:211]
    v_perm_b32 v26, v119, v115, s93
    v_perm_b32 v27, v127, v123, s93
    v_mfma_f32_16x16x32_bf16 v[240:243], v[16:19], a[92:95], v[240:243]
    s_waitcnt lgkmcnt(0)
    v_mfma_f32_16x16x32_bf16 v[148:151], v[20:23], a[80:83], v[148:151]
    v_perm_b32 v28, v103, v99, s94
    v_perm_b32 v29, v111, v107, s94
    v_mfma_f32_16x16x32_bf16 v[180:183], v[20:23], a[84:87], v[180:183]
    s_cmp_eq_u32 s7, 3
    s_cbranch_scc1 L_w4
    s_waitcnt vmcnt(8)
L_w4:
    s_waitcnt vmcnt(40)
    v_mfma_f32_16x16x32_bf16 v[212:215], v[20:23], a[88:91], v[212:215]
    v_perm_b32 v30, v119, v115, s94
    v_perm_b32 v31, v127, v123, s94
    v_mfma_f32_16x16x32_bf16 v[244:247], v[20:23], a[92:95], v[244:247]
    buffer_load_dwordx4 v[96:99], v14, s[24:27], s52 offen offset:0
    v_mfma_f32_16x16x32_bf16 v[152:155], v[24:27], a[80:83], v[152:155]
    v_perm_b32 v16, v36, v32, s93
    v_perm_b32 v17, v44, v40, s93
    v_mfma_f32_16x16x32_bf16 v[184:187], v[24:27], a[84:87], v[184:187]
    buffer_load_dwordx4 v[100:103], v14, s[24:27], s52 offen offset:1280
    v_mfma_f32_16x16x32_bf16 v[216:219], v[24:27], a[88:91], v[216:219]
    v_perm_b32 v18, v52, v48, s93
    v_perm_b32 v19, v60, v56, s93
    v_mfma_f32_16x16x32_bf16 v[248:251], v[24:27], a[92:95], v[248:251]
    buffer_load_dwordx4 v[104:107], v14, s[24:27], s52 offen offset:2560
    v_mfma_f32_16x16x32_bf16 v[156:159], v[28:31], a[80:83], v[156:159]
    v_perm_b32 v20, v36, v32, s94
    v_perm_b32 v21, v44, v40, s94
    v_mfma_f32_16x16x32_bf16 v[188:191], v[28:31], a[84:87], v[188:191]
    buffer_load_dwordx4 v[108:111], v14, s[24:27], s52 offen offset:3840
    v_mfma_f32_16x16x32_bf16 v[220:223], v[28:31], a[88:91], v[220:223]
    v_perm_b32 v22, v52, v48, s94
    v_perm_b32 v23, v60, v56, s94
    v_mfma_f32_16x16x32_bf16 v[252:255], v[28:31], a[92:95], v[252:255]
    buffer_load_dwordx4 v[112:115], v15, s[24:27], s52 offen offset:0
    v_mfma_f32_16x16x32_bf16 v[128:131], v[16:19], a[64:67], v[128:131]
    v_perm_b32 v24, v37, v33, s93
    v_perm_b32 v25, v45, v41, s93
    v_mfma_f32_16x16x32_bf16 v[160:163], v[16:19], a[68:71], v[160:163]
    v_xor_b32 v10, s91, v11
    v_mfma_f32_16x16x32_bf16 v[192:195], v[16:19], a[72:75], v[192:195]
    v_perm_b32 v26, v53, v49, s93
    v_perm_b32 v27, v61, v57, s93
    v_mfma_f32_16x16x32_bf16 v[224:227], v[16:19], a[76:79], v[224:227]
    ds_read_b128 a[80:83], v10 offset:0
    v_mfma_f32_16x16x32_bf16 v[132:135], v[20:23], a[64:67], v[132:135]
    v_perm_b32 v28, v37, v33, s94
    v_perm_b32 v29, v45, v41, s94
    v_mfma_f32_16x16x32_bf16 v[164:167], v[20:23], a[68:71], v[164:167]
    ds_read_b128 a[84:87], v10 offset:2048
    v_mfma_f32_16x16x32_bf16 v[196:199], v[20:23], a[72:75], v[196:199]
    v_perm_b32 v30, v53, v49, s94
    v_perm_b32 v31, v61, v57, s94
    v_mfma_f32_16x16x32_bf16 v[228:231], v[20:23], a[76:79], v[228:231]
    ds_read_b128 a[88:91], v10 offset:4096
    v_mfma_f32_16x16x32_bf16 v[136:139], v[24:27], a[64:67], v[136:139]
    v_perm_b32 v16, v38, v34, s93
    v_perm_b32 v17, v46, v42, s93
    v_mfma_f32_16x16x32_bf16 v[168:171], v[24:27], a[68:71], v[168:171]
    ds_read_b128 a[92:95], v10 offset:6144
    v_mfma_f32_16x16x32_bf16 v[200:203], v[24:27], a[72:75], v[200:203]
    v_perm_b32 v18, v54, v50, s93
    v_perm_b32 v19, v62, v58, s93
    v_mfma_f32_16x16x32_bf16 v[232:235], v[24:27], a[76:79], v[232:235]
    buffer_load_dwordx4 v[116:119], v15, s[24:27], s52 offen offset:1280
    v_mfma_f32_16x16x32_bf16 v[140:143], v[28:31], a[64:67], v[140:143]
    v_perm_b32 v20, v38, v34, s94
    v_perm_b32 v21, v46, v42, s94
    v_mfma_f32_16x16x32_bf16 v[172:175], v[28:31], a[68:71], v[172:175]
    buffer_load_dwordx4 v[120:123], v15, s[24:27], s52 offen offset:2560
    v_mfma_f32_16x16x32_bf16 v[204:207], v[28:31], a[72:75], v[204:207]
    v_perm_b32 v22, v54, v50, s94
    v_perm_b32 v23, v62, v58, s94
    v_mfma_f32_16x16x32_bf16 v[236:239], v[28:31], a[76:79], v[236:239]
    buffer_load_dwordx4 v[124:127], v15, s[24:27], s52 offen offset:3840
    v_mfma_f32_16x16x32_bf16 v[144:147], v[16:19], a[64:67], v[144:147]
    v_perm_b32 v24, v39, v35, s93
    v_perm_b32 v25, v47, v43, s93
    v_mfma_f32_16x16x32_bf16 v[176:179], v[16:19], a[68:71], v[176:179]
    v_mfma_f32_16x16x32_bf16 v[208:211], v[16:19], a[72:75], v[208:211]
    v_perm_b32 v26, v55, v51, s93
    v_perm_b32 v27, v63, v59, s93
    v_mfma_f32_16x16x32_bf16 v[240:243], v[16:19], a[76:79], v[240:243]
    s_waitcnt lgkmcnt(0)
    v_mfma_f32_16x16x32_bf16 v[148:151], v[20:23], a[64:67], v[148:151]
    v_perm_b32 v28, v39, v35, s94
    v_perm_b32 v29, v47, v43, s94
    v_mfma_f32_16x16x32_bf16 v[180:183], v[20:23], a[68:71], v[180:183]
    s_waitcnt vmcnt(8)
    v_mfma_f32_16x16x32_bf16 v[212:215], v[20:23], a[72:75], v[212:215]
    v_perm_b32 v30, v55, v51, s94
    v_perm_b32 v31, v63, v59, s94
    v_mfma_f32_16x16x32_bf16 v[244:247], v[20:23], a[76:79], v[244:247]
    v_mfma_f32_16x16x32_bf16 v[152:155], v[24:27], a[64:67], v[152:155]
    v_perm_b32 v16, v68, v64, s93
    v_perm_b32 v17, v76, v72, s93
    v_mfma_f32_16x16x32_bf16 v[184:187], v[24:27], a[68:71], v[184:187]
    v_mfma_f32_16x16x32_bf16 v[216:219], v[24:27], a[72:75], v[216:219]
    v_perm_b32 v18, v84, v80, s93
    v_perm_b32 v19, v92, v88, s93
    v_mfma_f32_16x16x32_bf16 v[248:251], v[24:27], a[76:79], v[248:251]
    v_mfma_f32_16x16x32_bf16 v[156:159], v[28:31], a[64:67], v[156:159]
    v_perm_b32 v20, v68, v64, s94
    v_perm_b32 v21, v76, v72, s94
    v_mfma_f32_16x16x32_bf16 v[188:191], v[28:31], a[68:71], v[188:191]
    v_mfma_f32_16x16x32_bf16 v[220:223], v[28:31], a[72:75], v[220:223]
    v_perm_b32 v22, v84, v80, s94
    v_perm_b32 v23, v92, v88, s94
    v_mfma_f32_16x16x32_bf16 v[252:255], v[28:31], a[76:79], v[252:255]
    v_mfma_f32_16x16x32_bf16 v[128:131], v[16:19], a[80:83], v[128:131]
    v_perm_b32 v24, v69, v65, s93
    v_perm_b32 v25, v77, v73, s93
    v_mfma_f32_16x16x32_bf16 v[160:163], v[16:19], a[84:87], v[160:163]
    v_mfma_f32_16x16x32_bf16 v[192:195], v[16:19], a[88:91], v[192:195]
    v_perm_b32 v26, v85, v81, s93
    v_perm_b32 v27, v93, v89, s93
    v_mfma_f32_16x16x32_bf16 v[224:227], v[16:19], a[92:95], v[224:227]
    v_mfma_f32_16x16x32_bf16 v[132:135], v[20:23], a[80:83], v[132:135]
    v_perm_b32 v28, v69, v65, s94
    v_perm_b32 v29, v77, v73, s94
    v_mfma_f32_16x16x32_bf16 v[164:167], v[20:23], a[84:87], v[164:167]
    v_mfma_f32_16x16x32_bf16 v[196:199], v[20:23], a[88:91], v[196:199]
    v_perm_b32 v30, v85, v81, s94
    v_perm_b32 v31, v93, v89, s94
    v_mfma_f32_16x16x32_bf16 v[228:231], v[20:23], a[92:95], v[228:231]
    v_mfma_f32_16x16x32_bf16 v[136:139], v[24:27], a[80:83], v[136:139]
    v_perm_b32 v16, v70, v66, s93
    v_perm_b32 v17, v78, v74, s93
    v_mfma_f32_16x16x32_bf16 v[168:171], v[24:27], a[84:87], v[168:171]
    v_mfma_f32_16x16x32_bf16 v[200:203], v[24:27], a[88:91], v[200:203]
    v_perm_b32 v18, v86, v82, s93
    v_perm_b32 v19, v94, v90, s93
    v_mfma_f32_16x16x32_bf16 v[232:235], v[24:27], a[92:95], v[232:235]
    v_mfma_f32_16x16x32_bf16 v[140:143], v[28:31], a[80:83], v[140:143]
    v_perm_b32 v20, v70, v66, s94
    v_perm_b32 v21, v78, v74, s94
    v_mfma_f32_16x16x32_bf16 v[172:175], v[28:31], a[84:87], v[172:175]
    v_mfma_f32_16x16x32_bf16 v[204:207], v[28:31], a[88:91], v[204:207]
    v_perm_b32 v22, v86, v82, s94
    v_perm_b32 v23, v94, v90, s94
    v_mfma_f32_16x16x32_bf16 v[236:239], v[28:31], a[92:95], v[236:239]
    v_mfma_f32_16x16x32_bf16 v[144:147], v[16:19], a[80:83], v[144:147]
    v_perm_b32 v24, v71, v67, s93
    v_perm_b32 v25, v79, v75, s93
    v_mfma_f32_16x16x32_bf16 v[176:179], v[16:19], a[84:87], v[176:179]
    v_mfma_f32_16x16x32_bf16 v[208:211], v[16:19], a[88:91], v[208:211]
    v_perm_b32 v26, v87, v83, s93
    v_perm_b32 v27, v95, v91, s93
    v_mfma_f32_16x16x32_bf16 v[240:243], v[16:19], a[92:95], v[240:243]
    v_mfma_f32_16x16x32_bf16 v[148:151], v[20:23], a[80:83], v[148:151]
    v_perm_b32 v28, v71, v67, s94
    v_perm_b32 v29, v79, v75, s94
    v_mfma_f32_16x16x32_bf16 v[180:183], v[20:23], a[84:87], v[180:183]
    v_mfma_f32_16x16x32_bf16 v[212:215], v[20:23], a[88:91], v[212:215]
    v_perm_b32 v30, v87, v83, s94
    v_perm_b32 v31, v95, v91, s94
    v_mfma_f32_16x16x32_bf16 v[244:247], v[20:23], a[92:95], v[244:247]
    v_mfma_f32_16x16x32_bf16 v[152:155], v[24:27], a[80:83], v[152:155]
    v_mfma_f32_16x16x32_bf16 v[184:187], v[24:27], a[84:87], v[184:187]
    v_mfma_f32_16x16x32_bf16 v[216:219], v[24:27], a[88:91], v[216:219]
    v_mfma_f32_16x16x32_bf16 v[248:251], v[24:27], a[92:95], v[248:251]
    v_mfma_f32_16x16x32_bf16 v[156:159], v[28:31], a[80:83], v[156:159]
    v_mfma_f32_16x16x32_bf16 v[188:191], v[28:31], a[84:87], v[188:191]
    v_mfma_f32_16x16x32_bf16 v[220:223], v[28:31], a[88:91], v[220:223]
    v_mfma_f32_16x16x32_bf16 v[252:255], v[28:31], a[92:95], v[252:255]
    s_load_dwordx2 s[12:13], s[0:1], 80
    s_load_dwordx2 s[16:17], s[0:1], 88
    s_mov_b32 s14, 2621440
    s_mov_b32 s18, 256
    s_movk_i32 s95, 0x78
    v_lshrrev_b32 v7, 10, v13
    v_bfe_u32 v6, v13, 4, 4
    v_lshrrev_b32 v8, 2, v6
    v_lshlrev_b32 v8, 1, v8
    v_lshrrev_b32 v8, v8, s95
    v_xor_b32 v8, v8, v7
    v_and_b32 v8, 3, v8
    v_lshlrev_b32 v8, 2, v8
    v_and_or_b32 v8, v6, 3, v8
    v_lshlrev_b32 v8, 4, v8
    v_lshl_add_u32 v8, v6, 8, v8
    v_add_u32 v2, s96, v8
    v_xor_b32 v3, 16, v2
    v_xor_b32 v4, 32, v2
    v_xor_b32 v5, 48, v2
    v_lshlrev_b32 v11, 8, v7
    v_lshl_add_u32 v11, v6, 4, v11
    s_mul_i32 s6, s4, 10240
    s_add_u32 s6, s6, s68
    v_mul_u32_u24 v1, 1024, v7
    v_add_u32 v1, v1, v11
    buffer_load_dwordx4 a[240:243], v1, s[24:27], s6 offen
    s_add_u32 s6, s6, 5120
    buffer_load_dwordx4 a[244:247], v1, s[24:27], s6 offen
    s_waitcnt lgkmcnt(0)
    ds_read_b128 a[128:131], v2 offset:0
    ds_read_b128 a[132:135], v3 offset:0
    ds_read_b128 a[136:139], v4 offset:0
    ds_read_b128 a[140:143], v5 offset:0
    ds_read_b128 a[144:147], v2 offset:4096
    ds_read_b128 a[148:151], v3 offset:4096
    ds_read_b128 a[152:155], v4 offset:4096
    ds_read_b128 a[156:159], v5 offset:4096
    v_cvt_pk_bf16_f32 v16, v128, v132
    v_cvt_pk_bf16_f32 v20, v129, v133
    v_cvt_pk_bf16_f32 v24, v130, v134
    v_cvt_pk_bf16_f32 v28, v131, v135
    v_cvt_pk_bf16_f32 v17, v136, v140
    v_cvt_pk_bf16_f32 v21, v137, v141
    v_cvt_pk_bf16_f32 v25, v138, v142
    v_cvt_pk_bf16_f32 v29, v139, v143
    v_cvt_pk_bf16_f32 v18, v144, v148
    v_cvt_pk_bf16_f32 v22, v145, v149
    v_cvt_pk_bf16_f32 v26, v146, v150
    v_cvt_pk_bf16_f32 v30, v147, v151
    v_cvt_pk_bf16_f32 v19, v152, v156
    v_cvt_pk_bf16_f32 v23, v153, v157
    v_cvt_pk_bf16_f32 v27, v154, v158
    v_cvt_pk_bf16_f32 v31, v155, v159
    s_waitcnt lgkmcnt(4)
    ds_read_b128 a[160:163], v2 offset:8192
    ds_read_b128 a[164:167], v3 offset:8192
    ds_read_b128 a[168:171], v4 offset:8192
    ds_read_b128 a[172:175], v5 offset:8192
    ds_read_b128 a[176:179], v2 offset:12288
    ds_read_b128 a[180:183], v3 offset:12288
    ds_read_b128 a[184:187], v4 offset:12288
    ds_read_b128 a[188:191], v5 offset:12288
    v_cvt_pk_bf16_f32 v128, v160, v164
    v_cvt_pk_bf16_f32 v132, v161, v165
    v_cvt_pk_bf16_f32 v136, v162, v166
    v_cvt_pk_bf16_f32 v140, v163, v167
    v_cvt_pk_bf16_f32 v129, v168, v172
    v_cvt_pk_bf16_f32 v133, v169, v173
    v_cvt_pk_bf16_f32 v137, v170, v174
    v_cvt_pk_bf16_f32 v141, v171, v175
    v_cvt_pk_bf16_f32 v130, v176, v180
    v_cvt_pk_bf16_f32 v134, v177, v181
    v_cvt_pk_bf16_f32 v138, v178, v182
    v_cvt_pk_bf16_f32 v142, v179, v183
    v_cvt_pk_bf16_f32 v131, v184, v188
    v_cvt_pk_bf16_f32 v135, v185, v189
    v_cvt_pk_bf16_f32 v139, v186, v190
    v_cvt_pk_bf16_f32 v143, v187, v191
    s_waitcnt lgkmcnt(8)
    s_nop 1
    v_mfma_f32_16x16x32_bf16 v[176:179], a[128:131], v[16:19], 0
    v_cvt_pk_bf16_f32 v144, v192, v196
    v_cvt_pk_bf16_f32 v148, v193, v197
    v_mfma_f32_16x16x32_bf16 v[180:183], a[128:131], v[128:131], 0
    v_cvt_pk_bf16_f32 v152, v194, v198
    v_cvt_pk_bf16_f32 v156, v195, v199
    v_mfma_f32_16x16x32_bf16 v[184:187], a[144:147], v[16:19], 0
    v_cvt_pk_bf16_f32 v145, v200, v204
    v_cvt_pk_bf16_f32 v149, v201, v205
    v_mfma_f32_16x16x32_bf16 v[188:191], a[144:147], v[128:131], 0
    v_cvt_pk_bf16_f32 v153, v202, v206
    v_cvt_pk_bf16_f32 v157, v203, v207
    v_mfma_f32_16x16x32_bf16 v[176:179], a[132:135], v[20:23], v[176:179]
    v_cvt_pk_bf16_f32 v146, v208, v212
    v_cvt_pk_bf16_f32 v150, v209, v213
    v_mfma_f32_16x16x32_bf16 v[180:183], a[132:135], v[132:135], v[180:183]
    v_cvt_pk_bf16_f32 v154, v210, v214
    v_cvt_pk_bf16_f32 v158, v211, v215
    v_mfma_f32_16x16x32_bf16 v[184:187], a[148:151], v[20:23], v[184:187]
    v_cvt_pk_bf16_f32 v147, v216, v220
    v_cvt_pk_bf16_f32 v151, v217, v221
    v_mfma_f32_16x16x32_bf16 v[188:191], a[148:151], v[132:135], v[188:191]
    v_cvt_pk_bf16_f32 v155, v218, v222
    v_cvt_pk_bf16_f32 v159, v219, v223
    v_mfma_f32_16x16x32_bf16 v[176:179], a[136:139], v[24:27], v[176:179]
    v_cvt_pk_bf16_f32 v160, v224, v228
    v_cvt_pk_bf16_f32 v164, v225, v229
    v_mfma_f32_16x16x32_bf16 v[180:183], a[136:139], v[136:139], v[180:183]
    v_cvt_pk_bf16_f32 v168, v226, v230
    v_cvt_pk_bf16_f32 v172, v227, v231
    v_mfma_f32_16x16x32_bf16 v[184:187], a[152:155], v[24:27], v[184:187]
    v_cvt_pk_bf16_f32 v161, v232, v236
    v_cvt_pk_bf16_f32 v165, v233, v237
    v_mfma_f32_16x16x32_bf16 v[188:191], a[152:155], v[136:139], v[188:191]
    v_cvt_pk_bf16_f32 v169, v234, v238
    v_cvt_pk_bf16_f32 v173, v235, v239
    v_mfma_f32_16x16x32_bf16 v[176:179], a[140:143], v[28:31], v[176:179]
    v_cvt_pk_bf16_f32 v162, v240, v244
    v_cvt_pk_bf16_f32 v166, v241, v245
    v_mfma_f32_16x16x32_bf16 v[180:183], a[140:143], v[140:143], v[180:183]
    v_cvt_pk_bf16_f32 v170, v242, v246
    v_cvt_pk_bf16_f32 v174, v243, v247
    v_mfma_f32_16x16x32_bf16 v[184:187], a[156:159], v[28:31], v[184:187]
    v_cvt_pk_bf16_f32 v163, v248, v252
    v_cvt_pk_bf16_f32 v167, v249, v253
    v_mfma_f32_16x16x32_bf16 v[188:191], a[156:159], v[140:143], v[188:191]
    v_cvt_pk_bf16_f32 v171, v250, v254
    v_cvt_pk_bf16_f32 v175, v251, v255
    s_waitcnt lgkmcnt(0)
    s_nop 1
    v_mfma_f32_16x16x32_bf16 v[192:195], a[160:163], v[144:147], 0
    v_mfma_f32_16x16x32_bf16 v[196:199], a[160:163], v[160:163], 0
    v_mfma_f32_16x16x32_bf16 v[200:203], a[176:179], v[144:147], 0
    v_mfma_f32_16x16x32_bf16 v[204:207], a[176:179], v[160:163], 0
    v_mfma_f32_16x16x32_bf16 v[192:195], a[164:167], v[148:151], v[192:195]
    v_max3_f32 v224, v176, v177, v178
    v_max3_f32 v225, v179, v184, v185
    v_mfma_f32_16x16x32_bf16 v[196:199], a[164:167], v[164:167], v[196:199]
    v_max3_f32 v224, v224, v186, v187
    v_max_f32 v224, v224, v225
    v_mfma_f32_16x16x32_bf16 v[200:203], a[180:183], v[148:151], v[200:203]
    v_mov_b32 v225, v224
    v_max3_f32 v228, v180, v181, v182
    v_mfma_f32_16x16x32_bf16 v[204:207], a[180:183], v[164:167], v[204:207]
    v_max3_f32 v229, v183, v188, v189
    v_max3_f32 v228, v228, v190, v191
    v_mfma_f32_16x16x32_bf16 v[192:195], a[168:171], v[152:155], v[192:195]
    v_max_f32 v228, v228, v229
    v_mov_b32 v229, v228
    v_mfma_f32_16x16x32_bf16 v[196:199], a[168:171], v[168:171], v[196:199]
    s_nop 1
    v_permlane32_swap_b32 v224, v225
    v_mfma_f32_16x16x32_bf16 v[200:203], a[184:187], v[152:155], v[200:203]
    v_permlane32_swap_b32 v228, v229
    s_nop 0
    v_mfma_f32_16x16x32_bf16 v[204:207], a[184:187], v[168:171], v[204:207]
    v_max_f32 v224, v224, v225
    v_mov_b32 v225, v224
    v_mfma_f32_16x16x32_bf16 v[192:195], a[172:175], v[156:159], v[192:195]
    v_max_f32 v228, v228, v229
    v_mov_b32 v229, v228
    v_mfma_f32_16x16x32_bf16 v[196:199], a[172:175], v[172:175], v[196:199]
    s_nop 1
    v_permlane16_swap_b32 v224, v225
    v_mfma_f32_16x16x32_bf16 v[200:203], a[188:191], v[156:159], v[200:203]
    v_permlane16_swap_b32 v228, v229
    s_nop 0
    v_mfma_f32_16x16x32_bf16 v[204:207], a[188:191], v[172:175], v[204:207]
    v_max_f32 v224, v224, v225
    v_mul_f32 v224, s97, v224
    v_fma_f32 v176, v176, s97, -v224
    v_fma_f32 v177, v177, s97, -v224
    v_fma_f32 v178, v178, s97, -v224
    v_fma_f32 v179, v179, s97, -v224
    v_fma_f32 v184, v184, s97, -v224
    v_fma_f32 v185, v185, s97, -v224
    v_fma_f32 v186, v186, s97, -v224
    v_fma_f32 v187, v187, s97, -v224
    v_exp_f32 v176, v176
    v_exp_f32 v177, v177
    v_exp_f32 v178, v178
    v_exp_f32 v179, v179
    v_exp_f32 v184, v184
    v_exp_f32 v185, v185
    v_exp_f32 v186, v186
    v_exp_f32 v187, v187
    v_max_f32 v228, v228, v229
    v_mul_f32 v228, s97, v228
    v_fma_f32 v180, v180, s97, -v228
    v_fma_f32 v181, v181, s97, -v228
    v_fma_f32 v182, v182, s97, -v228
    v_fma_f32 v183, v183, s97, -v228
    v_fma_f32 v188, v188, s97, -v228
    v_fma_f32 v189, v189, s97, -v228
    v_fma_f32 v190, v190, s97, -v228
    v_fma_f32 v191, v191, s97, -v228
    v_exp_f32 v180, v180
    v_exp_f32 v181, v181
    v_exp_f32 v182, v182
    v_exp_f32 v183, v183
    v_exp_f32 v188, v188
    v_exp_f32 v189, v189
    v_exp_f32 v190, v190
    v_exp_f32 v191, v191
    v_add_f32 v224, v176, v177
    v_add_f32 v225, v178, v179
    v_add_f32 v224, v224, v184
    v_add_f32 v225, v225, v185
    v_add_f32 v224, v224, v186
    v_add_f32 v225, v225, v187
    v_add_f32 v224, v224, v225
    v_mov_b32 v225, v224
    v_add_f32 v228, v180, v181
    v_add_f32 v229, v182, v183
    v_add_f32 v228, v228, v188
    v_add_f32 v229, v229, v189
    v_add_f32 v228, v228, v190
    v_add_f32 v229, v229, v191
    v_add_f32 v228, v228, v229
    v_mov_b32 v229, v228
    s_nop 1
    v_permlane32_swap_b32 v224, v225
    v_permlane32_swap_b32 v228, v229
    s_nop 0
    v_add_f32 v224, v224, v225
    v_mov_b32 v225, v224
    v_add_f32 v228, v228, v229
    v_mov_b32 v229, v228
    s_nop 1
    v_permlane16_swap_b32 v224, v225
    v_permlane16_swap_b32 v228, v229
    s_nop 0
    v_add_f32 v224, v224, v225
    v_add_f32 v228, v228, v229
    v_rcp_f32 v224, v224
    v_rcp_f32 v228, v228
    s_nop 0
    v_mul_f32 v176, v176, v224
    v_mul_f32 v177, v177, v224
    v_mul_f32 v178, v178, v224
    v_mul_f32 v179, v179, v224
    v_mul_f32 v184, v184, v224
    v_mul_f32 v185, v185, v224
    v_mul_f32 v186, v186, v224
    v_mul_f32 v187, v187, v224
    v_mul_f32 v180, v180, v228
    v_mul_f32 v181, v181, v228
    v_mul_f32 v182, v182, v228
    v_mul_f32 v183, v183, v228
    v_mul_f32 v188, v188, v228
    v_mul_f32 v189, v189, v228
    v_mul_f32 v190, v190, v228
    v_mul_f32 v191, v191, v228
    v_cvt_pk_bf16_f32 v208, v176, v177
    v_cvt_pk_bf16_f32 v209, v178, v179
    v_cvt_pk_bf16_f32 v210, v184, v185
    v_cvt_pk_bf16_f32 v211, v186, v187
    v_cvt_pk_bf16_f32 v212, v180, v181
    v_cvt_pk_bf16_f32 v213, v182, v183
    v_cvt_pk_bf16_f32 v214, v188, v189
    v_cvt_pk_bf16_f32 v215, v190, v191
    v_max3_f32 v232, v192, v193, v194
    v_max3_f32 v233, v195, v200, v201
    v_max3_f32 v232, v232, v202, v203
    v_max_f32 v232, v232, v233
    v_mov_b32 v233, v232
    v_max3_f32 v236, v196, v197, v198
    v_max3_f32 v237, v199, v204, v205
    v_max3_f32 v236, v236, v206, v207
    v_max_f32 v236, v236, v237
    v_mov_b32 v237, v236
    s_nop 1
    v_permlane32_swap_b32 v232, v233
    v_permlane32_swap_b32 v236, v237
    s_nop 0
    v_max_f32 v232, v232, v233
    v_mov_b32 v233, v232
    v_max_f32 v236, v236, v237
    v_mov_b32 v237, v236
    s_nop 1
    v_permlane16_swap_b32 v232, v233
    v_permlane16_swap_b32 v236, v237
    s_nop 0
    v_max_f32 v232, v232, v233
    v_mul_f32 v232, s97, v232
    v_fma_f32 v192, v192, s97, -v232
    v_fma_f32 v193, v193, s97, -v232
    v_fma_f32 v194, v194, s97, -v232
    v_fma_f32 v195, v195, s97, -v232
    v_fma_f32 v200, v200, s97, -v232
    v_fma_f32 v201, v201, s97, -v232
    v_fma_f32 v202, v202, s97, -v232
    v_fma_f32 v203, v203, s97, -v232
    v_exp_f32 v192, v192
    v_exp_f32 v193, v193
    v_exp_f32 v194, v194
    v_exp_f32 v195, v195
    v_exp_f32 v200, v200
    v_exp_f32 v201, v201
    v_exp_f32 v202, v202
    v_exp_f32 v203, v203
    v_max_f32 v236, v236, v237
    v_mul_f32 v236, s97, v236
    v_fma_f32 v196, v196, s97, -v236
    v_fma_f32 v197, v197, s97, -v236
    v_fma_f32 v198, v198, s97, -v236
    v_fma_f32 v199, v199, s97, -v236
    v_fma_f32 v204, v204, s97, -v236
    v_fma_f32 v205, v205, s97, -v236
    v_fma_f32 v206, v206, s97, -v236
    v_fma_f32 v207, v207, s97, -v236
    v_exp_f32 v196, v196
    v_exp_f32 v197, v197
    v_exp_f32 v198, v198
    v_exp_f32 v199, v199
    v_exp_f32 v204, v204
    v_exp_f32 v205, v205
    v_exp_f32 v206, v206
    v_exp_f32 v207, v207
    v_add_f32 v232, v192, v193
    v_add_f32 v233, v194, v195
    v_add_f32 v232, v232, v200
    v_add_f32 v233, v233, v201
    v_add_f32 v232, v232, v202
    v_add_f32 v233, v233, v203
    v_add_f32 v232, v232, v233
    v_mov_b32 v233, v232
    v_add_f32 v236, v196, v197
    v_add_f32 v237, v198, v199
    v_add_f32 v236, v236, v204
    v_add_f32 v237, v237, v205
    v_add_f32 v236, v236, v206
    v_add_f32 v237, v237, v207
    v_add_f32 v236, v236, v237
    v_mov_b32 v237, v236
    s_nop 1
    v_permlane32_swap_b32 v232, v233
    v_permlane32_swap_b32 v236, v237
    s_nop 0
    v_add_f32 v232, v232, v233
    v_mov_b32 v233, v232
    v_add_f32 v236, v236, v237
    v_mov_b32 v237, v236
    s_nop 1
    v_permlane16_swap_b32 v232, v233
    v_permlane16_swap_b32 v236, v237
    s_nop 0
    v_add_f32 v232, v232, v233
    v_add_f32 v236, v236, v237
    v_rcp_f32 v232, v232
    v_rcp_f32 v236, v236
    s_nop 0
    v_mul_f32 v192, v192, v232
    v_mul_f32 v193, v193, v232
    v_mul_f32 v194, v194, v232
    v_mul_f32 v195, v195, v232
    v_mul_f32 v200, v200, v232
    v_mul_f32 v201, v201, v232
    v_mul_f32 v202, v202, v232
    v_mul_f32 v203, v203, v232
    v_mul_f32 v196, v196, v236
    v_mul_f32 v197, v197, v236
    v_mul_f32 v198, v198, v236
    v_mul_f32 v199, v199, v236
    v_mul_f32 v204, v204, v236
    v_mul_f32 v205, v205, v236
    v_mul_f32 v206, v206, v236
    v_mul_f32 v207, v207, v236
    v_cvt_pk_bf16_f32 v216, v192, v193
    v_cvt_pk_bf16_f32 v217, v194, v195
    v_cvt_pk_bf16_f32 v218, v200, v201
    v_cvt_pk_bf16_f32 v219, v202, v203
    v_cvt_pk_bf16_f32 v220, v196, v197
    v_cvt_pk_bf16_f32 v221, v198, v199
    v_cvt_pk_bf16_f32 v222, v204, v205
    v_cvt_pk_bf16_f32 v223, v206, v207
    v_accvgpr_read_b32 v192, a0
    v_accvgpr_read_b32 v193, a4
    v_accvgpr_read_b32 v194, a8
    v_accvgpr_read_b32 v195, a12
    v_accvgpr_read_b32 v196, a16
    v_accvgpr_read_b32 v197, a20
    v_accvgpr_read_b32 v198, a24
    v_accvgpr_read_b32 v199, a28
    v_perm_b32 v16, v193, v192, s93
    v_perm_b32 v17, v195, v194, s93
    v_perm_b32 v18, v197, v196, s93
    v_perm_b32 v19, v199, v198, s93
    v_perm_b32 v20, v193, v192, s94
    v_perm_b32 v21, v195, v194, s94
    v_perm_b32 v22, v197, v196, s94
    v_perm_b32 v23, v199, v198, s94
    s_nop 1
    v_mfma_f32_16x16x32_bf16 v[128:131], v[16:19], v[208:211], 0
    v_accvgpr_read_b32 v192, a1
    v_accvgpr_read_b32 v193, a5
    v_accvgpr_read_b32 v194, a9
    v_accvgpr_read_b32 v195, a13
    buffer_load_dwordx4 v[32:35], v14, s[24:27], s53 offen offset:0
    v_mfma_f32_16x16x32_bf16 v[160:163], v[16:19], v[212:215], 0
    v_accvgpr_read_b32 v196, a17
    v_accvgpr_read_b32 v197, a21
    v_accvgpr_read_b32 v198, a25
    v_accvgpr_read_b32 v199, a29
    buffer_load_dwordx4 v[36:39], v14, s[24:27], s53 offen offset:1280
    v_mfma_f32_16x16x32_bf16 v[132:135], v[20:23], v[208:211], 0
    v_perm_b32 v24, v193, v192, s93
    v_perm_b32 v25, v195, v194, s93
    v_perm_b32 v26, v197, v196, s93
    v_perm_b32 v27, v199, v198, s93
    buffer_load_dwordx4 v[40:43], v14, s[24:27], s53 offen offset:2560
    v_mfma_f32_16x16x32_bf16 v[164:167], v[20:23], v[212:215], 0
    v_perm_b32 v28, v193, v192, s94
    v_perm_b32 v29, v195, v194, s94
    v_perm_b32 v30, v197, v196, s94
    v_perm_b32 v31, v199, v198, s94
    buffer_load_dwordx4 v[44:47], v14, s[24:27], s53 offen offset:3840
    s_nop 0
    v_mfma_f32_16x16x32_bf16 v[136:139], v[24:27], v[208:211], 0
    v_accvgpr_read_b32 v192, a2
    v_accvgpr_read_b32 v193, a6
    v_accvgpr_read_b32 v194, a10
    v_accvgpr_read_b32 v195, a14
    buffer_load_dwordx4 v[48:51], v15, s[24:27], s53 offen offset:0
    v_mfma_f32_16x16x32_bf16 v[168:171], v[24:27], v[212:215], 0
    v_accvgpr_read_b32 v196, a18
    v_accvgpr_read_b32 v197, a22
    v_accvgpr_read_b32 v198, a26
    v_accvgpr_read_b32 v199, a30
    buffer_load_dwordx4 v[52:55], v15, s[24:27], s53 offen offset:1280
    v_mfma_f32_16x16x32_bf16 v[140:143], v[28:31], v[208:211], 0
    v_perm_b32 v16, v193, v192, s93
    v_perm_b32 v17, v195, v194, s93
    v_perm_b32 v18, v197, v196, s93
    v_perm_b32 v19, v199, v198, s93
    buffer_load_dwordx4 v[56:59], v15, s[24:27], s53 offen offset:2560
    v_mfma_f32_16x16x32_bf16 v[172:175], v[28:31], v[212:215], 0
    v_perm_b32 v20, v193, v192, s94
    v_perm_b32 v21, v195, v194, s94
    v_perm_b32 v22, v197, v196, s94
    v_perm_b32 v23, v199, v198, s94
    buffer_load_dwordx4 v[60:63], v15, s[24:27], s53 offen offset:3840
    s_nop 0
    v_mfma_f32_16x16x32_bf16 v[144:147], v[16:19], v[208:211], 0
    v_accvgpr_read_b32 v192, a3
    v_accvgpr_read_b32 v193, a7
    v_accvgpr_read_b32 v194, a11
    v_accvgpr_read_b32 v195, a15
    buffer_load_dwordx4 v[64:67], v14, s[24:27], s54 offen offset:0
    v_mfma_f32_16x16x32_bf16 v[176:179], v[16:19], v[212:215], 0
    v_accvgpr_read_b32 v196, a19
    v_accvgpr_read_b32 v197, a23
    v_accvgpr_read_b32 v198, a27
    v_accvgpr_read_b32 v199, a31
    buffer_load_dwordx4 v[68:71], v14, s[24:27], s54 offen offset:1280
    v_mfma_f32_16x16x32_bf16 v[148:151], v[20:23], v[208:211], 0
    v_perm_b32 v24, v193, v192, s93
    v_perm_b32 v25, v195, v194, s93
    v_perm_b32 v26, v197, v196, s93
    v_perm_b32 v27, v199, v198, s93
    buffer_load_dwordx4 v[72:75], v14, s[24:27], s54 offen offset:2560
    v_mfma_f32_16x16x32_bf16 v[180:183], v[20:23], v[212:215], 0
    v_perm_b32 v28, v193, v192, s94
    v_perm_b32 v29, v195, v194, s94
    v_perm_b32 v30, v197, v196, s94
    v_perm_b32 v31, v199, v198, s94
    buffer_load_dwordx4 v[76:79], v14, s[24:27], s54 offen offset:3840
    s_nop 0
    v_mfma_f32_16x16x32_bf16 v[152:155], v[24:27], v[208:211], 0
    v_accvgpr_read_b32 v192, a32
    v_accvgpr_read_b32 v193, a36
    v_accvgpr_read_b32 v194, a40
    v_accvgpr_read_b32 v195, a44
    buffer_load_dwordx4 v[80:83], v15, s[24:27], s54 offen offset:0
    v_mfma_f32_16x16x32_bf16 v[184:187], v[24:27], v[212:215], 0
    v_accvgpr_read_b32 v196, a48
    v_accvgpr_read_b32 v197, a52
    v_accvgpr_read_b32 v198, a56
    v_accvgpr_read_b32 v199, a60
    buffer_load_dwordx4 v[84:87], v15, s[24:27], s54 offen offset:1280
    v_mfma_f32_16x16x32_bf16 v[156:159], v[28:31], v[208:211], 0
    v_perm_b32 v224, v193, v192, s93
    v_perm_b32 v225, v195, v194, s93
    v_perm_b32 v226, v197, v196, s93
    v_perm_b32 v227, v199, v198, s93
    buffer_load_dwordx4 v[88:91], v15, s[24:27], s54 offen offset:2560
    v_mfma_f32_16x16x32_bf16 v[188:191], v[28:31], v[212:215], 0
    v_perm_b32 v228, v193, v192, s94
    v_perm_b32 v229, v195, v194, s94
    v_perm_b32 v230, v197, v196, s94
    v_perm_b32 v231, v199, v198, s94
    buffer_load_dwordx4 v[92:95], v15, s[24:27], s54 offen offset:3840
    s_nop 0
    v_accvgpr_read_b32 v192, a33
    v_accvgpr_read_b32 v193, a37
    v_accvgpr_read_b32 v194, a41
    v_accvgpr_read_b32 v195, a45
    v_accvgpr_read_b32 v196, a49
    v_accvgpr_read_b32 v197, a53
    v_accvgpr_read_b32 v198, a57
    v_accvgpr_read_b32 v199, a61
    v_perm_b32 v232, v193, v192, s93
    v_perm_b32 v233, v195, v194, s93
    v_perm_b32 v234, v197, v196, s93
    v_perm_b32 v235, v199, v198, s93
    v_perm_b32 v236, v193, v192, s94
    v_perm_b32 v237, v195, v194, s94
    v_perm_b32 v238, v197, v196, s94
    v_perm_b32 v239, v199, v198, s94
    v_accvgpr_read_b32 v192, a34
    v_accvgpr_read_b32 v193, a38
    v_accvgpr_read_b32 v194, a42
    v_accvgpr_read_b32 v195, a46
    v_accvgpr_read_b32 v196, a50
    v_accvgpr_read_b32 v197, a54
    v_accvgpr_read_b32 v198, a58
    v_accvgpr_read_b32 v199, a62
    v_perm_b32 v240, v193, v192, s93
    v_perm_b32 v241, v195, v194, s93
    v_perm_b32 v242, v197, v196, s93
    v_perm_b32 v243, v199, v198, s93
    v_perm_b32 v244, v193, v192, s94
    v_perm_b32 v245, v195, v194, s94
    v_perm_b32 v246, v197, v196, s94
    v_perm_b32 v247, v199, v198, s94
    v_accvgpr_read_b32 v192, a35
    v_accvgpr_read_b32 v193, a39
    v_accvgpr_read_b32 v194, a43
    v_accvgpr_read_b32 v195, a47
    v_accvgpr_read_b32 v196, a51
    v_accvgpr_read_b32 v197, a55
    v_accvgpr_read_b32 v198, a59
    v_accvgpr_read_b32 v199, a63
    v_perm_b32 v248, v193, v192, s93
    v_perm_b32 v249, v195, v194, s93
    v_perm_b32 v250, v197, v196, s93
    v_perm_b32 v251, v199, v198, s93
    v_perm_b32 v252, v193, v192, s94
    v_perm_b32 v253, v195, v194, s94
    v_perm_b32 v254, v197, v196, s94
    v_perm_b32 v255, v199, v198, s94
    v_add_u32 v10, s96, v11
    v_cvt_pk_bf16_f32 v200, v128, v132
    v_cvt_pk_bf16_f32 v201, v136, v140
    v_cvt_pk_bf16_f32 v202, v144, v148
    v_cvt_pk_bf16_f32 v203, v152, v156
    ds_write_b128 v10, v[200:203] offset:0
    v_cvt_pk_bf16_f32 v204, v129, v133
    v_cvt_pk_bf16_f32 v205, v137, v141
    v_cvt_pk_bf16_f32 v206, v145, v149
    v_cvt_pk_bf16_f32 v207, v153, v157
    ds_write_b128 v10, v[204:207] offset:4096
    v_cvt_pk_bf16_f32 v200, v130, v134
    v_cvt_pk_bf16_f32 v201, v138, v142
    v_cvt_pk_bf16_f32 v202, v146, v150
    v_cvt_pk_bf16_f32 v203, v154, v158
    ds_write_b128 v10, v[200:203] offset:8192
    v_cvt_pk_bf16_f32 v204, v131, v135
    v_cvt_pk_bf16_f32 v205, v139, v143
    v_cvt_pk_bf16_f32 v206, v147, v151
    v_cvt_pk_bf16_f32 v207, v155, v159
    ds_write_b128 v10, v[204:207] offset:12288
    v_mfma_f32_16x16x32_bf16 v[128:131], v[224:227], v[216:219], 0
    v_cvt_pk_bf16_f32 v200, v160, v164
    v_cvt_pk_bf16_f32 v201, v168, v172
    v_cvt_pk_bf16_f32 v202, v176, v180
    v_mfma_f32_16x16x32_bf16 v[132:135], v[228:231], v[216:219], 0
    v_cvt_pk_bf16_f32 v203, v184, v188
    ds_write_b128 v10, v[200:203] offset:1024
    v_cvt_pk_bf16_f32 v204, v161, v165
    v_mfma_f32_16x16x32_bf16 v[136:139], v[232:235], v[216:219], 0
    v_cvt_pk_bf16_f32 v205, v169, v173
    v_cvt_pk_bf16_f32 v206, v177, v181
    v_cvt_pk_bf16_f32 v207, v185, v189
    v_mfma_f32_16x16x32_bf16 v[140:143], v[236:239], v[216:219], 0
    ds_write_b128 v10, v[204:207] offset:5120
    v_cvt_pk_bf16_f32 v200, v162, v166
    v_cvt_pk_bf16_f32 v201, v170, v174
    v_mfma_f32_16x16x32_bf16 v[144:147], v[240:243], v[216:219], 0
    v_cvt_pk_bf16_f32 v202, v178, v182
    v_cvt_pk_bf16_f32 v203, v186, v190
    ds_write_b128 v10, v[200:203] offset:9216
    v_mfma_f32_16x16x32_bf16 v[148:151], v[244:247], v[216:219], 0
    v_cvt_pk_bf16_f32 v204, v163, v167
    v_cvt_pk_bf16_f32 v205, v171, v175
    v_cvt_pk_bf16_f32 v206, v179, v183
    v_mfma_f32_16x16x32_bf16 v[152:155], v[248:251], v[216:219], 0
    v_cvt_pk_bf16_f32 v207, v187, v191
    ds_write_b128 v10, v[204:207] offset:13312
    v_mfma_f32_16x16x32_bf16 v[156:159], v[252:255], v[216:219], 0
    v_mfma_f32_16x16x32_bf16 v[160:163], v[224:227], v[220:223], 0
    v_mfma_f32_16x16x32_bf16 v[164:167], v[228:231], v[220:223], 0
    v_mfma_f32_16x16x32_bf16 v[168:171], v[232:235], v[220:223], 0
    v_mfma_f32_16x16x32_bf16 v[172:175], v[236:239], v[220:223], 0
    v_mfma_f32_16x16x32_bf16 v[176:179], v[240:243], v[220:223], 0
    v_mfma_f32_16x16x32_bf16 v[180:183], v[244:247], v[220:223], 0
    v_mfma_f32_16x16x32_bf16 v[184:187], v[248:251], v[220:223], 0
    v_mfma_f32_16x16x32_bf16 v[188:191], v[252:255], v[220:223], 0
    s_waitcnt lgkmcnt(4)
    v_cvt_pk_bf16_f32 v200, v128, v132
    v_cvt_pk_bf16_f32 v201, v136, v140
    v_cvt_pk_bf16_f32 v202, v144, v148
    v_cvt_pk_bf16_f32 v203, v152, v156
    ds_write_b128 v10, v[200:203] offset:2048
    v_cvt_pk_bf16_f32 v204, v129, v133
    v_cvt_pk_bf16_f32 v205, v137, v141
    v_cvt_pk_bf16_f32 v206, v145, v149
    v_cvt_pk_bf16_f32 v207, v153, v157
    ds_write_b128 v10, v[204:207] offset:6144
    v_cvt_pk_bf16_f32 v200, v130, v134
    v_cvt_pk_bf16_f32 v201, v138, v142
    v_cvt_pk_bf16_f32 v202, v146, v150
    v_cvt_pk_bf16_f32 v203, v154, v158
    ds_write_b128 v10, v[200:203] offset:10240
    v_cvt_pk_bf16_f32 v204, v131, v135
    v_cvt_pk_bf16_f32 v205, v139, v143
    v_cvt_pk_bf16_f32 v206, v147, v151
    v_cvt_pk_bf16_f32 v207, v155, v159
    ds_write_b128 v10, v[204:207] offset:14336
    v_cvt_pk_bf16_f32 v200, v160, v164
    v_cvt_pk_bf16_f32 v201, v168, v172
    v_cvt_pk_bf16_f32 v202, v176, v180
    v_cvt_pk_bf16_f32 v203, v184, v188
    ds_write_b128 v10, v[200:203] offset:3072
    v_cvt_pk_bf16_f32 v204, v161, v165
    v_cvt_pk_bf16_f32 v205, v169, v173
    v_cvt_pk_bf16_f32 v206, v177, v181
    v_cvt_pk_bf16_f32 v207, v185, v189
    ds_write_b128 v10, v[204:207] offset:7168
    v_cvt_pk_bf16_f32 v200, v162, v166
    v_cvt_pk_bf16_f32 v201, v170, v174
    v_cvt_pk_bf16_f32 v202, v178, v182
    v_cvt_pk_bf16_f32 v203, v186, v190
    ds_write_b128 v10, v[200:203] offset:11264
    v_cvt_pk_bf16_f32 v204, v163, v167
    v_cvt_pk_bf16_f32 v205, v171, v175
    v_cvt_pk_bf16_f32 v206, v179, v183
    v_cvt_pk_bf16_f32 v207, v187, v191
    ds_write_b128 v10, v[204:207] offset:15360
    s_lshl_b32 s6, s3, 10
    v_add_u32 v2, s6, v10
    v_xor_b32 v3, 1024, v2
    v_xor_b32 v4, 2048, v2
    v_xor_b32 v5, 3072, v2
    s_lshl_b32 s95, s4, 12
    s_waitcnt vmcnt(18)
    s_cmp_lg_u32 s3, 0
    s_cbranch_scc1 L_noann
    s_lshr_b32 s6, s2, 3
    s_lshl_b32 s6, s6, 2
    s_add_u32 s6, s6, 128
    v_mov_b32 v1, 1
    s_mov_b64 exec, 1
    buffer_atomic_add v1, off, s[16:19], s6 sc1
    s_mov_b64 exec, -1
L_noann:
    v_perm_b32 v16, v100, v96, s93
    v_perm_b32 v17, v108, v104, s93
    v_perm_b32 v18, v116, v112, s93
    v_perm_b32 v19, v124, v120, s93
    v_perm_b32 v20, v100, v96, s94
    v_perm_b32 v21, v108, v104, s94
    v_perm_b32 v22, v116, v112, s94
    v_perm_b32 v23, v124, v120, s94
    s_waitcnt lgkmcnt(0)
    s_barrier
    v_add_u32 v10, s95, v11
    s_add_u32 s95, s95, 4096
    s_and_b32 s95, s95, 0xffff
    ds_read_b128 a[64:67], v10 offset:0
    ds_read_b128 a[68:71], v10 offset:1024
    ds_read_b128 a[72:75], v10 offset:2048
    ds_read_b128 a[76:79], v10 offset:3072
    s_waitcnt lgkmcnt(0)
    v_mfma_f32_16x16x32_bf16 v[128:131], v[16:19], a[64:67], 0
    v_perm_b32 v24, v101, v97, s93
    v_perm_b32 v25, v109, v105, s93
    v_mfma_f32_16x16x32_bf16 v[160:163], v[16:19], a[68:71], 0
    v_add_u32 v10, s95, v11
    s_add_u32 s95, s95, 4096
    v_mfma_f32_16x16x32_bf16 v[192:195], v[16:19], a[72:75], 0
    v_perm_b32 v26, v117, v113, s93
    v_perm_b32 v27, v125, v121, s93
    v_mfma_f32_16x16x32_bf16 v[224:227], v[16:19], a[76:79], 0
    ds_read_b128 a[80:83], v10 offset:0
    v_mfma_f32_16x16x32_bf16 v[132:135], v[20:23], a[64:67], 0
    v_perm_b32 v28, v101, v97, s94
    v_perm_b32 v29, v109, v105, s94
    v_mfma_f32_16x16x32_bf16 v[164:167], v[20:23], a[68:71], 0
    ds_read_b128 a[84:87], v10 offset:1024
    v_mfma_f32_16x16x32_bf16 v[196:199], v[20:23], a[72:75], 0
    v_perm_b32 v30, v117, v113, s94
    v_perm_b32 v31, v125, v121, s94
    v_mfma_f32_16x16x32_bf16 v[228:231], v[20:23], a[76:79], 0
    ds_read_b128 a[88:91], v10 offset:2048
    v_mfma_f32_16x16x32_bf16 v[136:139], v[24:27], a[64:67], 0
    v_perm_b32 v16, v102, v98, s93
    v_perm_b32 v17, v110, v106, s93
    v_mfma_f32_16x16x32_bf16 v[168:171], v[24:27], a[68:71], 0
    ds_read_b128 a[92:95], v10 offset:3072
    v_mfma_f32_16x16x32_bf16 v[200:203], v[24:27], a[72:75], 0
    v_perm_b32 v18, v118, v114, s93
    v_perm_b32 v19, v126, v122, s93
    v_mfma_f32_16x16x32_bf16 v[232:235], v[24:27], a[76:79], 0
    v_mfma_f32_16x16x32_bf16 v[140:143], v[28:31], a[64:67], 0
    v_perm_b32 v20, v102, v98, s94
    v_perm_b32 v21, v110, v106, s94
    v_mfma_f32_16x16x32_bf16 v[172:175], v[28:31], a[68:71], 0
    v_mfma_f32_16x16x32_bf16 v[204:207], v[28:31], a[72:75], 0
    v_perm_b32 v22, v118, v114, s94
    v_perm_b32 v23, v126, v122, s94
    v_mfma_f32_16x16x32_bf16 v[236:239], v[28:31], a[76:79], 0
    v_mfma_f32_16x16x32_bf16 v[144:147], v[16:19], a[64:67], 0
    v_perm_b32 v24, v103, v99, s93
    v_perm_b32 v25, v111, v107, s93
    v_mfma_f32_16x16x32_bf16 v[176:179], v[16:19], a[68:71], 0
    s_and_b32 s95, s95, 0xffff
    v_mfma_f32_16x16x32_bf16 v[208:211], v[16:19], a[72:75], 0
    v_perm_b32 v26, v119, v115, s93
    v_perm_b32 v27, v127, v123, s93
    v_mfma_f32_16x16x32_bf16 v[240:243], v[16:19], a[76:79], 0
    s_waitcnt lgkmcnt(0)
    v_mfma_f32_16x16x32_bf16 v[148:151], v[20:23], a[64:67], 0
    v_perm_b32 v28, v103, v99, s94
    v_perm_b32 v29, v111, v107, s94
    v_mfma_f32_16x16x32_bf16 v[180:183], v[20:23], a[68:71], 0
    s_waitcnt vmcnt(8)
    v_mfma_f32_16x16x32_bf16 v[212:215], v[20:23], a[72:75], 0
    v_perm_b32 v30, v119, v115, s94
    v_perm_b32 v31, v127, v123, s94
    v_mfma_f32_16x16x32_bf16 v[244:247], v[20:23], a[76:79], 0
    buffer_load_dwordx4 v[96:99], v14, s[24:27], s55 offen offset:0
    v_mfma_f32_16x16x32_bf16 v[152:155], v[24:27], a[64:67], 0
    v_perm_b32 v16, v36, v32, s93
    v_perm_b32 v17, v44, v40, s93
    v_mfma_f32_16x16x32_bf16 v[184:187], v[24:27], a[68:71], 0
    buffer_load_dwordx4 v[100:103], v14, s[24:27], s55 offen offset:1280
    v_mfma_f32_16x16x32_bf16 v[216:219], v[24:27], a[72:75], 0
    v_perm_b32 v18, v52, v48, s93
    v_perm_b32 v19, v60, v56, s93
    v_mfma_f32_16x16x32_bf16 v[248:251], v[24:27], a[76:79], 0
    buffer_load_dwordx4 v[104:107], v14, s[24:27], s55 offen offset:2560
    v_mfma_f32_16x16x32_bf16 v[156:159], v[28:31], a[64:67], 0
    v_perm_b32 v20, v36, v32, s94
    v_perm_b32 v21, v44, v40, s94
    v_mfma_f32_16x16x32_bf16 v[188:191], v[28:31], a[68:71], 0
    buffer_load_dwordx4 v[108:111], v14, s[24:27], s55 offen offset:3840
    v_mfma_f32_16x16x32_bf16 v[220:223], v[28:31], a[72:75], 0
    v_perm_b32 v22, v52, v48, s94
    v_perm_b32 v23, v60, v56, s94
    v_mfma_f32_16x16x32_bf16 v[252:255], v[28:31], a[76:79], 0
    buffer_load_dwordx4 v[112:115], v15, s[24:27], s55 offen offset:0
    v_mfma_f32_16x16x32_bf16 v[128:131], v[16:19], a[80:83], v[128:131]
    v_perm_b32 v24, v37, v33, s93
    v_perm_b32 v25, v45, v41, s93
    v_mfma_f32_16x16x32_bf16 v[160:163], v[16:19], a[84:87], v[160:163]
    v_add_u32 v10, s95, v11
    s_add_u32 s95, s95, 4096
    v_mfma_f32_16x16x32_bf16 v[192:195], v[16:19], a[88:91], v[192:195]
    v_perm_b32 v26, v53, v49, s93
    v_perm_b32 v27, v61, v57, s93
    v_mfma_f32_16x16x32_bf16 v[224:227], v[16:19], a[92:95], v[224:227]
    ds_read_b128 a[64:67], v10 offset:0
    v_mfma_f32_16x16x32_bf16 v[132:135], v[20:23], a[80:83], v[132:135]
    v_perm_b32 v28, v37, v33, s94
    v_perm_b32 v29, v45, v41, s94
    v_mfma_f32_16x16x32_bf16 v[164:167], v[20:23], a[84:87], v[164:167]
    ds_read_b128 a[68:71], v10 offset:1024
    v_mfma_f32_16x16x32_bf16 v[196:199], v[20:23], a[88:91], v[196:199]
    v_perm_b32 v30, v53, v49, s94
    v_perm_b32 v31, v61, v57, s94
    v_mfma_f32_16x16x32_bf16 v[228:231], v[20:23], a[92:95], v[228:231]
    ds_read_b128 a[72:75], v10 offset:2048
    v_mfma_f32_16x16x32_bf16 v[136:139], v[24:27], a[80:83], v[136:139]
    v_perm_b32 v16, v38, v34, s93
    v_perm_b32 v17, v46, v42, s93
    v_mfma_f32_16x16x32_bf16 v[168:171], v[24:27], a[84:87], v[168:171]
    ds_read_b128 a[76:79], v10 offset:3072
    v_mfma_f32_16x16x32_bf16 v[200:203], v[24:27], a[88:91], v[200:203]
    v_perm_b32 v18, v54, v50, s93
    v_perm_b32 v19, v62, v58, s93
    v_mfma_f32_16x16x32_bf16 v[232:235], v[24:27], a[92:95], v[232:235]
    buffer_load_dwordx4 v[116:119], v15, s[24:27], s55 offen offset:1280
    v_mfma_f32_16x16x32_bf16 v[140:143], v[28:31], a[80:83], v[140:143]
    v_perm_b32 v20, v38, v34, s94
    v_perm_b32 v21, v46, v42, s94
    v_mfma_f32_16x16x32_bf16 v[172:175], v[28:31], a[84:87], v[172:175]
    buffer_load_dwordx4 v[120:123], v15, s[24:27], s55 offen offset:2560
    v_mfma_f32_16x16x32_bf16 v[204:207], v[28:31], a[88:91], v[204:207]
    v_perm_b32 v22, v54, v50, s94
    v_perm_b32 v23, v62, v58, s94
    v_mfma_f32_16x16x32_bf16 v[236:239], v[28:31], a[92:95], v[236:239]
    buffer_load_dwordx4 v[124:127], v15, s[24:27], s55 offen offset:3840
    v_mfma_f32_16x16x32_bf16 v[144:147], v[16:19], a[80:83], v[144:147]
    v_perm_b32 v24, v39, v35, s93
    v_perm_b32 v25, v47, v43, s93
    v_mfma_f32_16x16x32_bf16 v[176:179], v[16:19], a[84:87], v[176:179]
    s_and_b32 s95, s95, 0xffff
    v_mfma_f32_16x16x32_bf16 v[208:211], v[16:19], a[88:91], v[208:211]
    v_perm_b32 v26, v55, v51, s93
    v_perm_b32 v27, v63, v59, s93
    v_mfma_f32_16x16x32_bf16 v[240:243], v[16:19], a[92:95], v[240:243]
    s_waitcnt lgkmcnt(0)
    v_mfma_f32_16x16x32_bf16 v[148:151], v[20:23], a[80:83], v[148:151]
    v_perm_b32 v28, v39, v35, s94
    v_perm_b32 v29, v47, v43, s94
    v_mfma_f32_16x16x32_bf16 v[180:183], v[20:23], a[84:87], v[180:183]
    s_waitcnt vmcnt(8)
    v_mfma_f32_16x16x32_bf16 v[212:215], v[20:23], a[88:91], v[212:215]
    v_perm_b32 v30, v55, v51, s94
    v_perm_b32 v31, v63, v59, s94
    v_mfma_f32_16x16x32_bf16 v[244:247], v[20:23], a[92:95], v[244:247]
    buffer_load_dwordx4 v[32:35], v14, s[24:27], s56 offen offset:0
    v_mfma_f32_16x16x32_bf16 v[152:155], v[24:27], a[80:83], v[152:155]
    v_perm_b32 v16, v68, v64, s93
    v_perm_b32 v17, v76, v72, s93
    v_mfma_f32_16x16x32_bf16 v[184:187], v[24:27], a[84:87], v[184:187]
    buffer_load_dwordx4 v[36:39], v14, s[24:27], s56 offen offset:1280
    v_mfma_f32_16x16x32_bf16 v[216:219], v[24:27], a[88:91], v[216:219]
    v_perm_b32 v18, v84, v80, s93
    v_perm_b32 v19, v92, v88, s93
    v_mfma_f32_16x16x32_bf16 v[248:251], v[24:27], a[92:95], v[248:251]
    buffer_load_dwordx4 v[40:43], v14, s[24:27], s56 offen offset:2560
    v_mfma_f32_16x16x32_bf16 v[156:159], v[28:31], a[80:83], v[156:159]
    v_perm_b32 v20, v68, v64, s94
    v_perm_b32 v21, v76, v72, s94
    v_mfma_f32_16x16x32_bf16 v[188:191], v[28:31], a[84:87], v[188:191]
    buffer_load_dwordx4 v[44:47], v14, s[24:27], s56 offen offset:3840
    v_mfma_f32_16x16x32_bf16 v[220:223], v[28:31], a[88:91], v[220:223]
    v_perm_b32 v22, v84, v80, s94
    v_perm_b32 v23, v92, v88, s94
    v_mfma_f32_16x16x32_bf16 v[252:255], v[28:31], a[92:95], v[252:255]
    buffer_load_dwordx4 v[48:51], v15, s[24:27], s56 offen offset:0
    v_mfma_f32_16x16x32_bf16 v[128:131], v[16:19], a[64:67], v[128:131]
    v_perm_b32 v24, v69, v65, s93
    v_perm_b32 v25, v77, v73, s93
    v_mfma_f32_16x16x32_bf16 v[160:163], v[16:19], a[68:71], v[160:163]
    v_add_u32 v10, s95, v11
    s_add_u32 s95, s95, 4096
    v_mfma_f32_16x16x32_bf16 v[192:195], v[16:19], a[72:75], v[192:195]
    v_perm_b32 v26, v85, v81, s93
    v_perm_b32 v27, v93, v89, s93
    v_mfma_f32_16x16x32_bf16 v[224:227], v[16:19], a[76:79], v[224:227]
    ds_read_b128 a[80:83], v10 offset:0
    v_mfma_f32_16x16x32_bf16 v[132:135], v[20:23], a[64:67], v[132:135]
    v_perm_b32 v28, v69, v65, s94
    v_perm_b32 v29, v77, v73, s94
    v_mfma_f32_16x16x32_bf16 v[164:167], v[20:23], a[68:71], v[164:167]
    ds_read_b128 a[84:87], v10 offset:1024
    v_mfma_f32_16x16x32_bf16 v[196:199], v[20:23], a[72:75], v[196:199]
    v_perm_b32 v30, v85, v81, s94
    v_perm_b32 v31, v93, v89, s94
    v_mfma_f32_16x16x32_bf16 v[228:231], v[20:23], a[76:79], v[228:231]
    ds_read_b128 a[88:91], v10 offset:2048
    v_mfma_f32_16x16x32_bf16 v[136:139], v[24:27], a[64:67], v[136:139]
    v_perm_b32 v16, v70, v66, s93
    v_perm_b32 v17, v78, v74, s93
    v_mfma_f32_16x16x32_bf16 v[168:171], v[24:27], a[68:71], v[168:171]
    ds_read_b128 a[92:95], v10 offset:3072
    v_mfma_f32_16x16x32_bf16 v[200:203], v[24:27], a[72:75], v[200:203]
    v_perm_b32 v18, v86, v82, s93
    v_perm_b32 v19, v94, v90, s93
    v_mfma_f32_16x16x32_bf16 v[232:235], v[24:27], a[76:79], v[232:235]
    buffer_load_dwordx4 v[52:55], v15, s[24:27], s56 offen offset:1280
    v_mfma_f32_16x16x32_bf16 v[140:143], v[28:31], a[64:67], v[140:143]
    v_perm_b32 v20, v70, v66, s94
    v_perm_b32 v21, v78, v74, s94
    v_mfma_f32_16x16x32_bf16 v[172:175], v[28:31], a[68:71], v[172:175]
    buffer_load_dwordx4 v[56:59], v15, s[24:27], s56 offen offset:2560
    v_mfma_f32_16x16x32_bf16 v[204:207], v[28:31], a[72:75], v[204:207]
    v_perm_b32 v22, v86, v82, s94
    v_perm_b32 v23, v94, v90, s94
    v_mfma_f32_16x16x32_bf16 v[236:239], v[28:31], a[76:79], v[236:239]
    buffer_load_dwordx4 v[60:63], v15, s[24:27], s56 offen offset:3840
    v_mfma_f32_16x16x32_bf16 v[144:147], v[16:19], a[64:67], v[144:147]
    v_perm_b32 v24, v71, v67, s93
    v_perm_b32 v25, v79, v75, s93
    v_mfma_f32_16x16x32_bf16 v[176:179], v[16:19], a[68:71], v[176:179]
    s_and_b32 s95, s95, 0xffff
    v_mfma_f32_16x16x32_bf16 v[208:211], v[16:19], a[72:75], v[208:211]
    v_perm_b32 v26, v87, v83, s93
    v_perm_b32 v27, v95, v91, s93
    v_mfma_f32_16x16x32_bf16 v[240:243], v[16:19], a[76:79], v[240:243]
    s_waitcnt lgkmcnt(0)
    v_mfma_f32_16x16x32_bf16 v[148:151], v[20:23], a[64:67], v[148:151]
    v_perm_b32 v28, v71, v67, s94
    v_perm_b32 v29, v79, v75, s94
    v_mfma_f32_16x16x32_bf16 v[180:183], v[20:23], a[68:71], v[180:183]
    s_waitcnt vmcnt(8)
    v_mfma_f32_16x16x32_bf16 v[212:215], v[20:23], a[72:75], v[212:215]
    v_perm_b32 v30, v87, v83, s94
    v_perm_b32 v31, v95, v91, s94
    v_mfma_f32_16x16x32_bf16 v[244:247], v[20:23], a[76:79], v[244:247]
    buffer_load_dwordx4 v[64:67], v14, s[24:27], s57 offen offset:0
    v_mfma_f32_16x16x32_bf16 v[152:155], v[24:27], a[64:67], v[152:155]
    v_perm_b32 v16, v100, v96, s93
    v_perm_b32 v17, v108, v104, s93
    v_mfma_f32_16x16x32_bf16 v[184:187], v[24:27], a[68:71], v[184:187]
    buffer_load_dwordx4 v[68:71], v14, s[24:27], s57 offen offset:1280
    v_mfma_f32_16x16x32_bf16 v[216:219], v[24:27], a[72:75], v[216:219]
    v_perm_b32 v18, v116, v112, s93
    v_perm_b32 v19, v124, v120, s93
    v_mfma_f32_16x16x32_bf16 v[248:251], v[24:27], a[76:79], v[248:251]
    buffer_load_dwordx4 v[72:75], v14, s[24:27], s57 offen offset:2560
    v_mfma_f32_16x16x32_bf16 v[156:159], v[28:31], a[64:67], v[156:159]
    v_perm_b32 v20, v100, v96, s94
    v_perm_b32 v21, v108, v104, s94
    v_mfma_f32_16x16x32_bf16 v[188:191], v[28:31], a[68:71], v[188:191]
    buffer_load_dwordx4 v[76:79], v14, s[24:27], s57 offen offset:3840
    v_mfma_f32_16x16x32_bf16 v[220:223], v[28:31], a[72:75], v[220:223]
    v_perm_b32 v22, v116, v112, s94
    v_perm_b32 v23, v124, v120, s94
    v_mfma_f32_16x16x32_bf16 v[252:255], v[28:31], a[76:79], v[252:255]
    buffer_load_dwordx4 v[80:83], v15, s[24:27], s57 offen offset:0
    v_mfma_f32_16x16x32_bf16 v[128:131], v[16:19], a[80:83], v[128:131]
    v_perm_b32 v24, v101, v97, s93
    v_perm_b32 v25, v109, v105, s93
    v_mfma_f32_16x16x32_bf16 v[160:163], v[16:19], a[84:87], v[160:163]
    v_add_u32 v10, s95, v11
    s_add_u32 s95, s95, 4096
    v_mfma_f32_16x16x32_bf16 v[192:195], v[16:19], a[88:91], v[192:195]
    v_perm_b32 v26, v117, v113, s93
    v_perm_b32 v27, v125, v121, s93
    v_mfma_f32_16x16x32_bf16 v[224:227], v[16:19], a[92:95], v[224:227]
    ds_read_b128 a[64:67], v10 offset:0
    v_mfma_f32_16x16x32_bf16 v[132:135], v[20:23], a[80:83], v[132:135]
    v_perm_b32 v28, v101, v97, s94
    v_perm_b32 v29, v109, v105, s94
    v_mfma_f32_16x16x32_bf16 v[164:167], v[20:23], a[84:87], v[164:167]
    ds_read_b128 a[68:71], v10 offset:1024
    v_mfma_f32_16x16x32_bf16 v[196:199], v[20:23], a[88:91], v[196:199]
    v_perm_b32 v30, v117, v113, s94
    v_perm_b32 v31, v125, v121, s94
    v_mfma_f32_16x16x32_bf16 v[228:231], v[20:23], a[92:95], v[228:231]
    ds_read_b128 a[72:75], v10 offset:2048
    v_mfma_f32_16x16x32_bf16 v[136:139], v[24:27], a[80:83], v[136:139]
    v_perm_b32 v16, v102, v98, s93
    v_perm_b32 v17, v110, v106, s93
    v_mfma_f32_16x16x32_bf16 v[168:171], v[24:27], a[84:87], v[168:171]
    ds_read_b128 a[76:79], v10 offset:3072
    v_mfma_f32_16x16x32_bf16 v[200:203], v[24:27], a[88:91], v[200:203]
    v_perm_b32 v18, v118, v114, s93
    v_perm_b32 v19, v126, v122, s93
    v_mfma_f32_16x16x32_bf16 v[232:235], v[24:27], a[92:95], v[232:235]
    buffer_load_dwordx4 v[84:87], v15, s[24:27], s57 offen offset:1280
    v_mfma_f32_16x16x32_bf16 v[140:143], v[28:31], a[80:83], v[140:143]
    v_perm_b32 v20, v102, v98, s94
    v_perm_b32 v21, v110, v106, s94
    v_mfma_f32_16x16x32_bf16 v[172:175], v[28:31], a[84:87], v[172:175]
    buffer_load_dwordx4 v[88:91], v15, s[24:27], s57 offen offset:2560
    v_mfma_f32_16x16x32_bf16 v[204:207], v[28:31], a[88:91], v[204:207]
    v_perm_b32 v22, v118, v114, s94
    v_perm_b32 v23, v126, v122, s94
    v_mfma_f32_16x16x32_bf16 v[236:239], v[28:31], a[92:95], v[236:239]
    buffer_load_dwordx4 v[92:95], v15, s[24:27], s57 offen offset:3840
    v_mfma_f32_16x16x32_bf16 v[144:147], v[16:19], a[80:83], v[144:147]
    v_perm_b32 v24, v103, v99, s93
    v_perm_b32 v25, v111, v107, s93
    v_mfma_f32_16x16x32_bf16 v[176:179], v[16:19], a[84:87], v[176:179]
    s_and_b32 s95, s95, 0xffff
    v_mfma_f32_16x16x32_bf16 v[208:211], v[16:19], a[88:91], v[208:211]
    v_perm_b32 v26, v119, v115, s93
    v_perm_b32 v27, v127, v123, s93
    v_mfma_f32_16x16x32_bf16 v[240:243], v[16:19], a[92:95], v[240:243]
    s_waitcnt lgkmcnt(0)
    v_mfma_f32_16x16x32_bf16 v[148:151], v[20:23], a[80:83], v[148:151]
    v_perm_b32 v28, v103, v99, s94
    v_perm_b32 v29, v111, v107, s94
    v_mfma_f32_16x16x32_bf16 v[180:183], v[20:23], a[84:87], v[180:183]
    s_waitcnt vmcnt(8)
    v_mfma_f32_16x16x32_bf16 v[212:215], v[20:23], a[88:91], v[212:215]
    v_perm_b32 v30, v119, v115, s94
    v_perm_b32 v31, v127, v123, s94
    v_mfma_f32_16x16x32_bf16 v[244:247], v[20:23], a[92:95], v[244:247]
    buffer_load_dwordx4 v[96:99], v14, s[24:27], s58 offen offset:0
    v_mfma_f32_16x16x32_bf16 v[152:155], v[24:27], a[80:83], v[152:155]
    v_perm_b32 v16, v36, v32, s93
    v_perm_b32 v17, v44, v40, s93
    v_mfma_f32_16x16x32_bf16 v[184:187], v[24:27], a[84:87], v[184:187]
    buffer_load_dwordx4 v[100:103], v14, s[24:27], s58 offen offset:1280
    v_mfma_f32_16x16x32_bf16 v[216:219], v[24:27], a[88:91], v[216:219]
    v_perm_b32 v18, v52, v48, s93
    v_perm_b32 v19, v60, v56, s93
    v_mfma_f32_16x16x32_bf16 v[248:251], v[24:27], a[92:95], v[248:251]
    buffer_load_dwordx4 v[104:107], v14, s[24:27], s58 offen offset:2560
    v_mfma_f32_16x16x32_bf16 v[156:159], v[28:31], a[80:83], v[156:159]
    v_perm_b32 v20, v36, v32, s94
    v_perm_b32 v21, v44, v40, s94
    v_mfma_f32_16x16x32_bf16 v[188:191], v[28:31], a[84:87], v[188:191]
    buffer_load_dwordx4 v[108:111], v14, s[24:27], s58 offen offset:3840
    v_mfma_f32_16x16x32_bf16 v[220:223], v[28:31], a[88:91], v[220:223]
    v_perm_b32 v22, v52, v48, s94
    v_perm_b32 v23, v60, v56, s94
    v_mfma_f32_16x16x32_bf16 v[252:255], v[28:31], a[92:95], v[252:255]
    buffer_load_dwordx4 v[112:115], v15, s[24:27], s58 offen offset:0
    v_mfma_f32_16x16x32_bf16 v[128:131], v[16:19], a[64:67], v[128:131]
    v_perm_b32 v24, v37, v33, s93
    v_perm_b32 v25, v45, v41, s93
    v_mfma_f32_16x16x32_bf16 v[160:163], v[16:19], a[68:71], v[160:163]
    v_add_u32 v10, s95, v11
    s_add_u32 s95, s95, 4096
    v_mfma_f32_16x16x32_bf16 v[192:195], v[16:19], a[72:75], v[192:195]
    v_perm_b32 v26, v53, v49, s93
    v_perm_b32 v27, v61, v57, s93
    v_mfma_f32_16x16x32_bf16 v[224:227], v[16:19], a[76:79], v[224:227]
    ds_read_b128 a[80:83], v10 offset:0
    v_mfma_f32_16x16x32_bf16 v[132:135], v[20:23], a[64:67], v[132:135]
    v_perm_b32 v28, v37, v33, s94
    v_perm_b32 v29, v45, v41, s94
    v_mfma_f32_16x16x32_bf16 v[164:167], v[20:23], a[68:71], v[164:167]
    ds_read_b128 a[84:87], v10 offset:1024
    v_mfma_f32_16x16x32_bf16 v[196:199], v[20:23], a[72:75], v[196:199]
    v_perm_b32 v30, v53, v49, s94
    v_perm_b32 v31, v61, v57, s94
    v_mfma_f32_16x16x32_bf16 v[228:231], v[20:23], a[76:79], v[228:231]
    ds_read_b128 a[88:91], v10 offset:2048
    v_mfma_f32_16x16x32_bf16 v[136:139], v[24:27], a[64:67], v[136:139]
    v_perm_b32 v16, v38, v34, s93
    v_perm_b32 v17, v46, v42, s93
    v_mfma_f32_16x16x32_bf16 v[168:171], v[24:27], a[68:71], v[168:171]
    ds_read_b128 a[92:95], v10 offset:3072
    v_mfma_f32_16x16x32_bf16 v[200:203], v[24:27], a[72:75], v[200:203]
    v_perm_b32 v18, v54, v50, s93
    v_perm_b32 v19, v62, v58, s93
    v_mfma_f32_16x16x32_bf16 v[232:235], v[24:27], a[76:79], v[232:235]
    buffer_load_dwordx4 v[116:119], v15, s[24:27], s58 offen offset:1280
    v_mfma_f32_16x16x32_bf16 v[140:143], v[28:31], a[64:67], v[140:143]
    v_perm_b32 v20, v38, v34, s94
    v_perm_b32 v21, v46, v42, s94
    v_mfma_f32_16x16x32_bf16 v[172:175], v[28:31], a[68:71], v[172:175]
    buffer_load_dwordx4 v[120:123], v15, s[24:27], s58 offen offset:2560
    v_mfma_f32_16x16x32_bf16 v[204:207], v[28:31], a[72:75], v[204:207]
    v_perm_b32 v22, v54, v50, s94
    v_perm_b32 v23, v62, v58, s94
    v_mfma_f32_16x16x32_bf16 v[236:239], v[28:31], a[76:79], v[236:239]
    buffer_load_dwordx4 v[124:127], v15, s[24:27], s58 offen offset:3840
    v_mfma_f32_16x16x32_bf16 v[144:147], v[16:19], a[64:67], v[144:147]
    v_perm_b32 v24, v39, v35, s93
    v_perm_b32 v25, v47, v43, s93
    v_mfma_f32_16x16x32_bf16 v[176:179], v[16:19], a[68:71], v[176:179]
    s_and_b32 s95, s95, 0xffff
    v_mfma_f32_16x16x32_bf16 v[208:211], v[16:19], a[72:75], v[208:211]
    v_perm_b32 v26, v55, v51, s93
    v_perm_b32 v27, v63, v59, s93
    v_mfma_f32_16x16x32_bf16 v[240:243], v[16:19], a[76:79], v[240:243]
    s_waitcnt lgkmcnt(0)
    v_mfma_f32_16x16x32_bf16 v[148:151], v[20:23], a[64:67], v[148:151]
    v_perm_b32 v28, v39, v35, s94
    v_perm_b32 v29, v47, v43, s94
    v_mfma_f32_16x16x32_bf16 v[180:183], v[20:23], a[68:71], v[180:183]
    s_waitcnt vmcnt(8)
    v_mfma_f32_16x16x32_bf16 v[212:215], v[20:23], a[72:75], v[212:215]
    v_perm_b32 v30, v55, v51, s94
    v_perm_b32 v31, v63, v59, s94
    v_mfma_f32_16x16x32_bf16 v[244:247], v[20:23], a[76:79], v[244:247]
    buffer_load_dwordx4 v[32:35], v14, s[24:27], s59 offen offset:0
    v_mfma_f32_16x16x32_bf16 v[152:155], v[24:27], a[64:67], v[152:155]
    v_perm_b32 v16, v68, v64, s93
    v_perm_b32 v17, v76, v72, s93
    v_mfma_f32_16x16x32_bf16 v[184:187], v[24:27], a[68:71], v[184:187]
    buffer_load_dwordx4 v[36:39], v14, s[24:27], s59 offen offset:1280
    v_mfma_f32_16x16x32_bf16 v[216:219], v[24:27], a[72:75], v[216:219]
    v_perm_b32 v18, v84, v80, s93
    v_perm_b32 v19, v92, v88, s93
    v_mfma_f32_16x16x32_bf16 v[248:251], v[24:27], a[76:79], v[248:251]
    buffer_load_dwordx4 v[40:43], v14, s[24:27], s59 offen offset:2560
    v_mfma_f32_16x16x32_bf16 v[156:159], v[28:31], a[64:67], v[156:159]
    v_perm_b32 v20, v68, v64, s94
    v_perm_b32 v21, v76, v72, s94
    v_mfma_f32_16x16x32_bf16 v[188:191], v[28:31], a[68:71], v[188:191]
    buffer_load_dwordx4 v[44:47], v14, s[24:27], s59 offen offset:3840
    v_mfma_f32_16x16x32_bf16 v[220:223], v[28:31], a[72:75], v[220:223]
    v_perm_b32 v22, v84, v80, s94
    v_perm_b32 v23, v92, v88, s94
    v_mfma_f32_16x16x32_bf16 v[252:255], v[28:31], a[76:79], v[252:255]
    buffer_load_dwordx4 v[48:51], v15, s[24:27], s59 offen offset:0
    v_mfma_f32_16x16x32_bf16 v[128:131], v[16:19], a[80:83], v[128:131]
    v_perm_b32 v24, v69, v65, s93
    v_perm_b32 v25, v77, v73, s93
    v_mfma_f32_16x16x32_bf16 v[160:163], v[16:19], a[84:87], v[160:163]
    v_add_u32 v10, s95, v11
    s_add_u32 s95, s95, 4096
    v_mfma_f32_16x16x32_bf16 v[192:195], v[16:19], a[88:91], v[192:195]
    v_perm_b32 v26, v85, v81, s93
    v_perm_b32 v27, v93, v89, s93
    v_mfma_f32_16x16x32_bf16 v[224:227], v[16:19], a[92:95], v[224:227]
    ds_read_b128 a[64:67], v10 offset:0
    v_mfma_f32_16x16x32_bf16 v[132:135], v[20:23], a[80:83], v[132:135]
    v_perm_b32 v28, v69, v65, s94
    v_perm_b32 v29, v77, v73, s94
    v_mfma_f32_16x16x32_bf16 v[164:167], v[20:23], a[84:87], v[164:167]
    ds_read_b128 a[68:71], v10 offset:1024
    v_mfma_f32_16x16x32_bf16 v[196:199], v[20:23], a[88:91], v[196:199]
    v_perm_b32 v30, v85, v81, s94
    v_perm_b32 v31, v93, v89, s94
    v_mfma_f32_16x16x32_bf16 v[228:231], v[20:23], a[92:95], v[228:231]
    ds_read_b128 a[72:75], v10 offset:2048
    v_mfma_f32_16x16x32_bf16 v[136:139], v[24:27], a[80:83], v[136:139]
    v_perm_b32 v16, v70, v66, s93
    v_perm_b32 v17, v78, v74, s93
    v_mfma_f32_16x16x32_bf16 v[168:171], v[24:27], a[84:87], v[168:171]
    ds_read_b128 a[76:79], v10 offset:3072
    v_mfma_f32_16x16x32_bf16 v[200:203], v[24:27], a[88:91], v[200:203]
    v_perm_b32 v18, v86, v82, s93
    v_perm_b32 v19, v94, v90, s93
    v_mfma_f32_16x16x32_bf16 v[232:235], v[24:27], a[92:95], v[232:235]
    buffer_load_dwordx4 v[52:55], v15, s[24:27], s59 offen offset:1280
    v_mfma_f32_16x16x32_bf16 v[140:143], v[28:31], a[80:83], v[140:143]
    v_perm_b32 v20, v70, v66, s94
    v_perm_b32 v21, v78, v74, s94
    v_mfma_f32_16x16x32_bf16 v[172:175], v[28:31], a[84:87], v[172:175]
    buffer_load_dwordx4 v[56:59], v15, s[24:27], s59 offen offset:2560
    v_mfma_f32_16x16x32_bf16 v[204:207], v[28:31], a[88:91], v[204:207]
    v_perm_b32 v22, v86, v82, s94
    v_perm_b32 v23, v94, v90, s94
    v_mfma_f32_16x16x32_bf16 v[236:239], v[28:31], a[92:95], v[236:239]
    buffer_load_dwordx4 v[60:63], v15, s[24:27], s59 offen offset:3840
    v_mfma_f32_16x16x32_bf16 v[144:147], v[16:19], a[80:83], v[144:147]
    v_perm_b32 v24, v71, v67, s93
    v_perm_b32 v25, v79, v75, s93
    v_mfma_f32_16x16x32_bf16 v[176:179], v[16:19], a[84:87], v[176:179]
    s_and_b32 s95, s95, 0xffff
    v_mfma_f32_16x16x32_bf16 v[208:211], v[16:19], a[88:91], v[208:211]
    v_perm_b32 v26, v87, v83, s93
    v_perm_b32 v27, v95, v91, s93
    v_mfma_f32_16x16x32_bf16 v[240:243], v[16:19], a[92:95], v[240:243]
    s_waitcnt lgkmcnt(0)
    v_mfma_f32_16x16x32_bf16 v[148:151], v[20:23], a[80:83], v[148:151]
    v_perm_b32 v28, v71, v67, s94
    v_perm_b32 v29, v79, v75, s94
    v_mfma_f32_16x16x32_bf16 v[180:183], v[20:23], a[84:87], v[180:183]
    s_waitcnt vmcnt(8)
    v_mfma_f32_16x16x32_bf16 v[212:215], v[20:23], a[88:91], v[212:215]
    v_perm_b32 v30, v87, v83, s94
    v_perm_b32 v31, v95, v91, s94
    v_mfma_f32_16x16x32_bf16 v[244:247], v[20:23], a[92:95], v[244:247]
    buffer_load_dwordx4 v[64:67], v14, s[24:27], s60 offen offset:0
    v_mfma_f32_16x16x32_bf16 v[152:155], v[24:27], a[80:83], v[152:155]
    v_perm_b32 v16, v100, v96, s93
    v_perm_b32 v17, v108, v104, s93
    v_mfma_f32_16x16x32_bf16 v[184:187], v[24:27], a[84:87], v[184:187]
    buffer_load_dwordx4 v[68:71], v14, s[24:27], s60 offen offset:1280
    v_mfma_f32_16x16x32_bf16 v[216:219], v[24:27], a[88:91], v[216:219]
    v_perm_b32 v18, v116, v112, s93
    v_perm_b32 v19, v124, v120, s93
    v_mfma_f32_16x16x32_bf16 v[248:251], v[24:27], a[92:95], v[248:251]
    buffer_load_dwordx4 v[72:75], v14, s[24:27], s60 offen offset:2560
    v_mfma_f32_16x16x32_bf16 v[156:159], v[28:31], a[80:83], v[156:159]
    v_perm_b32 v20, v100, v96, s94
    v_perm_b32 v21, v108, v104, s94
    v_mfma_f32_16x16x32_bf16 v[188:191], v[28:31], a[84:87], v[188:191]
    buffer_load_dwordx4 v[76:79], v14, s[24:27], s60 offen offset:3840
    v_mfma_f32_16x16x32_bf16 v[220:223], v[28:31], a[88:91], v[220:223]
    v_perm_b32 v22, v116, v112, s94
    v_perm_b32 v23, v124, v120, s94
    v_mfma_f32_16x16x32_bf16 v[252:255], v[28:31], a[92:95], v[252:255]
    buffer_load_dwordx4 v[80:83], v15, s[24:27], s60 offen offset:0
    v_mfma_f32_16x16x32_bf16 v[128:131], v[16:19], a[64:67], v[128:131]
    v_perm_b32 v24, v101, v97, s93
    v_perm_b32 v25, v109, v105, s93
    v_mfma_f32_16x16x32_bf16 v[160:163], v[16:19], a[68:71], v[160:163]
    v_add_u32 v10, s95, v11
    s_add_u32 s95, s95, 4096
    v_mfma_f32_16x16x32_bf16 v[192:195], v[16:19], a[72:75], v[192:195]
    v_perm_b32 v26, v117, v113, s93
    v_perm_b32 v27, v125, v121, s93
    v_mfma_f32_16x16x32_bf16 v[224:227], v[16:19], a[76:79], v[224:227]
    ds_read_b128 a[80:83], v10 offset:0
    v_mfma_f32_16x16x32_bf16 v[132:135], v[20:23], a[64:67], v[132:135]
    v_perm_b32 v28, v101, v97, s94
    v_perm_b32 v29, v109, v105, s94
    v_mfma_f32_16x16x32_bf16 v[164:167], v[20:23], a[68:71], v[164:167]
    ds_read_b128 a[84:87], v10 offset:1024
    v_mfma_f32_16x16x32_bf16 v[196:199], v[20:23], a[72:75], v[196:199]
    v_perm_b32 v30, v117, v113, s94
    v_perm_b32 v31, v125, v121, s94
    v_mfma_f32_16x16x32_bf16 v[228:231], v[20:23], a[76:79], v[228:231]
    ds_read_b128 a[88:91], v10 offset:2048
    v_mfma_f32_16x16x32_bf16 v[136:139], v[24:27], a[64:67], v[136:139]
    v_perm_b32 v16, v102, v98, s93
    v_perm_b32 v17, v110, v106, s93
    v_mfma_f32_16x16x32_bf16 v[168:171], v[24:27], a[68:71], v[168:171]
    ds_read_b128 a[92:95], v10 offset:3072
    v_mfma_f32_16x16x32_bf16 v[200:203], v[24:27], a[72:75], v[200:203]
    v_perm_b32 v18, v118, v114, s93
    v_perm_b32 v19, v126, v122, s93
    v_mfma_f32_16x16x32_bf16 v[232:235], v[24:27], a[76:79], v[232:235]
    buffer_load_dwordx4 v[84:87], v15, s[24:27], s60 offen offset:1280
    v_mfma_f32_16x16x32_bf16 v[140:143], v[28:31], a[64:67], v[140:143]
    v_perm_b32 v20, v102, v98, s94
    v_perm_b32 v21, v110, v106, s94
    v_mfma_f32_16x16x32_bf16 v[172:175], v[28:31], a[68:71], v[172:175]
    buffer_load_dwordx4 v[88:91], v15, s[24:27], s60 offen offset:2560
    v_mfma_f32_16x16x32_bf16 v[204:207], v[28:31], a[72:75], v[204:207]
    v_perm_b32 v22, v118, v114, s94
    v_perm_b32 v23, v126, v122, s94
    v_mfma_f32_16x16x32_bf16 v[236:239], v[28:31], a[76:79], v[236:239]
    buffer_load_dwordx4 v[92:95], v15, s[24:27], s60 offen offset:3840
    v_mfma_f32_16x16x32_bf16 v[144:147], v[16:19], a[64:67], v[144:147]
    v_perm_b32 v24, v103, v99, s93
    v_perm_b32 v25, v111, v107, s93
    v_mfma_f32_16x16x32_bf16 v[176:179], v[16:19], a[68:71], v[176:179]
    s_and_b32 s95, s95, 0xffff
    v_mfma_f32_16x16x32_bf16 v[208:211], v[16:19], a[72:75], v[208:211]
    v_perm_b32 v26, v119, v115, s93
    v_perm_b32 v27, v127, v123, s93
    v_mfma_f32_16x16x32_bf16 v[240:243], v[16:19], a[76:79], v[240:243]
    s_waitcnt lgkmcnt(0)
    v_mfma_f32_16x16x32_bf16 v[148:151], v[20:23], a[64:67], v[148:151]
    v_perm_b32 v28, v103, v99, s94
    v_perm_b32 v29, v111, v107, s94
    v_mfma_f32_16x16x32_bf16 v[180:183], v[20:23], a[68:71], v[180:183]
    s_waitcnt vmcnt(8)
    v_mfma_f32_16x16x32_bf16 v[212:215], v[20:23], a[72:75], v[212:215]
    v_perm_b32 v30, v119, v115, s94
    v_perm_b32 v31, v127, v123, s94
    v_mfma_f32_16x16x32_bf16 v[244:247], v[20:23], a[76:79], v[244:247]
    buffer_load_dwordx4 v[96:99], v14, s[24:27], s61 offen offset:0
    v_mfma_f32_16x16x32_bf16 v[152:155], v[24:27], a[64:67], v[152:155]
    v_perm_b32 v16, v36, v32, s93
    v_perm_b32 v17, v44, v40, s93
    v_mfma_f32_16x16x32_bf16 v[184:187], v[24:27], a[68:71], v[184:187]
    buffer_load_dwordx4 v[100:103], v14, s[24:27], s61 offen offset:1280
    v_mfma_f32_16x16x32_bf16 v[216:219], v[24:27], a[72:75], v[216:219]
    v_perm_b32 v18, v52, v48, s93
    v_perm_b32 v19, v60, v56, s93
    v_mfma_f32_16x16x32_bf16 v[248:251], v[24:27], a[76:79], v[248:251]
    buffer_load_dwordx4 v[104:107], v14, s[24:27], s61 offen offset:2560
    v_mfma_f32_16x16x32_bf16 v[156:159], v[28:31], a[64:67], v[156:159]
    v_perm_b32 v20, v36, v32, s94
    v_perm_b32 v21, v44, v40, s94
    v_mfma_f32_16x16x32_bf16 v[188:191], v[28:31], a[68:71], v[188:191]
    buffer_load_dwordx4 v[108:111], v14, s[24:27], s61 offen offset:3840
    v_mfma_f32_16x16x32_bf16 v[220:223], v[28:31], a[72:75], v[220:223]
    v_perm_b32 v22, v52, v48, s94
    v_perm_b32 v23, v60, v56, s94
    v_mfma_f32_16x16x32_bf16 v[252:255], v[28:31], a[76:79], v[252:255]
    buffer_load_dwordx4 v[112:115], v15, s[24:27], s61 offen offset:0
    v_mfma_f32_16x16x32_bf16 v[128:131], v[16:19], a[80:83], v[128:131]
    v_perm_b32 v24, v37, v33, s93
    v_perm_b32 v25, v45, v41, s93
    v_mfma_f32_16x16x32_bf16 v[160:163], v[16:19], a[84:87], v[160:163]
    v_add_u32 v10, s95, v11
    s_add_u32 s95, s95, 4096
    v_mfma_f32_16x16x32_bf16 v[192:195], v[16:19], a[88:91], v[192:195]
    v_perm_b32 v26, v53, v49, s93
    v_perm_b32 v27, v61, v57, s93
    v_mfma_f32_16x16x32_bf16 v[224:227], v[16:19], a[92:95], v[224:227]
    ds_read_b128 a[64:67], v10 offset:0
    v_mfma_f32_16x16x32_bf16 v[132:135], v[20:23], a[80:83], v[132:135]
    v_perm_b32 v28, v37, v33, s94
    v_perm_b32 v29, v45, v41, s94
    v_mfma_f32_16x16x32_bf16 v[164:167], v[20:23], a[84:87], v[164:167]
    ds_read_b128 a[68:71], v10 offset:1024
    v_mfma_f32_16x16x32_bf16 v[196:199], v[20:23], a[88:91], v[196:199]
    v_perm_b32 v30, v53, v49, s94
    v_perm_b32 v31, v61, v57, s94
    v_mfma_f32_16x16x32_bf16 v[228:231], v[20:23], a[92:95], v[228:231]
    ds_read_b128 a[72:75], v10 offset:2048
    v_mfma_f32_16x16x32_bf16 v[136:139], v[24:27], a[80:83], v[136:139]
    v_perm_b32 v16, v38, v34, s93
    v_perm_b32 v17, v46, v42, s93
    v_mfma_f32_16x16x32_bf16 v[168:171], v[24:27], a[84:87], v[168:171]
    ds_read_b128 a[76:79], v10 offset:3072
    v_mfma_f32_16x16x32_bf16 v[200:203], v[24:27], a[88:91], v[200:203]
    v_perm_b32 v18, v54, v50, s93
    v_perm_b32 v19, v62, v58, s93
    v_mfma_f32_16x16x32_bf16 v[232:235], v[24:27], a[92:95], v[232:235]
    buffer_load_dwordx4 v[116:119], v15, s[24:27], s61 offen offset:1280
    v_mfma_f32_16x16x32_bf16 v[140:143], v[28:31], a[80:83], v[140:143]
    v_perm_b32 v20, v38, v34, s94
    v_perm_b32 v21, v46, v42, s94
    v_mfma_f32_16x16x32_bf16 v[172:175], v[28:31], a[84:87], v[172:175]
    buffer_load_dwordx4 v[120:123], v15, s[24:27], s61 offen offset:2560
    v_mfma_f32_16x16x32_bf16 v[204:207], v[28:31], a[88:91], v[204:207]
    v_perm_b32 v22, v54, v50, s94
    v_perm_b32 v23, v62, v58, s94
    v_mfma_f32_16x16x32_bf16 v[236:239], v[28:31], a[92:95], v[236:239]
    buffer_load_dwordx4 v[124:127], v15, s[24:27], s61 offen offset:3840
    v_mfma_f32_16x16x32_bf16 v[144:147], v[16:19], a[80:83], v[144:147]
    v_perm_b32 v24, v39, v35, s93
    v_perm_b32 v25, v47, v43, s93
    v_mfma_f32_16x16x32_bf16 v[176:179], v[16:19], a[84:87], v[176:179]
    s_and_b32 s95, s95, 0xffff
    v_mfma_f32_16x16x32_bf16 v[208:211], v[16:19], a[88:91], v[208:211]
    v_perm_b32 v26, v55, v51, s93
    v_perm_b32 v27, v63, v59, s93
    v_mfma_f32_16x16x32_bf16 v[240:243], v[16:19], a[92:95], v[240:243]
    s_waitcnt lgkmcnt(0)
    v_mfma_f32_16x16x32_bf16 v[148:151], v[20:23], a[80:83], v[148:151]
    v_perm_b32 v28, v39, v35, s94
    v_perm_b32 v29, v47, v43, s94
    v_mfma_f32_16x16x32_bf16 v[180:183], v[20:23], a[84:87], v[180:183]
    s_waitcnt vmcnt(8)
    v_mfma_f32_16x16x32_bf16 v[212:215], v[20:23], a[88:91], v[212:215]
    v_perm_b32 v30, v55, v51, s94
    v_perm_b32 v31, v63, v59, s94
    v_mfma_f32_16x16x32_bf16 v[244:247], v[20:23], a[92:95], v[244:247]
    buffer_load_dwordx4 v[32:35], v14, s[24:27], s62 offen offset:0
    v_mfma_f32_16x16x32_bf16 v[152:155], v[24:27], a[80:83], v[152:155]
    v_perm_b32 v16, v68, v64, s93
    v_perm_b32 v17, v76, v72, s93
    v_mfma_f32_16x16x32_bf16 v[184:187], v[24:27], a[84:87], v[184:187]
    buffer_load_dwordx4 v[36:39], v14, s[24:27], s62 offen offset:1280
    v_mfma_f32_16x16x32_bf16 v[216:219], v[24:27], a[88:91], v[216:219]
    v_perm_b32 v18, v84, v80, s93
    v_perm_b32 v19, v92, v88, s93
    v_mfma_f32_16x16x32_bf16 v[248:251], v[24:27], a[92:95], v[248:251]
    buffer_load_dwordx4 v[40:43], v14, s[24:27], s62 offen offset:2560
    v_mfma_f32_16x16x32_bf16 v[156:159], v[28:31], a[80:83], v[156:159]
    v_perm_b32 v20, v68, v64, s94
    v_perm_b32 v21, v76, v72, s94
    v_mfma_f32_16x16x32_bf16 v[188:191], v[28:31], a[84:87], v[188:191]
    buffer_load_dwordx4 v[44:47], v14, s[24:27], s62 offen offset:3840
    v_mfma_f32_16x16x32_bf16 v[220:223], v[28:31], a[88:91], v[220:223]
    v_perm_b32 v22, v84, v80, s94
    v_perm_b32 v23, v92, v88, s94
    v_mfma_f32_16x16x32_bf16 v[252:255], v[28:31], a[92:95], v[252:255]
    buffer_load_dwordx4 v[48:51], v15, s[24:27], s62 offen offset:0
    v_mfma_f32_16x16x32_bf16 v[128:131], v[16:19], a[64:67], v[128:131]
    v_perm_b32 v24, v69, v65, s93
    v_perm_b32 v25, v77, v73, s93
    v_mfma_f32_16x16x32_bf16 v[160:163], v[16:19], a[68:71], v[160:163]
    v_add_u32 v10, s95, v11
    s_add_u32 s95, s95, 4096
    v_mfma_f32_16x16x32_bf16 v[192:195], v[16:19], a[72:75], v[192:195]
    v_perm_b32 v26, v85, v81, s93
    v_perm_b32 v27, v93, v89, s93
    v_mfma_f32_16x16x32_bf16 v[224:227], v[16:19], a[76:79], v[224:227]
    ds_read_b128 a[80:83], v10 offset:0
    v_mfma_f32_16x16x32_bf16 v[132:135], v[20:23], a[64:67], v[132:135]
    v_perm_b32 v28, v69, v65, s94
    v_perm_b32 v29, v77, v73, s94
    v_mfma_f32_16x16x32_bf16 v[164:167], v[20:23], a[68:71], v[164:167]
    ds_read_b128 a[84:87], v10 offset:1024
    v_mfma_f32_16x16x32_bf16 v[196:199], v[20:23], a[72:75], v[196:199]
    v_perm_b32 v30, v85, v81, s94
    v_perm_b32 v31, v93, v89, s94
    v_mfma_f32_16x16x32_bf16 v[228:231], v[20:23], a[76:79], v[228:231]
    ds_read_b128 a[88:91], v10 offset:2048
    v_mfma_f32_16x16x32_bf16 v[136:139], v[24:27], a[64:67], v[136:139]
    v_perm_b32 v16, v70, v66, s93
    v_perm_b32 v17, v78, v74, s93
    v_mfma_f32_16x16x32_bf16 v[168:171], v[24:27], a[68:71], v[168:171]
    ds_read_b128 a[92:95], v10 offset:3072
    v_mfma_f32_16x16x32_bf16 v[200:203], v[24:27], a[72:75], v[200:203]
    v_perm_b32 v18, v86, v82, s93
    v_perm_b32 v19, v94, v90, s93
    v_mfma_f32_16x16x32_bf16 v[232:235], v[24:27], a[76:79], v[232:235]
    buffer_load_dwordx4 v[52:55], v15, s[24:27], s62 offen offset:1280
    v_mfma_f32_16x16x32_bf16 v[140:143], v[28:31], a[64:67], v[140:143]
    v_perm_b32 v20, v70, v66, s94
    v_perm_b32 v21, v78, v74, s94
    v_mfma_f32_16x16x32_bf16 v[172:175], v[28:31], a[68:71], v[172:175]
    buffer_load_dwordx4 v[56:59], v15, s[24:27], s62 offen offset:2560
    v_mfma_f32_16x16x32_bf16 v[204:207], v[28:31], a[72:75], v[204:207]
    v_perm_b32 v22, v86, v82, s94
    v_perm_b32 v23, v94, v90, s94
    v_mfma_f32_16x16x32_bf16 v[236:239], v[28:31], a[76:79], v[236:239]
    buffer_load_dwordx4 v[60:63], v15, s[24:27], s62 offen offset:3840
    v_mfma_f32_16x16x32_bf16 v[144:147], v[16:19], a[64:67], v[144:147]
    v_perm_b32 v24, v71, v67, s93
    v_perm_b32 v25, v79, v75, s93
    v_mfma_f32_16x16x32_bf16 v[176:179], v[16:19], a[68:71], v[176:179]
    s_and_b32 s95, s95, 0xffff
    v_mfma_f32_16x16x32_bf16 v[208:211], v[16:19], a[72:75], v[208:211]
    v_perm_b32 v26, v87, v83, s93
    v_perm_b32 v27, v95, v91, s93
    v_mfma_f32_16x16x32_bf16 v[240:243], v[16:19], a[76:79], v[240:243]
    s_waitcnt lgkmcnt(0)
    v_mfma_f32_16x16x32_bf16 v[148:151], v[20:23], a[64:67], v[148:151]
    v_perm_b32 v28, v71, v67, s94
    v_perm_b32 v29, v79, v75, s94
    v_mfma_f32_16x16x32_bf16 v[180:183], v[20:23], a[68:71], v[180:183]
    s_waitcnt vmcnt(8)
    v_mfma_f32_16x16x32_bf16 v[212:215], v[20:23], a[72:75], v[212:215]
    v_perm_b32 v30, v87, v83, s94
    v_perm_b32 v31, v95, v91, s94
    v_mfma_f32_16x16x32_bf16 v[244:247], v[20:23], a[76:79], v[244:247]
    buffer_load_dwordx4 v[64:67], v14, s[24:27], s63 offen offset:0
    v_mfma_f32_16x16x32_bf16 v[152:155], v[24:27], a[64:67], v[152:155]
    v_perm_b32 v16, v100, v96, s93
    v_perm_b32 v17, v108, v104, s93
    v_mfma_f32_16x16x32_bf16 v[184:187], v[24:27], a[68:71], v[184:187]
    buffer_load_dwordx4 v[68:71], v14, s[24:27], s63 offen offset:1280
    v_mfma_f32_16x16x32_bf16 v[216:219], v[24:27], a[72:75], v[216:219]
    v_perm_b32 v18, v116, v112, s93
    v_perm_b32 v19, v124, v120, s93
    v_mfma_f32_16x16x32_bf16 v[248:251], v[24:27], a[76:79], v[248:251]
    buffer_load_dwordx4 v[72:75], v14, s[24:27], s63 offen offset:2560
    v_mfma_f32_16x16x32_bf16 v[156:159], v[28:31], a[64:67], v[156:159]
    v_perm_b32 v20, v100, v96, s94
    v_perm_b32 v21, v108, v104, s94
    v_mfma_f32_16x16x32_bf16 v[188:191], v[28:31], a[68:71], v[188:191]
    buffer_load_dwordx4 v[76:79], v14, s[24:27], s63 offen offset:3840
    v_mfma_f32_16x16x32_bf16 v[220:223], v[28:31], a[72:75], v[220:223]
    v_perm_b32 v22, v116, v112, s94
    v_perm_b32 v23, v124, v120, s94
    v_mfma_f32_16x16x32_bf16 v[252:255], v[28:31], a[76:79], v[252:255]
    buffer_load_dwordx4 v[80:83], v15, s[24:27], s63 offen offset:0
    v_mfma_f32_16x16x32_bf16 v[128:131], v[16:19], a[80:83], v[128:131]
    v_perm_b32 v24, v101, v97, s93
    v_perm_b32 v25, v109, v105, s93
    v_mfma_f32_16x16x32_bf16 v[160:163], v[16:19], a[84:87], v[160:163]
    v_add_u32 v10, s95, v11
    s_add_u32 s95, s95, 4096
    v_mfma_f32_16x16x32_bf16 v[192:195], v[16:19], a[88:91], v[192:195]
    v_perm_b32 v26, v117, v113, s93
    v_perm_b32 v27, v125, v121, s93
    v_mfma_f32_16x16x32_bf16 v[224:227], v[16:19], a[92:95], v[224:227]
    ds_read_b128 a[64:67], v10 offset:0
    v_mfma_f32_16x16x32_bf16 v[132:135], v[20:23], a[80:83], v[132:135]
    v_perm_b32 v28, v101, v97, s94
    v_perm_b32 v29, v109, v105, s94
    v_mfma_f32_16x16x32_bf16 v[164:167], v[20:23], a[84:87], v[164:167]
    ds_read_b128 a[68:71], v10 offset:1024
    v_mfma_f32_16x16x32_bf16 v[196:199], v[20:23], a[88:91], v[196:199]
    v_perm_b32 v30, v117, v113, s94
    v_perm_b32 v31, v125, v121, s94
    v_mfma_f32_16x16x32_bf16 v[228:231], v[20:23], a[92:95], v[228:231]
    ds_read_b128 a[72:75], v10 offset:2048
    v_mfma_f32_16x16x32_bf16 v[136:139], v[24:27], a[80:83], v[136:139]
    v_perm_b32 v16, v102, v98, s93
    v_perm_b32 v17, v110, v106, s93
    v_mfma_f32_16x16x32_bf16 v[168:171], v[24:27], a[84:87], v[168:171]
    ds_read_b128 a[76:79], v10 offset:3072
    v_mfma_f32_16x16x32_bf16 v[200:203], v[24:27], a[88:91], v[200:203]
    v_perm_b32 v18, v118, v114, s93
    v_perm_b32 v19, v126, v122, s93
    v_mfma_f32_16x16x32_bf16 v[232:235], v[24:27], a[92:95], v[232:235]
    buffer_load_dwordx4 v[84:87], v15, s[24:27], s63 offen offset:1280
    v_mfma_f32_16x16x32_bf16 v[140:143], v[28:31], a[80:83], v[140:143]
    v_perm_b32 v20, v102, v98, s94
    v_perm_b32 v21, v110, v106, s94
    v_mfma_f32_16x16x32_bf16 v[172:175], v[28:31], a[84:87], v[172:175]
    buffer_load_dwordx4 v[88:91], v15, s[24:27], s63 offen offset:2560
    v_mfma_f32_16x16x32_bf16 v[204:207], v[28:31], a[88:91], v[204:207]
    v_perm_b32 v22, v118, v114, s94
    v_perm_b32 v23, v126, v122, s94
    v_mfma_f32_16x16x32_bf16 v[236:239], v[28:31], a[92:95], v[236:239]
    buffer_load_dwordx4 v[92:95], v15, s[24:27], s63 offen offset:3840
    v_mfma_f32_16x16x32_bf16 v[144:147], v[16:19], a[80:83], v[144:147]
    v_perm_b32 v24, v103, v99, s93
    v_perm_b32 v25, v111, v107, s93
    v_mfma_f32_16x16x32_bf16 v[176:179], v[16:19], a[84:87], v[176:179]
    s_and_b32 s95, s95, 0xffff
    v_mfma_f32_16x16x32_bf16 v[208:211], v[16:19], a[88:91], v[208:211]
    v_perm_b32 v26, v119, v115, s93
    v_perm_b32 v27, v127, v123, s93
    v_mfma_f32_16x16x32_bf16 v[240:243], v[16:19], a[92:95], v[240:243]
    s_waitcnt lgkmcnt(0)
    v_mfma_f32_16x16x32_bf16 v[148:151], v[20:23], a[80:83], v[148:151]
    v_perm_b32 v28, v103, v99, s94
    v_perm_b32 v29, v111, v107, s94
    v_mfma_f32_16x16x32_bf16 v[180:183], v[20:23], a[84:87], v[180:183]
    s_waitcnt vmcnt(8)
    v_mfma_f32_16x16x32_bf16 v[212:215], v[20:23], a[88:91], v[212:215]
    v_perm_b32 v30, v119, v115, s94
    v_perm_b32 v31, v127, v123, s94
    v_mfma_f32_16x16x32_bf16 v[244:247], v[20:23], a[92:95], v[244:247]
    buffer_load_dwordx4 v[96:99], v14, s[24:27], s64 offen offset:0
    v_mfma_f32_16x16x32_bf16 v[152:155], v[24:27], a[80:83], v[152:155]
    v_perm_b32 v16, v36, v32, s93
    v_perm_b32 v17, v44, v40, s93
    v_mfma_f32_16x16x32_bf16 v[184:187], v[24:27], a[84:87], v[184:187]
    buffer_load_dwordx4 v[100:103], v14, s[24:27], s64 offen offset:1280
    v_mfma_f32_16x16x32_bf16 v[216:219], v[24:27], a[88:91], v[216:219]
    v_perm_b32 v18, v52, v48, s93
    v_perm_b32 v19, v60, v56, s93
    v_mfma_f32_16x16x32_bf16 v[248:251], v[24:27], a[92:95], v[248:251]
    buffer_load_dwordx4 v[104:107], v14, s[24:27], s64 offen offset:2560
    v_mfma_f32_16x16x32_bf16 v[156:159], v[28:31], a[80:83], v[156:159]
    v_perm_b32 v20, v36, v32, s94
    v_perm_b32 v21, v44, v40, s94
    v_mfma_f32_16x16x32_bf16 v[188:191], v[28:31], a[84:87], v[188:191]
    buffer_load_dwordx4 v[108:111], v14, s[24:27], s64 offen offset:3840
    v_mfma_f32_16x16x32_bf16 v[220:223], v[28:31], a[88:91], v[220:223]
    v_perm_b32 v22, v52, v48, s94
    v_perm_b32 v23, v60, v56, s94
    v_mfma_f32_16x16x32_bf16 v[252:255], v[28:31], a[92:95], v[252:255]
    buffer_load_dwordx4 v[112:115], v15, s[24:27], s64 offen offset:0
    v_mfma_f32_16x16x32_bf16 v[128:131], v[16:19], a[64:67], v[128:131]
    v_perm_b32 v24, v37, v33, s93
    v_perm_b32 v25, v45, v41, s93
    v_mfma_f32_16x16x32_bf16 v[160:163], v[16:19], a[68:71], v[160:163]
    v_add_u32 v10, s95, v11
    s_add_u32 s95, s95, 4096
    v_mfma_f32_16x16x32_bf16 v[192:195], v[16:19], a[72:75], v[192:195]
    v_perm_b32 v26, v53, v49, s93
    v_perm_b32 v27, v61, v57, s93
    v_mfma_f32_16x16x32_bf16 v[224:227], v[16:19], a[76:79], v[224:227]
    ds_read_b128 a[80:83], v10 offset:0
    v_mfma_f32_16x16x32_bf16 v[132:135], v[20:23], a[64:67], v[132:135]
    v_perm_b32 v28, v37, v33, s94
    v_perm_b32 v29, v45, v41, s94
    v_mfma_f32_16x16x32_bf16 v[164:167], v[20:23], a[68:71], v[164:167]
    ds_read_b128 a[84:87], v10 offset:1024
    v_mfma_f32_16x16x32_bf16 v[196:199], v[20:23], a[72:75], v[196:199]
    v_perm_b32 v30, v53, v49, s94
    v_perm_b32 v31, v61, v57, s94
    v_mfma_f32_16x16x32_bf16 v[228:231], v[20:23], a[76:79], v[228:231]
    ds_read_b128 a[88:91], v10 offset:2048
    v_mfma_f32_16x16x32_bf16 v[136:139], v[24:27], a[64:67], v[136:139]
    v_perm_b32 v16, v38, v34, s93
    v_perm_b32 v17, v46, v42, s93
    v_mfma_f32_16x16x32_bf16 v[168:171], v[24:27], a[68:71], v[168:171]
    ds_read_b128 a[92:95], v10 offset:3072
    v_mfma_f32_16x16x32_bf16 v[200:203], v[24:27], a[72:75], v[200:203]
    v_perm_b32 v18, v54, v50, s93
    v_perm_b32 v19, v62, v58, s93
    v_mfma_f32_16x16x32_bf16 v[232:235], v[24:27], a[76:79], v[232:235]
    buffer_load_dwordx4 v[116:119], v15, s[24:27], s64 offen offset:1280
    v_mfma_f32_16x16x32_bf16 v[140:143], v[28:31], a[64:67], v[140:143]
    v_perm_b32 v20, v38, v34, s94
    v_perm_b32 v21, v46, v42, s94
    v_mfma_f32_16x16x32_bf16 v[172:175], v[28:31], a[68:71], v[172:175]
    buffer_load_dwordx4 v[120:123], v15, s[24:27], s64 offen offset:2560
    v_mfma_f32_16x16x32_bf16 v[204:207], v[28:31], a[72:75], v[204:207]
    v_perm_b32 v22, v54, v50, s94
    v_perm_b32 v23, v62, v58, s94
    v_mfma_f32_16x16x32_bf16 v[236:239], v[28:31], a[76:79], v[236:239]
    buffer_load_dwordx4 v[124:127], v15, s[24:27], s64 offen offset:3840
    v_mfma_f32_16x16x32_bf16 v[144:147], v[16:19], a[64:67], v[144:147]
    v_perm_b32 v24, v39, v35, s93
    v_perm_b32 v25, v47, v43, s93
    v_mfma_f32_16x16x32_bf16 v[176:179], v[16:19], a[68:71], v[176:179]
    s_and_b32 s95, s95, 0xffff
    v_mfma_f32_16x16x32_bf16 v[208:211], v[16:19], a[72:75], v[208:211]
    v_perm_b32 v26, v55, v51, s93
    v_perm_b32 v27, v63, v59, s93
    v_mfma_f32_16x16x32_bf16 v[240:243], v[16:19], a[76:79], v[240:243]
    s_waitcnt lgkmcnt(0)
    v_mfma_f32_16x16x32_bf16 v[148:151], v[20:23], a[64:67], v[148:151]
    v_perm_b32 v28, v39, v35, s94
    v_perm_b32 v29, v47, v43, s94
    v_mfma_f32_16x16x32_bf16 v[180:183], v[20:23], a[68:71], v[180:183]
    s_waitcnt vmcnt(8)
    v_mfma_f32_16x16x32_bf16 v[212:215], v[20:23], a[72:75], v[212:215]
    v_perm_b32 v30, v55, v51, s94
    v_perm_b32 v31, v63, v59, s94
    v_mfma_f32_16x16x32_bf16 v[244:247], v[20:23], a[76:79], v[244:247]
    buffer_load_dwordx4 v[32:35], v14, s[24:27], s65 offen offset:0
    v_mfma_f32_16x16x32_bf16 v[152:155], v[24:27], a[64:67], v[152:155]
    v_perm_b32 v16, v68, v64, s93
    v_perm_b32 v17, v76, v72, s93
    v_mfma_f32_16x16x32_bf16 v[184:187], v[24:27], a[68:71], v[184:187]
    buffer_load_dwordx4 v[36:39], v14, s[24:27], s65 offen offset:1280
    v_mfma_f32_16x16x32_bf16 v[216:219], v[24:27], a[72:75], v[216:219]
    v_perm_b32 v18, v84, v80, s93
    v_perm_b32 v19, v92, v88, s93
    v_mfma_f32_16x16x32_bf16 v[248:251], v[24:27], a[76:79], v[248:251]
    buffer_load_dwordx4 v[40:43], v14, s[24:27], s65 offen offset:2560
    v_mfma_f32_16x16x32_bf16 v[156:159], v[28:31], a[64:67], v[156:159]
    v_perm_b32 v20, v68, v64, s94
    v_perm_b32 v21, v76, v72, s94
    v_mfma_f32_16x16x32_bf16 v[188:191], v[28:31], a[68:71], v[188:191]
    buffer_load_dwordx4 v[44:47], v14, s[24:27], s65 offen offset:3840
    v_mfma_f32_16x16x32_bf16 v[220:223], v[28:31], a[72:75], v[220:223]
    v_perm_b32 v22, v84, v80, s94
    v_perm_b32 v23, v92, v88, s94
    v_mfma_f32_16x16x32_bf16 v[252:255], v[28:31], a[76:79], v[252:255]
    buffer_load_dwordx4 v[48:51], v15, s[24:27], s65 offen offset:0
    v_mfma_f32_16x16x32_bf16 v[128:131], v[16:19], a[80:83], v[128:131]
    v_perm_b32 v24, v69, v65, s93
    v_perm_b32 v25, v77, v73, s93
    v_mfma_f32_16x16x32_bf16 v[160:163], v[16:19], a[84:87], v[160:163]
    v_add_u32 v10, s95, v11
    s_add_u32 s95, s95, 4096
    v_mfma_f32_16x16x32_bf16 v[192:195], v[16:19], a[88:91], v[192:195]
    v_perm_b32 v26, v85, v81, s93
    v_perm_b32 v27, v93, v89, s93
    v_mfma_f32_16x16x32_bf16 v[224:227], v[16:19], a[92:95], v[224:227]
    ds_read_b128 a[64:67], v10 offset:0
    v_mfma_f32_16x16x32_bf16 v[132:135], v[20:23], a[80:83], v[132:135]
    v_perm_b32 v28, v69, v65, s94
    v_perm_b32 v29, v77, v73, s94
    v_mfma_f32_16x16x32_bf16 v[164:167], v[20:23], a[84:87], v[164:167]
    ds_read_b128 a[68:71], v10 offset:1024
    v_mfma_f32_16x16x32_bf16 v[196:199], v[20:23], a[88:91], v[196:199]
    v_perm_b32 v30, v85, v81, s94
    v_perm_b32 v31, v93, v89, s94
    v_mfma_f32_16x16x32_bf16 v[228:231], v[20:23], a[92:95], v[228:231]
    ds_read_b128 a[72:75], v10 offset:2048
    v_mfma_f32_16x16x32_bf16 v[136:139], v[24:27], a[80:83], v[136:139]
    v_perm_b32 v16, v70, v66, s93
    v_perm_b32 v17, v78, v74, s93
    v_mfma_f32_16x16x32_bf16 v[168:171], v[24:27], a[84:87], v[168:171]
    ds_read_b128 a[76:79], v10 offset:3072
    v_mfma_f32_16x16x32_bf16 v[200:203], v[24:27], a[88:91], v[200:203]
    v_perm_b32 v18, v86, v82, s93
    v_perm_b32 v19, v94, v90, s93
    v_mfma_f32_16x16x32_bf16 v[232:235], v[24:27], a[92:95], v[232:235]
    buffer_load_dwordx4 v[52:55], v15, s[24:27], s65 offen offset:1280
    v_mfma_f32_16x16x32_bf16 v[140:143], v[28:31], a[80:83], v[140:143]
    v_perm_b32 v20, v70, v66, s94
    v_perm_b32 v21, v78, v74, s94
    v_mfma_f32_16x16x32_bf16 v[172:175], v[28:31], a[84:87], v[172:175]
    buffer_load_dwordx4 v[56:59], v15, s[24:27], s65 offen offset:2560
    v_mfma_f32_16x16x32_bf16 v[204:207], v[28:31], a[88:91], v[204:207]
    v_perm_b32 v22, v86, v82, s94
    v_perm_b32 v23, v94, v90, s94
    v_mfma_f32_16x16x32_bf16 v[236:239], v[28:31], a[92:95], v[236:239]
    buffer_load_dwordx4 v[60:63], v15, s[24:27], s65 offen offset:3840
    v_mfma_f32_16x16x32_bf16 v[144:147], v[16:19], a[80:83], v[144:147]
    v_perm_b32 v24, v71, v67, s93
    v_perm_b32 v25, v79, v75, s93
    v_mfma_f32_16x16x32_bf16 v[176:179], v[16:19], a[84:87], v[176:179]
    s_and_b32 s95, s95, 0xffff
    v_mfma_f32_16x16x32_bf16 v[208:211], v[16:19], a[88:91], v[208:211]
    v_perm_b32 v26, v87, v83, s93
    v_perm_b32 v27, v95, v91, s93
    v_mfma_f32_16x16x32_bf16 v[240:243], v[16:19], a[92:95], v[240:243]
    s_waitcnt lgkmcnt(0)
    v_mfma_f32_16x16x32_bf16 v[148:151], v[20:23], a[80:83], v[148:151]
    v_perm_b32 v28, v71, v67, s94
    v_perm_b32 v29, v79, v75, s94
    v_mfma_f32_16x16x32_bf16 v[180:183], v[20:23], a[84:87], v[180:183]
    s_waitcnt vmcnt(8)
    v_mfma_f32_16x16x32_bf16 v[212:215], v[20:23], a[88:91], v[212:215]
    v_perm_b32 v30, v87, v83, s94
    v_perm_b32 v31, v95, v91, s94
    v_mfma_f32_16x16x32_bf16 v[244:247], v[20:23], a[92:95], v[244:247]
    buffer_load_dwordx4 v[64:67], v14, s[24:27], s66 offen offset:0
    v_mfma_f32_16x16x32_bf16 v[152:155], v[24:27], a[80:83], v[152:155]
    v_perm_b32 v16, v100, v96, s93
    v_perm_b32 v17, v108, v104, s93
    v_mfma_f32_16x16x32_bf16 v[184:187], v[24:27], a[84:87], v[184:187]
    buffer_load_dwordx4 v[68:71], v14, s[24:27], s66 offen offset:1280
    v_mfma_f32_16x16x32_bf16 v[216:219], v[24:27], a[88:91], v[216:219]
    v_perm_b32 v18, v116, v112, s93
    v_perm_b32 v19, v124, v120, s93
    v_mfma_f32_16x16x32_bf16 v[248:251], v[24:27], a[92:95], v[248:251]
    buffer_load_dwordx4 v[72:75], v14, s[24:27], s66 offen offset:2560
    v_mfma_f32_16x16x32_bf16 v[156:159], v[28:31], a[80:83], v[156:159]
    v_perm_b32 v20, v100, v96, s94
    v_perm_b32 v21, v108, v104, s94
    v_mfma_f32_16x16x32_bf16 v[188:191], v[28:31], a[84:87], v[188:191]
    buffer_load_dwordx4 v[76:79], v14, s[24:27], s66 offen offset:3840
    v_mfma_f32_16x16x32_bf16 v[220:223], v[28:31], a[88:91], v[220:223]
    v_perm_b32 v22, v116, v112, s94
    v_perm_b32 v23, v124, v120, s94
    v_mfma_f32_16x16x32_bf16 v[252:255], v[28:31], a[92:95], v[252:255]
    buffer_load_dwordx4 v[80:83], v15, s[24:27], s66 offen offset:0
    v_mfma_f32_16x16x32_bf16 v[128:131], v[16:19], a[64:67], v[128:131]
    v_perm_b32 v24, v101, v97, s93
    v_perm_b32 v25, v109, v105, s93
    v_mfma_f32_16x16x32_bf16 v[160:163], v[16:19], a[68:71], v[160:163]
    v_add_u32 v10, s95, v11
    s_add_u32 s95, s95, 4096
    v_mfma_f32_16x16x32_bf16 v[192:195], v[16:19], a[72:75], v[192:195]
    v_perm_b32 v26, v117, v113, s93
    v_perm_b32 v27, v125, v121, s93
    v_mfma_f32_16x16x32_bf16 v[224:227], v[16:19], a[76:79], v[224:227]
    ds_read_b128 a[80:83], v10 offset:0
    v_mfma_f32_16x16x32_bf16 v[132:135], v[20:23], a[64:67], v[132:135]
    v_perm_b32 v28, v101, v97, s94
    v_perm_b32 v29, v109, v105, s94
    v_mfma_f32_16x16x32_bf16 v[164:167], v[20:23], a[68:71], v[164:167]
    ds_read_b128 a[84:87], v10 offset:1024
    v_mfma_f32_16x16x32_bf16 v[196:199], v[20:23], a[72:75], v[196:199]
    v_perm_b32 v30, v117, v113, s94
    v_perm_b32 v31, v125, v121, s94
    v_mfma_f32_16x16x32_bf16 v[228:231], v[20:23], a[76:79], v[228:231]
    ds_read_b128 a[88:91], v10 offset:2048
    v_mfma_f32_16x16x32_bf16 v[136:139], v[24:27], a[64:67], v[136:139]
    v_perm_b32 v16, v102, v98, s93
    v_perm_b32 v17, v110, v106, s93
    v_mfma_f32_16x16x32_bf16 v[168:171], v[24:27], a[68:71], v[168:171]
    ds_read_b128 a[92:95], v10 offset:3072
    v_mfma_f32_16x16x32_bf16 v[200:203], v[24:27], a[72:75], v[200:203]
    v_perm_b32 v18, v118, v114, s93
    v_perm_b32 v19, v126, v122, s93
    v_mfma_f32_16x16x32_bf16 v[232:235], v[24:27], a[76:79], v[232:235]
    buffer_load_dwordx4 v[84:87], v15, s[24:27], s66 offen offset:1280
    v_mfma_f32_16x16x32_bf16 v[140:143], v[28:31], a[64:67], v[140:143]
    v_perm_b32 v20, v102, v98, s94
    v_perm_b32 v21, v110, v106, s94
    v_mfma_f32_16x16x32_bf16 v[172:175], v[28:31], a[68:71], v[172:175]
    buffer_load_dwordx4 v[88:91], v15, s[24:27], s66 offen offset:2560
    v_mfma_f32_16x16x32_bf16 v[204:207], v[28:31], a[72:75], v[204:207]
    v_perm_b32 v22, v118, v114, s94
    v_perm_b32 v23, v126, v122, s94
    v_mfma_f32_16x16x32_bf16 v[236:239], v[28:31], a[76:79], v[236:239]
    buffer_load_dwordx4 v[92:95], v15, s[24:27], s66 offen offset:3840
    v_mfma_f32_16x16x32_bf16 v[144:147], v[16:19], a[64:67], v[144:147]
    v_perm_b32 v24, v103, v99, s93
    v_perm_b32 v25, v111, v107, s93
    v_mfma_f32_16x16x32_bf16 v[176:179], v[16:19], a[68:71], v[176:179]
    s_and_b32 s95, s95, 0xffff
    v_mfma_f32_16x16x32_bf16 v[208:211], v[16:19], a[72:75], v[208:211]
    v_perm_b32 v26, v119, v115, s93
    v_perm_b32 v27, v127, v123, s93
    v_mfma_f32_16x16x32_bf16 v[240:243], v[16:19], a[76:79], v[240:243]
    s_waitcnt lgkmcnt(0)
    v_mfma_f32_16x16x32_bf16 v[148:151], v[20:23], a[64:67], v[148:151]
    v_perm_b32 v28, v103, v99, s94
    v_perm_b32 v29, v111, v107, s94
    v_mfma_f32_16x16x32_bf16 v[180:183], v[20:23], a[68:71], v[180:183]
    s_waitcnt vmcnt(8)
    v_mfma_f32_16x16x32_bf16 v[212:215], v[20:23], a[72:75], v[212:215]
    v_perm_b32 v30, v119, v115, s94
    v_perm_b32 v31, v127, v123, s94
    v_mfma_f32_16x16x32_bf16 v[244:247], v[20:23], a[76:79], v[244:247]
    buffer_load_dwordx4 v[96:99], v14, s[24:27], s67 offen offset:0
    v_mfma_f32_16x16x32_bf16 v[152:155], v[24:27], a[64:67], v[152:155]
    v_perm_b32 v16, v36, v32, s93
    v_perm_b32 v17, v44, v40, s93
    v_mfma_f32_16x16x32_bf16 v[184:187], v[24:27], a[68:71], v[184:187]
    buffer_load_dwordx4 v[100:103], v14, s[24:27], s67 offen offset:1280
    v_mfma_f32_16x16x32_bf16 v[216:219], v[24:27], a[72:75], v[216:219]
    v_perm_b32 v18, v52, v48, s93
    v_perm_b32 v19, v60, v56, s93
    v_mfma_f32_16x16x32_bf16 v[248:251], v[24:27], a[76:79], v[248:251]
    buffer_load_dwordx4 v[104:107], v14, s[24:27], s67 offen offset:2560
    v_mfma_f32_16x16x32_bf16 v[156:159], v[28:31], a[64:67], v[156:159]
    v_perm_b32 v20, v36, v32, s94
    v_perm_b32 v21, v44, v40, s94
    v_mfma_f32_16x16x32_bf16 v[188:191], v[28:31], a[68:71], v[188:191]
    buffer_load_dwordx4 v[108:111], v14, s[24:27], s67 offen offset:3840
    v_mfma_f32_16x16x32_bf16 v[220:223], v[28:31], a[72:75], v[220:223]
    v_perm_b32 v22, v52, v48, s94
    v_perm_b32 v23, v60, v56, s94
    v_mfma_f32_16x16x32_bf16 v[252:255], v[28:31], a[76:79], v[252:255]
    buffer_load_dwordx4 v[112:115], v15, s[24:27], s67 offen offset:0
    v_mfma_f32_16x16x32_bf16 v[128:131], v[16:19], a[80:83], v[128:131]
    v_perm_b32 v24, v37, v33, s93
    v_perm_b32 v25, v45, v41, s93
    v_mfma_f32_16x16x32_bf16 v[160:163], v[16:19], a[84:87], v[160:163]
    v_add_u32 v10, s95, v11
    s_add_u32 s95, s95, 4096
    v_mfma_f32_16x16x32_bf16 v[192:195], v[16:19], a[88:91], v[192:195]
    v_perm_b32 v26, v53, v49, s93
    v_perm_b32 v27, v61, v57, s93
    v_mfma_f32_16x16x32_bf16 v[224:227], v[16:19], a[92:95], v[224:227]
    ds_read_b128 a[64:67], v10 offset:0
    v_mfma_f32_16x16x32_bf16 v[132:135], v[20:23], a[80:83], v[132:135]
    v_perm_b32 v28, v37, v33, s94
    v_perm_b32 v29, v45, v41, s94
    v_mfma_f32_16x16x32_bf16 v[164:167], v[20:23], a[84:87], v[164:167]
    ds_read_b128 a[68:71], v10 offset:1024
    v_mfma_f32_16x16x32_bf16 v[196:199], v[20:23], a[88:91], v[196:199]
    v_perm_b32 v30, v53, v49, s94
    v_perm_b32 v31, v61, v57, s94
    v_mfma_f32_16x16x32_bf16 v[228:231], v[20:23], a[92:95], v[228:231]
    ds_read_b128 a[72:75], v10 offset:2048
    v_mfma_f32_16x16x32_bf16 v[136:139], v[24:27], a[80:83], v[136:139]
    v_perm_b32 v16, v38, v34, s93
    v_perm_b32 v17, v46, v42, s93
    v_mfma_f32_16x16x32_bf16 v[168:171], v[24:27], a[84:87], v[168:171]
    ds_read_b128 a[76:79], v10 offset:3072
    v_mfma_f32_16x16x32_bf16 v[200:203], v[24:27], a[88:91], v[200:203]
    v_perm_b32 v18, v54, v50, s93
    v_perm_b32 v19, v62, v58, s93
    v_mfma_f32_16x16x32_bf16 v[232:235], v[24:27], a[92:95], v[232:235]
    buffer_load_dwordx4 v[116:119], v15, s[24:27], s67 offen offset:1280
    v_mfma_f32_16x16x32_bf16 v[140:143], v[28:31], a[80:83], v[140:143]
    v_perm_b32 v20, v38, v34, s94
    v_perm_b32 v21, v46, v42, s94
    v_mfma_f32_16x16x32_bf16 v[172:175], v[28:31], a[84:87], v[172:175]
    buffer_load_dwordx4 v[120:123], v15, s[24:27], s67 offen offset:2560
    v_mfma_f32_16x16x32_bf16 v[204:207], v[28:31], a[88:91], v[204:207]
    v_perm_b32 v22, v54, v50, s94
    v_perm_b32 v23, v62, v58, s94
    v_mfma_f32_16x16x32_bf16 v[236:239], v[28:31], a[92:95], v[236:239]
    buffer_load_dwordx4 v[124:127], v15, s[24:27], s67 offen offset:3840
    v_mfma_f32_16x16x32_bf16 v[144:147], v[16:19], a[80:83], v[144:147]
    v_perm_b32 v24, v39, v35, s93
    v_perm_b32 v25, v47, v43, s93
    v_mfma_f32_16x16x32_bf16 v[176:179], v[16:19], a[84:87], v[176:179]
    s_and_b32 s95, s95, 0xffff
    v_mfma_f32_16x16x32_bf16 v[208:211], v[16:19], a[88:91], v[208:211]
    v_perm_b32 v26, v55, v51, s93
    v_perm_b32 v27, v63, v59, s93
    v_mfma_f32_16x16x32_bf16 v[240:243], v[16:19], a[92:95], v[240:243]
    s_waitcnt lgkmcnt(0)
    v_mfma_f32_16x16x32_bf16 v[148:151], v[20:23], a[80:83], v[148:151]
    v_perm_b32 v28, v39, v35, s94
    v_perm_b32 v29, v47, v43, s94
    v_mfma_f32_16x16x32_bf16 v[180:183], v[20:23], a[84:87], v[180:183]
    s_waitcnt vmcnt(8)
    v_mfma_f32_16x16x32_bf16 v[212:215], v[20:23], a[88:91], v[212:215]
    v_perm_b32 v30, v55, v51, s94
    v_perm_b32 v31, v63, v59, s94
    v_mfma_f32_16x16x32_bf16 v[244:247], v[20:23], a[92:95], v[244:247]
    buffer_load_dwordx4 v[32:35], v14, s[24:27], s68 offen offset:0
    v_mfma_f32_16x16x32_bf16 v[152:155], v[24:27], a[80:83], v[152:155]
    v_perm_b32 v16, v68, v64, s93
    v_perm_b32 v17, v76, v72, s93
    v_mfma_f32_16x16x32_bf16 v[184:187], v[24:27], a[84:87], v[184:187]
    buffer_load_dwordx4 v[36:39], v14, s[24:27], s68 offen offset:1280
    v_mfma_f32_16x16x32_bf16 v[216:219], v[24:27], a[88:91], v[216:219]
    v_perm_b32 v18, v84, v80, s93
    v_perm_b32 v19, v92, v88, s93
    v_mfma_f32_16x16x32_bf16 v[248:251], v[24:27], a[92:95], v[248:251]
    buffer_load_dwordx4 v[40:43], v14, s[24:27], s68 offen offset:2560
    v_mfma_f32_16x16x32_bf16 v[156:159], v[28:31], a[80:83], v[156:159]
    v_perm_b32 v20, v68, v64, s94
    v_perm_b32 v21, v76, v72, s94
    v_mfma_f32_16x16x32_bf16 v[188:191], v[28:31], a[84:87], v[188:191]
    buffer_load_dwordx4 v[44:47], v14, s[24:27], s68 offen offset:3840
    v_mfma_f32_16x16x32_bf16 v[220:223], v[28:31], a[88:91], v[220:223]
    v_perm_b32 v22, v84, v80, s94
    v_perm_b32 v23, v92, v88, s94
    v_mfma_f32_16x16x32_bf16 v[252:255], v[28:31], a[92:95], v[252:255]
    buffer_load_dwordx4 v[48:51], v15, s[24:27], s68 offen offset:0
    v_mfma_f32_16x16x32_bf16 v[128:131], v[16:19], a[64:67], v[128:131]
    v_perm_b32 v24, v69, v65, s93
    v_perm_b32 v25, v77, v73, s93
    v_mfma_f32_16x16x32_bf16 v[160:163], v[16:19], a[68:71], v[160:163]
    v_add_u32 v10, s95, v11
    s_add_u32 s95, s95, 4096
    v_mfma_f32_16x16x32_bf16 v[192:195], v[16:19], a[72:75], v[192:195]
    v_perm_b32 v26, v85, v81, s93
    v_perm_b32 v27, v93, v89, s93
    v_mfma_f32_16x16x32_bf16 v[224:227], v[16:19], a[76:79], v[224:227]
    ds_read_b128 a[80:83], v10 offset:0
    v_mfma_f32_16x16x32_bf16 v[132:135], v[20:23], a[64:67], v[132:135]
    v_perm_b32 v28, v69, v65, s94
    v_perm_b32 v29, v77, v73, s94
    v_mfma_f32_16x16x32_bf16 v[164:167], v[20:23], a[68:71], v[164:167]
    ds_read_b128 a[84:87], v10 offset:1024
    v_mfma_f32_16x16x32_bf16 v[196:199], v[20:23], a[72:75], v[196:199]
    v_perm_b32 v30, v85, v81, s94
    v_perm_b32 v31, v93, v89, s94
    v_mfma_f32_16x16x32_bf16 v[228:231], v[20:23], a[76:79], v[228:231]
    ds_read_b128 a[88:91], v10 offset:2048
    v_mfma_f32_16x16x32_bf16 v[136:139], v[24:27], a[64:67], v[136:139]
    v_perm_b32 v16, v70, v66, s93
    v_perm_b32 v17, v78, v74, s93
    v_mfma_f32_16x16x32_bf16 v[168:171], v[24:27], a[68:71], v[168:171]
    ds_read_b128 a[92:95], v10 offset:3072
    v_mfma_f32_16x16x32_bf16 v[200:203], v[24:27], a[72:75], v[200:203]
    v_perm_b32 v18, v86, v82, s93
    v_perm_b32 v19, v94, v90, s93
    v_mfma_f32_16x16x32_bf16 v[232:235], v[24:27], a[76:79], v[232:235]
    buffer_load_dwordx4 v[52:55], v15, s[24:27], s68 offen offset:1280
    v_mfma_f32_16x16x32_bf16 v[140:143], v[28:31], a[64:67], v[140:143]
    v_perm_b32 v20, v70, v66, s94
    v_perm_b32 v21, v78, v74, s94
    v_mfma_f32_16x16x32_bf16 v[172:175], v[28:31], a[68:71], v[172:175]
    buffer_load_dwordx4 v[56:59], v15, s[24:27], s68 offen offset:2560
    v_mfma_f32_16x16x32_bf16 v[204:207], v[28:31], a[72:75], v[204:207]
    v_perm_b32 v22, v86, v82, s94
    v_perm_b32 v23, v94, v90, s94
    v_mfma_f32_16x16x32_bf16 v[236:239], v[28:31], a[76:79], v[236:239]
    buffer_load_dwordx4 v[60:63], v15, s[24:27], s68 offen offset:3840
    v_mfma_f32_16x16x32_bf16 v[144:147], v[16:19], a[64:67], v[144:147]
    v_perm_b32 v24, v71, v67, s93
    v_perm_b32 v25, v79, v75, s93
    v_mfma_f32_16x16x32_bf16 v[176:179], v[16:19], a[68:71], v[176:179]
    s_and_b32 s95, s95, 0xffff
    v_mfma_f32_16x16x32_bf16 v[208:211], v[16:19], a[72:75], v[208:211]
    v_perm_b32 v26, v87, v83, s93
    v_perm_b32 v27, v95, v91, s93
    v_mfma_f32_16x16x32_bf16 v[240:243], v[16:19], a[76:79], v[240:243]
    s_waitcnt lgkmcnt(0)
    v_mfma_f32_16x16x32_bf16 v[148:151], v[20:23], a[64:67], v[148:151]
    v_perm_b32 v28, v71, v67, s94
    v_perm_b32 v29, v79, v75, s94
    v_mfma_f32_16x16x32_bf16 v[180:183], v[20:23], a[68:71], v[180:183]
    s_waitcnt vmcnt(8)
    v_mfma_f32_16x16x32_bf16 v[212:215], v[20:23], a[72:75], v[212:215]
    v_perm_b32 v30, v87, v83, s94
    v_perm_b32 v31, v95, v91, s94
    v_mfma_f32_16x16x32_bf16 v[244:247], v[20:23], a[76:79], v[244:247]
    buffer_load_dwordx4 v[64:67], v14, s[24:27], s69 offen offset:0
    v_mfma_f32_16x16x32_bf16 v[152:155], v[24:27], a[64:67], v[152:155]
    v_perm_b32 v16, v100, v96, s93
    v_perm_b32 v17, v108, v104, s93
    v_mfma_f32_16x16x32_bf16 v[184:187], v[24:27], a[68:71], v[184:187]
    buffer_load_dwordx4 v[68:71], v14, s[24:27], s69 offen offset:1280
    v_mfma_f32_16x16x32_bf16 v[216:219], v[24:27], a[72:75], v[216:219]
    v_perm_b32 v18, v116, v112, s93
    v_perm_b32 v19, v124, v120, s93
    v_mfma_f32_16x16x32_bf16 v[248:251], v[24:27], a[76:79], v[248:251]
    buffer_load_dwordx4 v[72:75], v14, s[24:27], s69 offen offset:2560
    v_mfma_f32_16x16x32_bf16 v[156:159], v[28:31], a[64:67], v[156:159]
    v_perm_b32 v20, v100, v96, s94
    v_perm_b32 v21, v108, v104, s94
    v_mfma_f32_16x16x32_bf16 v[188:191], v[28:31], a[68:71], v[188:191]
    buffer_load_dwordx4 v[76:79], v14, s[24:27], s69 offen offset:3840
    v_mfma_f32_16x16x32_bf16 v[220:223], v[28:31], a[72:75], v[220:223]
    v_perm_b32 v22, v116, v112, s94
    v_perm_b32 v23, v124, v120, s94
    v_mfma_f32_16x16x32_bf16 v[252:255], v[28:31], a[76:79], v[252:255]
    buffer_load_dwordx4 v[80:83], v15, s[24:27], s69 offen offset:0
    v_mfma_f32_16x16x32_bf16 v[128:131], v[16:19], a[80:83], v[128:131]
    v_perm_b32 v24, v101, v97, s93
    v_perm_b32 v25, v109, v105, s93
    v_mfma_f32_16x16x32_bf16 v[160:163], v[16:19], a[84:87], v[160:163]
    ds_read_b128 a[64:67], v2 offset:0
    v_mfma_f32_16x16x32_bf16 v[192:195], v[16:19], a[88:91], v[192:195]
    v_perm_b32 v26, v117, v113, s93
    v_perm_b32 v27, v125, v121, s93
    v_mfma_f32_16x16x32_bf16 v[224:227], v[16:19], a[92:95], v[224:227]
    ds_read_b128 a[68:71], v3 offset:0
    v_mfma_f32_16x16x32_bf16 v[132:135], v[20:23], a[80:83], v[132:135]
    v_perm_b32 v28, v101, v97, s94
    v_perm_b32 v29, v109, v105, s94
    v_mfma_f32_16x16x32_bf16 v[164:167], v[20:23], a[84:87], v[164:167]
    ds_read_b128 a[72:75], v4 offset:0
    v_mfma_f32_16x16x32_bf16 v[196:199], v[20:23], a[88:91], v[196:199]
    v_perm_b32 v30, v117, v113, s94
    v_perm_b32 v31, v125, v121, s94
    v_mfma_f32_16x16x32_bf16 v[228:231], v[20:23], a[92:95], v[228:231]
    ds_read_b128 a[76:79], v5 offset:0
    v_mfma_f32_16x16x32_bf16 v[136:139], v[24:27], a[80:83], v[136:139]
    v_perm_b32 v16, v102, v98, s93
    v_perm_b32 v17, v110, v106, s93
    v_mfma_f32_16x16x32_bf16 v[168:171], v[24:27], a[84:87], v[168:171]
    v_mfma_f32_16x16x32_bf16 v[200:203], v[24:27], a[88:91], v[200:203]
    v_perm_b32 v18, v118, v114, s93
    v_perm_b32 v19, v126, v122, s93
    v_mfma_f32_16x16x32_bf16 v[232:235], v[24:27], a[92:95], v[232:235]
    buffer_load_dwordx4 v[84:87], v15, s[24:27], s69 offen offset:1280
    v_mfma_f32_16x16x32_bf16 v[140:143], v[28:31], a[80:83], v[140:143]
    v_perm_b32 v20, v102, v98, s94
    v_perm_b32 v21, v110, v106, s94
    v_mfma_f32_16x16x32_bf16 v[172:175], v[28:31], a[84:87], v[172:175]
    buffer_load_dwordx4 v[88:91], v15, s[24:27], s69 offen offset:2560
    v_mfma_f32_16x16x32_bf16 v[204:207], v[28:31], a[88:91], v[204:207]
    v_perm_b32 v22, v118, v114, s94
    v_perm_b32 v23, v126, v122, s94
    v_mfma_f32_16x16x32_bf16 v[236:239], v[28:31], a[92:95], v[236:239]
    buffer_load_dwordx4 v[92:95], v15, s[24:27], s69 offen offset:3840
    v_mfma_f32_16x16x32_bf16 v[144:147], v[16:19], a[80:83], v[144:147]
    v_perm_b32 v24, v103, v99, s93
    v_perm_b32 v25, v111, v107, s93
    v_mfma_f32_16x16x32_bf16 v[176:179], v[16:19], a[84:87], v[176:179]
    v_mfma_f32_16x16x32_bf16 v[208:211], v[16:19], a[88:91], v[208:211]
    v_perm_b32 v26, v119, v115, s93
    v_perm_b32 v27, v127, v123, s93
    v_mfma_f32_16x16x32_bf16 v[240:243], v[16:19], a[92:95], v[240:243]
    s_waitcnt lgkmcnt(0)
    v_mfma_f32_16x16x32_bf16 v[148:151], v[20:23], a[80:83], v[148:151]
    v_perm_b32 v28, v103, v99, s94
    v_perm_b32 v29, v111, v107, s94
    v_mfma_f32_16x16x32_bf16 v[180:183], v[20:23], a[84:87], v[180:183]
    s_waitcnt vmcnt(8)
    v_mfma_f32_16x16x32_bf16 v[212:215], v[20:23], a[88:91], v[212:215]
    v_perm_b32 v30, v119, v115, s94
    v_perm_b32 v31, v127, v123, s94
    v_mfma_f32_16x16x32_bf16 v[244:247], v[20:23], a[92:95], v[244:247]
    buffer_load_dwordx4 v[96:99], v14, s[24:27], s70 offen offset:0
    v_mfma_f32_16x16x32_bf16 v[152:155], v[24:27], a[80:83], v[152:155]
    v_perm_b32 v16, v36, v32, s93
    v_perm_b32 v17, v44, v40, s93
    v_mfma_f32_16x16x32_bf16 v[184:187], v[24:27], a[84:87], v[184:187]
    buffer_load_dwordx4 v[100:103], v14, s[24:27], s70 offen offset:1280
    v_mfma_f32_16x16x32_bf16 v[216:219], v[24:27], a[88:91], v[216:219]
    v_perm_b32 v18, v52, v48, s93
    v_perm_b32 v19, v60, v56, s93
    v_mfma_f32_16x16x32_bf16 v[248:251], v[24:27], a[92:95], v[248:251]
    buffer_load_dwordx4 v[104:107], v14, s[24:27], s70 offen offset:2560
    v_mfma_f32_16x16x32_bf16 v[156:159], v[28:31], a[80:83], v[156:159]
    v_perm_b32 v20, v36, v32, s94
    v_perm_b32 v21, v44, v40, s94
    v_mfma_f32_16x16x32_bf16 v[188:191], v[28:31], a[84:87], v[188:191]
    buffer_load_dwordx4 v[108:111], v14, s[24:27], s70 offen offset:3840
    v_mfma_f32_16x16x32_bf16 v[220:223], v[28:31], a[88:91], v[220:223]
    v_perm_b32 v22, v52, v48, s94
    v_perm_b32 v23, v60, v56, s94
    v_mfma_f32_16x16x32_bf16 v[252:255], v[28:31], a[92:95], v[252:255]
    buffer_load_dwordx4 v[112:115], v15, s[24:27], s70 offen offset:0
    s_lshl_b32 s6, s3, 14
    s_add_u32 s6, s6, s92
    s_add_u32 s32, s6, 0
    s_add_u32 s33, s6, 4096
    s_add_u32 s34, s6, 8192
    s_add_u32 s35, s6, 12288
    v_lshrrev_b32 v10, 9, v11
    s_lshr_b32 s41, s5, 1
    v_mul_u32_u24 v10, 1536, v10
    s_bitcmp1_b32 s5, 0
    s_cselect_b32 s48, 0, -1
    s_cselect_b32 s49, -1, 0
    v_add_u32 v10, v10, v11
    v_mfma_f32_16x16x32_bf16 a[128:131], v[16:19], a[64:67], 0
    v_perm_b32 v24, v37, v33, s93
    v_perm_b32 v25, v45, v41, s93
    v_mfma_f32_16x16x32_bf16 a[160:163], v[16:19], a[68:71], 0
    ds_read_b128 a[80:83], v2 offset:4096
    v_mfma_f32_16x16x32_bf16 a[192:195], v[16:19], a[72:75], 0
    v_perm_b32 v26, v53, v49, s93
    v_perm_b32 v27, v61, v57, s93
    v_mfma_f32_16x16x32_bf16 a[224:227], v[16:19], a[76:79], 0
    ds_read_b128 a[84:87], v3 offset:4096
    v_mfma_f32_16x16x32_bf16 a[132:135], v[20:23], a[64:67], 0
    v_perm_b32 v28, v37, v33, s94
    v_perm_b32 v29, v45, v41, s94
    v_mfma_f32_16x16x32_bf16 a[164:167], v[20:23], a[68:71], 0
    ds_read_b128 a[88:91], v4 offset:4096
    v_mfma_f32_16x16x32_bf16 a[196:199], v[20:23], a[72:75], 0
    v_perm_b32 v30, v53, v49, s94
    v_perm_b32 v31, v61, v57, s94
    v_mfma_f32_16x16x32_bf16 a[228:231], v[20:23], a[76:79], 0
    ds_read_b128 a[92:95], v5 offset:4096
    v_mfma_f32_16x16x32_bf16 a[136:139], v[24:27], a[64:67], 0
    v_perm_b32 v16, v38, v34, s93
    v_perm_b32 v17, v46, v42, s93
    v_mfma_f32_16x16x32_bf16 a[168:171], v[24:27], a[68:71], 0
    v_mfma_f32_16x16x32_bf16 a[200:203], v[24:27], a[72:75], 0
    v_perm_b32 v18, v54, v50, s93
    v_perm_b32 v19, v62, v58, s93
    v_mfma_f32_16x16x32_bf16 a[232:235], v[24:27], a[76:79], 0
    buffer_load_dwordx4 v[116:119], v15, s[24:27], s70 offen offset:1280
    v_mfma_f32_16x16x32_bf16 a[140:143], v[28:31], a[64:67], 0
    v_perm_b32 v20, v38, v34, s94
    v_perm_b32 v21, v46, v42, s94
    v_mfma_f32_16x16x32_bf16 a[172:175], v[28:31], a[68:71], 0
    buffer_load_dwordx4 v[120:123], v15, s[24:27], s70 offen offset:2560
    s_lshr_b32 s36, s2, 3
    v_mfma_f32_16x16x32_bf16 a[204:207], v[28:31], a[72:75], 0
    v_perm_b32 v22, v54, v50, s94
    v_perm_b32 v23, v62, v58, s94
    v_mfma_f32_16x16x32_bf16 a[236:239], v[28:31], a[76:79], 0
    buffer_load_dwordx4 v[124:127], v15, s[24:27], s70 offen offset:3840
    s_lshl_b32 s36, s36, 2
    v_mfma_f32_16x16x32_bf16 a[144:147], v[16:19], a[64:67], 0
    v_perm_b32 v24, v39, v35, s93
    v_perm_b32 v25, v47, v43, s93
    v_mfma_f32_16x16x32_bf16 a[176:179], v[16:19], a[68:71], 0
    s_add_u32 s36, s36, 128
    v_mfma_f32_16x16x32_bf16 a[208:211], v[16:19], a[72:75], 0
    v_perm_b32 v26, v55, v51, s93
    v_perm_b32 v27, v63, v59, s93
    v_mfma_f32_16x16x32_bf16 a[240:243], v[16:19], a[76:79], 0
    s_waitcnt lgkmcnt(0)
    v_mfma_f32_16x16x32_bf16 a[148:151], v[20:23], a[64:67], 0
    v_perm_b32 v28, v39, v35, s94
    v_perm_b32 v29, v47, v43, s94
    v_mfma_f32_16x16x32_bf16 a[180:183], v[20:23], a[68:71], 0
    s_waitcnt vmcnt(8)
    v_mfma_f32_16x16x32_bf16 a[212:215], v[20:23], a[72:75], 0
    v_perm_b32 v30, v55, v51, s94
    v_perm_b32 v31, v63, v59, s94
    v_mfma_f32_16x16x32_bf16 a[244:247], v[20:23], a[76:79], 0
    buffer_load_dwordx4 v[32:35], v14, s[24:27], s71 offen offset:0
    v_mfma_f32_16x16x32_bf16 a[152:155], v[24:27], a[64:67], 0
    v_perm_b32 v16, v68, v64, s93
    v_perm_b32 v17, v76, v72, s93
    v_mfma_f32_16x16x32_bf16 a[184:187], v[24:27], a[68:71], 0
    buffer_load_dwordx4 v[36:39], v14, s[24:27], s71 offen offset:1280
    v_mfma_f32_16x16x32_bf16 a[216:219], v[24:27], a[72:75], 0
    v_perm_b32 v18, v84, v80, s93
    v_perm_b32 v19, v92, v88, s93
    v_mfma_f32_16x16x32_bf16 a[248:251], v[24:27], a[76:79], 0
    buffer_load_dwordx4 v[40:43], v14, s[24:27], s71 offen offset:2560
    v_mfma_f32_16x16x32_bf16 a[156:159], v[28:31], a[64:67], 0
    v_perm_b32 v20, v68, v64, s94
    v_perm_b32 v21, v76, v72, s94
    v_mfma_f32_16x16x32_bf16 a[188:191], v[28:31], a[68:71], 0
    buffer_load_dwordx4 v[44:47], v14, s[24:27], s71 offen offset:3840
    v_mfma_f32_16x16x32_bf16 a[220:223], v[28:31], a[72:75], 0
    v_perm_b32 v22, v84, v80, s94
    v_perm_b32 v23, v92, v88, s94
    v_mfma_f32_16x16x32_bf16 a[252:255], v[28:31], a[76:79], 0
    buffer_load_dwordx4 v[48:51], v15, s[24:27], s71 offen offset:0
    buffer_load_dword a96, off, s[16:19], s36 sc1
    v_mfma_f32_16x16x32_bf16 a[128:131], v[16:19], a[80:83], a[128:131]
    v_perm_b32 v24, v69, v65, s93
    v_perm_b32 v25, v77, v73, s93
    v_mfma_f32_16x16x32_bf16 a[160:163], v[16:19], a[84:87], a[160:163]
    ds_read_b128 a[64:67], v2 offset:8192
    v_mfma_f32_16x16x32_bf16 a[192:195], v[16:19], a[88:91], a[192:195]
    v_perm_b32 v26, v85, v81, s93
    v_perm_b32 v27, v93, v89, s93
    v_mfma_f32_16x16x32_bf16 a[224:227], v[16:19], a[92:95], a[224:227]
    ds_read_b128 a[68:71], v3 offset:8192
    v_mfma_f32_16x16x32_bf16 a[132:135], v[20:23], a[80:83], a[132:135]
    v_perm_b32 v28, v69, v65, s94
    v_perm_b32 v29, v77, v73, s94
    v_mfma_f32_16x16x32_bf16 a[164:167], v[20:23], a[84:87], a[164:167]
    ds_read_b128 a[72:75], v4 offset:8192
    v_mfma_f32_16x16x32_bf16 a[196:199], v[20:23], a[88:91], a[196:199]
    v_perm_b32 v30, v85, v81, s94
    v_perm_b32 v31, v93, v89, s94
    v_mfma_f32_16x16x32_bf16 a[228:231], v[20:23], a[92:95], a[228:231]
    ds_read_b128 a[76:79], v5 offset:8192
    v_mfma_f32_16x16x32_bf16 a[136:139], v[24:27], a[80:83], a[136:139]
    v_perm_b32 v16, v70, v66, s93
    v_perm_b32 v17, v78, v74, s93
    v_mfma_f32_16x16x32_bf16 a[168:171], v[24:27], a[84:87], a[168:171]
    v_mfma_f32_16x16x32_bf16 a[200:203], v[24:27], a[88:91], a[200:203]
    v_perm_b32 v18, v86, v82, s93
    v_perm_b32 v19, v94, v90, s93
    v_mfma_f32_16x16x32_bf16 a[232:235], v[24:27], a[92:95], a[232:235]
    buffer_load_dwordx4 v[52:55], v15, s[24:27], s71 offen offset:1280
    v_mfma_f32_16x16x32_bf16 a[140:143], v[28:31], a[80:83], a[140:143]
    v_perm_b32 v20, v70, v66, s94
    v_perm_b32 v21, v78, v74, s94
    v_mfma_f32_16x16x32_bf16 a[172:175], v[28:31], a[84:87], a[172:175]
    buffer_load_dwordx4 v[56:59], v15, s[24:27], s71 offen offset:2560
    v_mfma_f32_16x16x32_bf16 a[204:207], v[28:31], a[88:91], a[204:207]
    v_perm_b32 v22, v86, v82, s94
    v_perm_b32 v23, v94, v90, s94
    v_mfma_f32_16x16x32_bf16 a[236:239], v[28:31], a[92:95], a[236:239]
    buffer_load_dwordx4 v[60:63], v15, s[24:27], s71 offen offset:3840
    v_mfma_f32_16x16x32_bf16 a[144:147], v[16:19], a[80:83], a[144:147]
    v_perm_b32 v24, v71, v67, s93
    v_perm_b32 v25, v79, v75, s93
    v_mfma_f32_16x16x32_bf16 a[176:179], v[16:19], a[84:87], a[176:179]
    v_cvt_pk_bf16_f32 v6, v128, v132
    v_mfma_f32_16x16x32_bf16 a[208:211], v[16:19], a[88:91], a[208:211]
    v_perm_b32 v26, v87, v83, s93
    v_perm_b32 v27, v95, v91, s93
    v_cvt_pk_bf16_f32 v7, v136, v140
    s_cmp_eq_u32 s41, 0
    s_cselect_b64 s[58:59], s[48:49], 0
    v_mfma_f32_16x16x32_bf16 a[240:243], v[16:19], a[92:95], a[240:243]
    s_waitcnt lgkmcnt(0)
    v_cvt_pk_bf16_f32 v8, v144, v148
    v_cndmask_b32 v1, v10, 2.0, s[58:59]
    v_mfma_f32_16x16x32_bf16 a[148:151], v[20:23], a[80:83], a[148:151]
    v_perm_b32 v28, v71, v67, s94
    v_perm_b32 v29, v79, v75, s94
    v_cvt_pk_bf16_f32 v9, v152, v156
    v_mfma_f32_16x16x32_bf16 a[180:183], v[20:23], a[84:87], a[180:183]
    s_waitcnt vmcnt(9)
    buffer_store_dwordx4 v[6:9], v1, s[28:31], s32 offen offset:0 sc1
    v_mfma_f32_16x16x32_bf16 a[212:215], v[20:23], a[88:91], a[212:215]
    v_perm_b32 v30, v87, v83, s94
    v_perm_b32 v31, v95, v91, s94
    v_cvt_pk_bf16_f32 v12, v129, v133
    v_mfma_f32_16x16x32_bf16 a[244:247], v[20:23], a[92:95], a[244:247]
    v_cvt_pk_bf16_f32 v13, v137, v141
    v_mfma_f32_16x16x32_bf16 a[152:155], v[24:27], a[80:83], a[152:155]
    v_perm_b32 v16, v100, v96, s93
    v_perm_b32 v17, v108, v104, s93
    v_cvt_pk_bf16_f32 v14, v145, v149
    v_mfma_f32_16x16x32_bf16 a[184:187], v[24:27], a[84:87], a[184:187]
    v_cvt_pk_bf16_f32 v15, v153, v157
    v_mfma_f32_16x16x32_bf16 a[216:219], v[24:27], a[88:91], a[216:219]
    v_perm_b32 v18, v116, v112, s93
    v_perm_b32 v19, v124, v120, s93
    buffer_store_dwordx4 v[12:15], v1, s[28:31], s32 offen offset:512 sc1
    v_mfma_f32_16x16x32_bf16 a[248:251], v[24:27], a[92:95], a[248:251]
    v_cvt_pk_bf16_f32 v6, v130, v134
    v_mfma_f32_16x16x32_bf16 a[156:159], v[28:31], a[80:83], a[156:159]
    v_perm_b32 v20, v100, v96, s94
    v_perm_b32 v21, v108, v104, s94
    v_cvt_pk_bf16_f32 v7, v138, v142
    v_mfma_f32_16x16x32_bf16 a[188:191], v[28:31], a[84:87], a[188:191]
    v_cvt_pk_bf16_f32 v8, v146, v150
    v_mfma_f32_16x16x32_bf16 a[220:223], v[28:31], a[88:91], a[220:223]
    v_perm_b32 v22, v116, v112, s94
    v_perm_b32 v23, v124, v120, s94
    v_cvt_pk_bf16_f32 v9, v154, v158
    v_mfma_f32_16x16x32_bf16 a[252:255], v[28:31], a[92:95], a[252:255]
    buffer_store_dwordx4 v[6:9], v1, s[28:31], s32 offen offset:1024 sc1
    v_mfma_f32_16x16x32_bf16 a[128:131], v[16:19], a[64:67], a[128:131]
    v_perm_b32 v24, v101, v97, s93
    v_perm_b32 v25, v109, v105, s93
    v_cvt_pk_bf16_f32 v12, v131, v135
    v_mfma_f32_16x16x32_bf16 a[160:163], v[16:19], a[68:71], a[160:163]
    ds_read_b128 a[80:83], v2 offset:12288
    v_cvt_pk_bf16_f32 v13, v139, v143
    v_mfma_f32_16x16x32_bf16 a[192:195], v[16:19], a[72:75], a[192:195]
    v_perm_b32 v26, v117, v113, s93
    v_perm_b32 v27, v125, v121, s93
    v_cvt_pk_bf16_f32 v14, v147, v151
    v_mfma_f32_16x16x32_bf16 a[224:227], v[16:19], a[76:79], a[224:227]
    ds_read_b128 a[84:87], v3 offset:12288
    v_cvt_pk_bf16_f32 v15, v155, v159
    v_mfma_f32_16x16x32_bf16 a[132:135], v[20:23], a[64:67], a[132:135]
    v_perm_b32 v28, v101, v97, s94
    v_perm_b32 v29, v109, v105, s94
    buffer_store_dwordx4 v[12:15], v1, s[28:31], s32 offen offset:1536 sc1
    v_mfma_f32_16x16x32_bf16 a[164:167], v[20:23], a[68:71], a[164:167]
    ds_read_b128 a[88:91], v4 offset:12288
    v_cvt_pk_bf16_f32 v6, v160, v164
    v_mfma_f32_16x16x32_bf16 a[196:199], v[20:23], a[72:75], a[196:199]
    v_perm_b32 v30, v117, v113, s94
    v_perm_b32 v31, v125, v121, s94
    v_cvt_pk_bf16_f32 v7, v168, v172
    s_cmp_eq_u32 s41, 1
    s_cselect_b64 s[58:59], s[48:49], 0
    v_mfma_f32_16x16x32_bf16 a[228:231], v[20:23], a[76:79], a[228:231]
    ds_read_b128 a[92:95], v5 offset:12288
    v_cvt_pk_bf16_f32 v8, v176, v180
    v_cndmask_b32 v1, v10, 2.0, s[58:59]
    v_mfma_f32_16x16x32_bf16 a[136:139], v[24:27], a[64:67], a[136:139]
    v_perm_b32 v16, v102, v98, s93
    v_perm_b32 v17, v110, v106, s93
    v_cvt_pk_bf16_f32 v9, v184, v188
    v_mfma_f32_16x16x32_bf16 a[168:171], v[24:27], a[68:71], a[168:171]
    buffer_store_dwordx4 v[6:9], v1, s[28:31], s33 offen offset:0 sc1
    v_mfma_f32_16x16x32_bf16 a[200:203], v[24:27], a[72:75], a[200:203]
    v_perm_b32 v18, v118, v114, s93
    v_perm_b32 v19, v126, v122, s93
    v_cvt_pk_bf16_f32 v12, v161, v165
    v_mfma_f32_16x16x32_bf16 a[232:235], v[24:27], a[76:79], a[232:235]
    v_cvt_pk_bf16_f32 v13, v169, v173
    v_mfma_f32_16x16x32_bf16 a[140:143], v[28:31], a[64:67], a[140:143]
    v_perm_b32 v20, v102, v98, s94
    v_perm_b32 v21, v110, v106, s94
    v_cvt_pk_bf16_f32 v14, v177, v181
    v_mfma_f32_16x16x32_bf16 a[172:175], v[28:31], a[68:71], a[172:175]
    v_cvt_pk_bf16_f32 v15, v185, v189
    v_mfma_f32_16x16x32_bf16 a[204:207], v[28:31], a[72:75], a[204:207]
    v_perm_b32 v22, v118, v114, s94
    v_perm_b32 v23, v126, v122, s94
    buffer_store_dwordx4 v[12:15], v1, s[28:31], s33 offen offset:512 sc1
    v_mfma_f32_16x16x32_bf16 a[236:239], v[28:31], a[76:79], a[236:239]
    v_cvt_pk_bf16_f32 v6, v162, v166
    v_mfma_f32_16x16x32_bf16 a[144:147], v[16:19], a[64:67], a[144:147]
    v_perm_b32 v24, v103, v99, s93
    v_perm_b32 v25, v111, v107, s93
    v_cvt_pk_bf16_f32 v7, v170, v174
    v_mfma_f32_16x16x32_bf16 a[176:179], v[16:19], a[68:71], a[176:179]
    v_cvt_pk_bf16_f32 v8, v178, v182
    v_mfma_f32_16x16x32_bf16 a[208:211], v[16:19], a[72:75], a[208:211]
    v_perm_b32 v26, v119, v115, s93
    v_perm_b32 v27, v127, v123, s93
    v_cvt_pk_bf16_f32 v9, v186, v190
    v_mfma_f32_16x16x32_bf16 a[240:243], v[16:19], a[76:79], a[240:243]
    s_waitcnt lgkmcnt(0)
    buffer_store_dwordx4 v[6:9], v1, s[28:31], s33 offen offset:1024 sc1
    v_mfma_f32_16x16x32_bf16 a[148:151], v[20:23], a[64:67], a[148:151]
    v_perm_b32 v28, v103, v99, s94
    v_perm_b32 v29, v111, v107, s94
    v_cvt_pk_bf16_f32 v12, v163, v167
    v_mfma_f32_16x16x32_bf16 a[180:183], v[20:23], a[68:71], a[180:183]
    s_waitcnt vmcnt(7)
    v_cvt_pk_bf16_f32 v13, v171, v175
    v_mfma_f32_16x16x32_bf16 a[212:215], v[20:23], a[72:75], a[212:215]
    v_perm_b32 v30, v119, v115, s94
    v_perm_b32 v31, v127, v123, s94
    v_cvt_pk_bf16_f32 v14, v179, v183
    v_mfma_f32_16x16x32_bf16 a[244:247], v[20:23], a[76:79], a[244:247]
    v_cvt_pk_bf16_f32 v15, v187, v191
    v_mfma_f32_16x16x32_bf16 a[152:155], v[24:27], a[64:67], a[152:155]
    v_perm_b32 v16, v36, v32, s93
    v_perm_b32 v17, v44, v40, s93
    buffer_store_dwordx4 v[12:15], v1, s[28:31], s33 offen offset:1536 sc1
    v_mfma_f32_16x16x32_bf16 a[184:187], v[24:27], a[68:71], a[184:187]
    v_cvt_pk_bf16_f32 v6, v192, v196
    v_mfma_f32_16x16x32_bf16 a[216:219], v[24:27], a[72:75], a[216:219]
    v_perm_b32 v18, v52, v48, s93
    v_perm_b32 v19, v60, v56, s93
    v_cvt_pk_bf16_f32 v7, v200, v204
    s_cmp_eq_u32 s41, 2
    s_cselect_b64 s[58:59], s[48:49], 0
    v_mfma_f32_16x16x32_bf16 a[248:251], v[24:27], a[76:79], a[248:251]
    v_cvt_pk_bf16_f32 v8, v208, v212
    v_cndmask_b32 v1, v10, 2.0, s[58:59]
    v_mfma_f32_16x16x32_bf16 a[156:159], v[28:31], a[64:67], a[156:159]
    v_perm_b32 v20, v36, v32, s94
    v_perm_b32 v21, v44, v40, s94
    v_cvt_pk_bf16_f32 v9, v216, v220
    v_mfma_f32_16x16x32_bf16 a[188:191], v[28:31], a[68:71], a[188:191]
    buffer_store_dwordx4 v[6:9], v1, s[28:31], s34 offen offset:0 sc1
    v_mfma_f32_16x16x32_bf16 a[220:223], v[28:31], a[72:75], a[220:223]
    v_perm_b32 v22, v52, v48, s94
    v_perm_b32 v23, v60, v56, s94
    v_cvt_pk_bf16_f32 v12, v193, v197
    v_mfma_f32_16x16x32_bf16 a[252:255], v[28:31], a[76:79], a[252:255]
    v_cvt_pk_bf16_f32 v13, v201, v205
    v_mfma_f32_16x16x32_bf16 a[128:131], v[16:19], a[80:83], a[128:131]
    v_perm_b32 v24, v37, v33, s93
    v_perm_b32 v25, v45, v41, s93
    v_cvt_pk_bf16_f32 v14, v209, v213
    v_mfma_f32_16x16x32_bf16 a[160:163], v[16:19], a[84:87], a[160:163]
    v_cvt_pk_bf16_f32 v15, v217, v221
    v_mfma_f32_16x16x32_bf16 a[192:195], v[16:19], a[88:91], a[192:195]
    v_perm_b32 v26, v53, v49, s93
    v_perm_b32 v27, v61, v57, s93
    buffer_store_dwordx4 v[12:15], v1, s[28:31], s34 offen offset:512 sc1
    v_mfma_f32_16x16x32_bf16 a[224:227], v[16:19], a[92:95], a[224:227]
    v_cvt_pk_bf16_f32 v6, v194, v198
    v_mfma_f32_16x16x32_bf16 a[132:135], v[20:23], a[80:83], a[132:135]
    v_perm_b32 v28, v37, v33, s94
    v_perm_b32 v29, v45, v41, s94
    v_cvt_pk_bf16_f32 v7, v202, v206
    v_mfma_f32_16x16x32_bf16 a[164:167], v[20:23], a[84:87], a[164:167]
    v_cvt_pk_bf16_f32 v8, v210, v214
    v_mfma_f32_16x16x32_bf16 a[196:199], v[20:23], a[88:91], a[196:199]
    v_perm_b32 v30, v53, v49, s94
    v_perm_b32 v31, v61, v57, s94
    v_cvt_pk_bf16_f32 v9, v218, v222
    v_mfma_f32_16x16x32_bf16 a[228:231], v[20:23], a[92:95], a[228:231]
    buffer_store_dwordx4 v[6:9], v1, s[28:31], s34 offen offset:1024 sc1
    v_mfma_f32_16x16x32_bf16 a[136:139], v[24:27], a[80:83], a[136:139]
    v_perm_b32 v16, v38, v34, s93
    v_perm_b32 v17, v46, v42, s93
    v_cvt_pk_bf16_f32 v12, v195, v199
    v_mfma_f32_16x16x32_bf16 a[168:171], v[24:27], a[84:87], a[168:171]
    v_cvt_pk_bf16_f32 v13, v203, v207
    v_mfma_f32_16x16x32_bf16 a[200:203], v[24:27], a[88:91], a[200:203]
    v_perm_b32 v18, v54, v50, s93
    v_perm_b32 v19, v62, v58, s93
    v_cvt_pk_bf16_f32 v14, v211, v215
    v_mfma_f32_16x16x32_bf16 a[232:235], v[24:27], a[92:95], a[232:235]
    v_cvt_pk_bf16_f32 v15, v219, v223
    v_mfma_f32_16x16x32_bf16 a[140:143], v[28:31], a[80:83], a[140:143]
    v_perm_b32 v20, v38, v34, s94
    v_perm_b32 v21, v46, v42, s94
    buffer_store_dwordx4 v[12:15], v1, s[28:31], s34 offen offset:1536 sc1
    v_mfma_f32_16x16x32_bf16 a[172:175], v[28:31], a[84:87], a[172:175]
    v_cvt_pk_bf16_f32 v6, v224, v228
    v_mfma_f32_16x16x32_bf16 a[204:207], v[28:31], a[88:91], a[204:207]
    v_perm_b32 v22, v54, v50, s94
    v_perm_b32 v23, v62, v58, s94
    v_cvt_pk_bf16_f32 v7, v232, v236
    s_cmp_eq_u32 s41, 3
    s_cselect_b64 s[58:59], s[48:49], 0
    v_mfma_f32_16x16x32_bf16 a[236:239], v[28:31], a[92:95], a[236:239]
    v_cvt_pk_bf16_f32 v8, v240, v244
    v_cndmask_b32 v1, v10, 2.0, s[58:59]
    v_mfma_f32_16x16x32_bf16 a[144:147], v[16:19], a[80:83], a[144:147]
    v_perm_b32 v24, v39, v35, s93
    v_perm_b32 v25, v47, v43, s93
    v_cvt_pk_bf16_f32 v9, v248, v252
    v_mfma_f32_16x16x32_bf16 a[176:179], v[16:19], a[84:87], a[176:179]
    buffer_store_dwordx4 v[6:9], v1, s[28:31], s35 offen offset:0 sc1
    v_mfma_f32_16x16x32_bf16 a[208:211], v[16:19], a[88:91], a[208:211]
    v_perm_b32 v26, v55, v51, s93
    v_perm_b32 v27, v63, v59, s93
    v_cvt_pk_bf16_f32 v12, v225, v229
    v_mfma_f32_16x16x32_bf16 a[240:243], v[16:19], a[92:95], a[240:243]
    v_cvt_pk_bf16_f32 v13, v233, v237
    v_mfma_f32_16x16x32_bf16 a[148:151], v[20:23], a[80:83], a[148:151]
    v_perm_b32 v28, v39, v35, s94
    v_perm_b32 v29, v47, v43, s94
    v_cvt_pk_bf16_f32 v14, v241, v245
    v_mfma_f32_16x16x32_bf16 a[180:183], v[20:23], a[84:87], a[180:183]
    v_cvt_pk_bf16_f32 v15, v249, v253
    v_mfma_f32_16x16x32_bf16 a[212:215], v[20:23], a[88:91], a[212:215]
    v_perm_b32 v30, v55, v51, s94
    v_perm_b32 v31, v63, v59, s94
    buffer_store_dwordx4 v[12:15], v1, s[28:31], s35 offen offset:512 sc1
    v_mfma_f32_16x16x32_bf16 a[244:247], v[20:23], a[92:95], a[244:247]
    v_cvt_pk_bf16_f32 v6, v226, v230
    v_mfma_f32_16x16x32_bf16 a[152:155], v[24:27], a[80:83], a[152:155]
    v_cvt_pk_bf16_f32 v7, v234, v238
    v_cvt_pk_bf16_f32 v8, v242, v246
    v_mfma_f32_16x16x32_bf16 a[184:187], v[24:27], a[84:87], a[184:187]
    v_cvt_pk_bf16_f32 v9, v250, v254
    buffer_store_dwordx4 v[6:9], v1, s[28:31], s35 offen offset:1024 sc1
    v_mfma_f32_16x16x32_bf16 a[216:219], v[24:27], a[88:91], a[216:219]
    v_cvt_pk_bf16_f32 v12, v227, v231
    v_cvt_pk_bf16_f32 v13, v235, v239
    v_mfma_f32_16x16x32_bf16 a[248:251], v[24:27], a[92:95], a[248:251]
    v_cvt_pk_bf16_f32 v14, v243, v247
    v_cvt_pk_bf16_f32 v15, v251, v255
    v_mfma_f32_16x16x32_bf16 a[156:159], v[28:31], a[80:83], a[156:159]
    buffer_store_dwordx4 v[12:15], v1, s[28:31], s35 offen offset:1536 sc1
    v_mfma_f32_16x16x32_bf16 a[188:191], v[28:31], a[84:87], a[188:191]
    v_mfma_f32_16x16x32_bf16 a[220:223], v[28:31], a[88:91], a[220:223]
    v_mfma_f32_16x16x32_bf16 a[252:255], v[28:31], a[92:95], a[252:255]
    s_xor_b32 s6, s3, 1
    s_mul_i32 s6, s6, 24576
    s_add_u32 s6, s6, 65536
    v_add_u32 v3, s6, v11
    s_xor_b32 s6, s3, 2
    s_mul_i32 s6, s6, 24576
    s_add_u32 s6, s6, 73728
    v_add_u32 v4, s6, v11
    s_xor_b32 s6, s3, 3
    s_mul_i32 s6, s6, 24576
    s_add_u32 s6, s6, 81920
    v_add_u32 v5, s6, v11
    s_mul_i32 s6, s3, 24576
    s_add_u32 s6, s6, 65536
    v_add_u32 v2, s6, v11
    ds_write_b128 v3, a[160:163] offset:0
    ds_write_b128 v4, a[192:195] offset:0
    s_cmp_lg_u32 s5, 0
    s_cbranch_scc1 L_pkm0
    v_permlane32_swap_b32 v128, v129
    v_permlane32_swap_b32 v132, v133
    v_permlane32_swap_b32 v136, v137
    v_permlane32_swap_b32 v140, v141
    v_permlane32_swap_b32 v144, v145
    v_permlane32_swap_b32 v148, v149
    v_permlane32_swap_b32 v152, v153
    v_permlane32_swap_b32 v156, v157
    v_permlane32_swap_b32 v130, v131
    v_permlane32_swap_b32 v134, v135
    v_permlane32_swap_b32 v138, v139
    v_permlane32_swap_b32 v142, v143
    v_permlane32_swap_b32 v146, v147
    v_permlane32_swap_b32 v150, v151
    v_permlane32_swap_b32 v154, v155
    v_permlane32_swap_b32 v158, v159
    v_mov_b32 v16, v128
    v_mov_b32 v17, v132
    v_mov_b32 v18, v136
    v_mov_b32 v19, v140
    v_mov_b32 v20, v144
    v_mov_b32 v21, v148
    v_mov_b32 v22, v152
    v_mov_b32 v23, v156
    v_mov_b32 v24, v130
    v_mov_b32 v25, v134
    v_mov_b32 v26, v138
    v_mov_b32 v27, v142
    v_mov_b32 v28, v146
    v_mov_b32 v29, v150
    v_mov_b32 v30, v154
    v_mov_b32 v31, v158
    s_branch L_pkme
L_pkm0:
    s_cmp_lg_u32 s5, 1
    s_cbranch_scc1 L_pkm1
    v_permlane32_swap_b32 v128, v129
    v_permlane32_swap_b32 v132, v133
    v_permlane32_swap_b32 v136, v137
    v_permlane32_swap_b32 v140, v141
    v_permlane32_swap_b32 v144, v145
    v_permlane32_swap_b32 v148, v149
    v_permlane32_swap_b32 v152, v153
    v_permlane32_swap_b32 v156, v157
    v_permlane32_swap_b32 v130, v131
    v_permlane32_swap_b32 v134, v135
    v_permlane32_swap_b32 v138, v139
    v_permlane32_swap_b32 v142, v143
    v_permlane32_swap_b32 v146, v147
    v_permlane32_swap_b32 v150, v151
    v_permlane32_swap_b32 v154, v155
    v_permlane32_swap_b32 v158, v159
    v_mov_b32 v16, v129
    v_mov_b32 v17, v133
    v_mov_b32 v18, v137
    v_mov_b32 v19, v141
    v_mov_b32 v20, v145
    v_mov_b32 v21, v149
    v_mov_b32 v22, v153
    v_mov_b32 v23, v157
    v_mov_b32 v24, v131
    v_mov_b32 v25, v135
    v_mov_b32 v26, v139
    v_mov_b32 v27, v143
    v_mov_b32 v28, v147
    v_mov_b32 v29, v151
    v_mov_b32 v30, v155
    v_mov_b32 v31, v159
    s_branch L_pkme
L_pkm1:
    s_cmp_lg_u32 s5, 2
    s_cbranch_scc1 L_pkm2
    v_permlane32_swap_b32 v160, v161
    v_permlane32_swap_b32 v164, v165
    v_permlane32_swap_b32 v168, v169
    v_permlane32_swap_b32 v172, v173
    v_permlane32_swap_b32 v176, v177
    v_permlane32_swap_b32 v180, v181
    v_permlane32_swap_b32 v184, v185
    v_permlane32_swap_b32 v188, v189
    v_permlane32_swap_b32 v162, v163
    v_permlane32_swap_b32 v166, v167
    v_permlane32_swap_b32 v170, v171
    v_permlane32_swap_b32 v174, v175
    v_permlane32_swap_b32 v178, v179
    v_permlane32_swap_b32 v182, v183
    v_permlane32_swap_b32 v186, v187
    v_permlane32_swap_b32 v190, v191
    v_mov_b32 v16, v160
    v_mov_b32 v17, v164
    v_mov_b32 v18, v168
    v_mov_b32 v19, v172
    v_mov_b32 v20, v176
    v_mov_b32 v21, v180
    v_mov_b32 v22, v184
    v_mov_b32 v23, v188
    v_mov_b32 v24, v162
    v_mov_b32 v25, v166
    v_mov_b32 v26, v170
    v_mov_b32 v27, v174
    v_mov_b32 v28, v178
    v_mov_b32 v29, v182
    v_mov_b32 v30, v186
    v_mov_b32 v31, v190
    s_branch L_pkme
L_pkm2:
    s_cmp_lg_u32 s5, 3
    s_cbranch_scc1 L_pkm3
    v_permlane32_swap_b32 v160, v161
    v_permlane32_swap_b32 v164, v165
    v_permlane32_swap_b32 v168, v169
    v_permlane32_swap_b32 v172, v173
    v_permlane32_swap_b32 v176, v177
    v_permlane32_swap_b32 v180, v181
    v_permlane32_swap_b32 v184, v185
    v_permlane32_swap_b32 v188, v189
    v_permlane32_swap_b32 v162, v163
    v_permlane32_swap_b32 v166, v167
    v_permlane32_swap_b32 v170, v171
    v_permlane32_swap_b32 v174, v175
    v_permlane32_swap_b32 v178, v179
    v_permlane32_swap_b32 v182, v183
    v_permlane32_swap_b32 v186, v187
    v_permlane32_swap_b32 v190, v191
    v_mov_b32 v16, v161
    v_mov_b32 v17, v165
    v_mov_b32 v18, v169
    v_mov_b32 v19, v173
    v_mov_b32 v20, v177
    v_mov_b32 v21, v181
    v_mov_b32 v22, v185
    v_mov_b32 v23, v189
    v_mov_b32 v24, v163
    v_mov_b32 v25, v167
    v_mov_b32 v26, v171
    v_mov_b32 v27, v175
    v_mov_b32 v28, v179
    v_mov_b32 v29, v183
    v_mov_b32 v30, v187
    v_mov_b32 v31, v191
    s_branch L_pkme
L_pkm3:
    s_cmp_lg_u32 s5, 4
    s_cbranch_scc1 L_pkm4
    v_permlane32_swap_b32 v192, v193
    v_permlane32_swap_b32 v196, v197
    v_permlane32_swap_b32 v200, v201
    v_permlane32_swap_b32 v204, v205
    v_permlane32_swap_b32 v208, v209
    v_permlane32_swap_b32 v212, v213
    v_permlane32_swap_b32 v216, v217
    v_permlane32_swap_b32 v220, v221
    v_permlane32_swap_b32 v194, v195
    v_permlane32_swap_b32 v198, v199
    v_permlane32_swap_b32 v202, v203
    v_permlane32_swap_b32 v206, v207
    v_permlane32_swap_b32 v210, v211
    v_permlane32_swap_b32 v214, v215
    v_permlane32_swap_b32 v218, v219
    v_permlane32_swap_b32 v222, v223
    v_mov_b32 v16, v192
    v_mov_b32 v17, v196
    v_mov_b32 v18, v200
    v_mov_b32 v19, v204
    v_mov_b32 v20, v208
    v_mov_b32 v21, v212
    v_mov_b32 v22, v216
    v_mov_b32 v23, v220
    v_mov_b32 v24, v194
    v_mov_b32 v25, v198
    v_mov_b32 v26, v202
    v_mov_b32 v27, v206
    v_mov_b32 v28, v210
    v_mov_b32 v29, v214
    v_mov_b32 v30, v218
    v_mov_b32 v31, v222
    s_branch L_pkme
L_pkm4:
    s_cmp_lg_u32 s5, 5
    s_cbranch_scc1 L_pkm5
    v_permlane32_swap_b32 v192, v193
    v_permlane32_swap_b32 v196, v197
    v_permlane32_swap_b32 v200, v201
    v_permlane32_swap_b32 v204, v205
    v_permlane32_swap_b32 v208, v209
    v_permlane32_swap_b32 v212, v213
    v_permlane32_swap_b32 v216, v217
    v_permlane32_swap_b32 v220, v221
    v_permlane32_swap_b32 v194, v195
    v_permlane32_swap_b32 v198, v199
    v_permlane32_swap_b32 v202, v203
    v_permlane32_swap_b32 v206, v207
    v_permlane32_swap_b32 v210, v211
    v_permlane32_swap_b32 v214, v215
    v_permlane32_swap_b32 v218, v219
    v_permlane32_swap_b32 v222, v223
    v_mov_b32 v16, v193
    v_mov_b32 v17, v197
    v_mov_b32 v18, v201
    v_mov_b32 v19, v205
    v_mov_b32 v20, v209
    v_mov_b32 v21, v213
    v_mov_b32 v22, v217
    v_mov_b32 v23, v221
    v_mov_b32 v24, v195
    v_mov_b32 v25, v199
    v_mov_b32 v26, v203
    v_mov_b32 v27, v207
    v_mov_b32 v28, v211
    v_mov_b32 v29, v215
    v_mov_b32 v30, v219
    v_mov_b32 v31, v223
    s_branch L_pkme
L_pkm5:
    s_cmp_lg_u32 s5, 6
    s_cbranch_scc1 L_pkm6
    v_permlane32_swap_b32 v224, v225
    v_permlane32_swap_b32 v228, v229
    v_permlane32_swap_b32 v232, v233
    v_permlane32_swap_b32 v236, v237
    v_permlane32_swap_b32 v240, v241
    v_permlane32_swap_b32 v244, v245
    v_permlane32_swap_b32 v248, v249
    v_permlane32_swap_b32 v252, v253
    v_permlane32_swap_b32 v226, v227
    v_permlane32_swap_b32 v230, v231
    v_permlane32_swap_b32 v234, v235
    v_permlane32_swap_b32 v238, v239
    v_permlane32_swap_b32 v242, v243
    v_permlane32_swap_b32 v246, v247
    v_permlane32_swap_b32 v250, v251
    v_permlane32_swap_b32 v254, v255
    v_mov_b32 v16, v224
    v_mov_b32 v17, v228
    v_mov_b32 v18, v232
    v_mov_b32 v19, v236
    v_mov_b32 v20, v240
    v_mov_b32 v21, v244
    v_mov_b32 v22, v248
    v_mov_b32 v23, v252
    v_mov_b32 v24, v226
    v_mov_b32 v25, v230
    v_mov_b32 v26, v234
    v_mov_b32 v27, v238
    v_mov_b32 v28, v242
    v_mov_b32 v29, v246
    v_mov_b32 v30, v250
    v_mov_b32 v31, v254
    s_branch L_pkme
L_pkm6:
    v_permlane32_swap_b32 v224, v225
    v_permlane32_swap_b32 v228, v229
    v_permlane32_swap_b32 v232, v233
    v_permlane32_swap_b32 v236, v237
    v_permlane32_swap_b32 v240, v241
    v_permlane32_swap_b32 v244, v245
    v_permlane32_swap_b32 v248, v249
    v_permlane32_swap_b32 v252, v253
    v_permlane32_swap_b32 v226, v227
    v_permlane32_swap_b32 v230, v231
    v_permlane32_swap_b32 v234, v235
    v_permlane32_swap_b32 v238, v239
    v_permlane32_swap_b32 v242, v243
    v_permlane32_swap_b32 v246, v247
    v_permlane32_swap_b32 v250, v251
    v_permlane32_swap_b32 v254, v255
    v_mov_b32 v16, v225
    v_mov_b32 v17, v229
    v_mov_b32 v18, v233
    v_mov_b32 v19, v237
    v_mov_b32 v20, v241
    v_mov_b32 v21, v245
    v_mov_b32 v22, v249
    v_mov_b32 v23, v253
    v_mov_b32 v24, v227
    v_mov_b32 v25, v231
    v_mov_b32 v26, v235
    v_mov_b32 v27, v239
    v_mov_b32 v28, v243
    v_mov_b32 v29, v247
    v_mov_b32 v30, v251
    v_mov_b32 v31, v255
L_pkme:
    ds_write_b128 v5, a[224:227] offset:0
    v_accvgpr_read_b32 v128, a128
    v_accvgpr_read_b32 v129, a129
    v_accvgpr_read_b32 v130, a130
    v_accvgpr_read_b32 v131, a131
    v_accvgpr_read_b32 v132, a132
    v_accvgpr_read_b32 v133, a133
    v_accvgpr_read_b32 v134, a134
    ds_write_b128 v3, a[164:167] offset:1024
    v_accvgpr_read_b32 v135, a135
    v_accvgpr_read_b32 v136, a136
    v_accvgpr_read_b32 v137, a137
    v_accvgpr_read_b32 v138, a138
    v_accvgpr_read_b32 v139, a139
    v_accvgpr_read_b32 v140, a140
    v_accvgpr_read_b32 v141, a141
    s_waitcnt lgkmcnt(11)
    ds_write_b128 v4, a[196:199] offset:1024
    v_accvgpr_read_b32 v142, a142
    v_accvgpr_read_b32 v143, a143
    v_accvgpr_read_b32 v144, a144
    v_accvgpr_read_b32 v145, a145
    v_accvgpr_read_b32 v146, a146
    v_accvgpr_read_b32 v147, a147
    v_accvgpr_read_b32 v148, a148
    ds_write_b128 v5, a[228:231] offset:1024
    v_accvgpr_read_b32 v149, a149
    v_accvgpr_read_b32 v150, a150
    v_accvgpr_read_b32 v151, a151
    v_accvgpr_read_b32 v152, a152
    v_accvgpr_read_b32 v153, a153
    v_accvgpr_read_b32 v154, a154
    v_accvgpr_read_b32 v155, a155
    ds_write_b128 v3, a[168:171] offset:2048
    v_accvgpr_read_b32 v156, a156
    v_accvgpr_read_b32 v157, a157
    v_accvgpr_read_b32 v158, a158
    v_accvgpr_read_b32 v159, a159
    s_lshl_b32 s6, s3, 12
    s_add_u32 s6, s6, s92
    s_add_u32 s6, s6, 65536
    ds_write_b128 v4, a[200:203] offset:2048
    v_accvgpr_read_b32 v10, a96
    s_lshr_b32 s37, s2, 3
    s_mul_i32 s39, s37, 655360
    s_lshl_b32 s40, s3, 14
    s_lshl_b32 s38, s5, 11
    s_add_u32 s40, s40, s38
    s_add_u32 s42, s40, s39
    s_waitcnt lgkmcnt(11)
    ds_write_b128 v5, a[232:235] offset:2048
    s_add_u32 s45, s5, 0
    s_and_b32 s45, s45, 7
    s_mul_i32 s45, s45, 81920
    s_add_u32 s72, s42, s45
    s_add_u32 s45, s5, 1
    s_and_b32 s45, s45, 7
    ds_write_b128 v3, a[172:175] offset:3072
    s_mul_i32 s45, s45, 81920
    s_add_u32 s73, s42, s45
    s_add_u32 s45, s5, 2
    s_and_b32 s45, s45, 7
    s_mul_i32 s45, s45, 81920
    s_add_u32 s74, s42, s45
    ds_write_b128 v4, a[204:207] offset:3072
    s_add_u32 s45, s5, 3
    s_and_b32 s45, s45, 7
    s_mul_i32 s45, s45, 81920
    s_add_u32 s75, s42, s45
    s_add_u32 s45, s5, 4
    s_and_b32 s45, s45, 7
    ds_write_b128 v5, a[236:239] offset:3072
    s_mul_i32 s45, s45, 81920
    s_add_u32 s76, s42, s45
    s_add_u32 s45, s5, 5
    s_and_b32 s45, s45, 7
    s_mul_i32 s45, s45, 81920
    s_add_u32 s77, s42, s45
    s_waitcnt lgkmcnt(11)
    ds_write_b128 v3, a[176:179] offset:4096
    s_add_u32 s45, s5, 6
    s_and_b32 s45, s45, 7
    s_mul_i32 s45, s45, 81920
    s_add_u32 s78, s42, s45
    s_add_u32 s45, s5, 7
    s_and_b32 s45, s45, 7
    ds_write_b128 v4, a[208:211] offset:4096
    s_mul_i32 s45, s45, 81920
    s_add_u32 s79, s42, s45
    s_lshl_b32 s38, s3, 12
    s_lshl_b32 s45, s5, 9
    s_add_u32 s38, s38, s45
    s_add_u32 s38, s38, 65536
    ds_write_b128 v5, a[240:243] offset:4096
    s_sub_u32 s45, s38, s40
    v_add_u32 v12, s45, v11
    v_bfe_u32 v13, v11, 6, 2
    v_lshrrev_b32 v14, 9, v11
    v_lshl_add_u32 v13, v13, 1, v14
    v_bfe_u32 v14, v11, 4, 2
    ds_write_b128 v3, a[180:183] offset:5120
    v_bfe_u32 v7, v11, 8, 1
    v_lshl_add_u32 v14, v14, 1, v7
    v_lshlrev_b32 v14, 4, v14
    v_lshl_add_u32 v13, v13, 9, v14
    s_and_b32 s44, s37, 15
    s_mul_i32 s44, s44, 163840
    s_waitcnt lgkmcnt(11)
    ds_write_b128 v4, a[212:215] offset:5120
    s_lshr_b32 s45, s37, 4
    s_mul_i32 s45, s45, 1280
    s_add_u32 s44, s44, s45
    s_and_b32 s45, s5, 1
    s_lshl_b32 s45, s45, 7
    s_add_u32 s44, s44, s45
    ds_write_b128 v5, a[244:247] offset:5120
    s_mul_i32 s45, s41, 40960
    s_add_u32 s46, s44, s45
    s_lshl_b32 s45, s3, 8
    s_add_u32 s46, s46, s45
    s_lshl_b32 s45, s3, 2
    s_add_u32 s45, s45, s41
    ds_write_b128 v3, a[184:187] offset:6144
    s_mul_i32 s45, s45, 10240
    s_add_u32 s47, s44, s45
    s_add_u32 s47, s47, 1024
    s_mov_b32 s50, 0x3f80
    s_mov_b32 s51, 0x3f800000
    s_mov_b32 s52, 0xffff0000
    ds_write_b128 v4, a[216:219] offset:6144
    v_bfe_u32 v6, v11, 4, 4
    v_bfe_u32 v7, v11, 8, 1
    v_mul_u32_u24 v6, 2560, v6
    v_lshl_add_u32 v6, v7, 6, v6
    v_lshrrev_b32 v7, 9, v11
    v_lshl_add_u32 v6, v7, 4, v6
    s_waitcnt lgkmcnt(11)
    ds_write_b128 v5, a[248:251] offset:6144
    v_bfe_u32 v7, v11, 7, 1
    v_mul_u32_u24 v7, 20448, v7
    v_sub_u32 v6, v6, v7
    v_bfe_u32 v14, v11, 5, 2
    v_bfe_u32 v7, v11, 4, 1
    v_mul_u32_u24 v14, 2560, v14
    ds_write_b128 v3, a[188:191] offset:7168
    v_lshl_add_u32 v14, v7, 6, v14
    v_lshrrev_b32 v7, 7, v11
    v_lshl_add_u32 v14, v7, 4, v14
    v_lshrrev_b32 v7, 2, v11
    s_lshl_b32 s54, s37, 9
    s_lshl_b32 s45, s3, 7
    ds_write_b128 v4, a[220:223] offset:7168
    s_add_u32 s54, s54, s45
    s_add_u32 s54, s54, 33554432
    s_lshl_b32 s45, s5, 2
    s_add_u32 s53, s54, s45
    s_lshl_b32 s45, 1, s5
    s_andn2_b32 s60, 0xff, s45
    ds_write_b128 v5, a[252:255] offset:7168
    s_mov_b32 s61, 0
    s_mov_b32 s48, -1
    s_mov_b32 s49, 0
    s_mov_b32 s55, 1048576
    v_mov_b32 v8, 1
    v_mov_b32 v9, 2
    s_waitcnt lgkmcnt(11)
    s_waitcnt lgkmcnt(0)
    s_barrier
    ds_read_b128 v[32:35], v2 offset:0
    ds_read_b128 v[36:39], v2 offset:1024
    ds_read_b128 v[40:43], v2 offset:2048
    ds_read_b128 v[44:47], v2 offset:3072
    ds_read_b128 v[48:51], v2 offset:4096
    ds_read_b128 v[52:55], v2 offset:5120
    ds_read_b128 v[56:59], v2 offset:6144
    ds_read_b128 v[60:63], v2 offset:7168
    ds_read_b128 v[64:67], v2 offset:8192
    ds_read_b128 v[68:71], v2 offset:9216
    ds_read_b128 v[72:75], v2 offset:10240
    ds_read_b128 v[76:79], v2 offset:11264
    s_waitcnt lgkmcnt(4)
    s_waitcnt vmcnt(0)
    s_mov_b64 exec, 1
    buffer_store_dword v8, off, s[28:31], s53 sc1
    s_mov_b64 exec, -1
    v_add_f32 v128, v128, v32
    v_add_f32 v129, v129, v33
    v_add_f32 v130, v130, v34
    v_add_f32 v131, v131, v35
    v_add_f32 v132, v132, v36
    v_add_f32 v133, v133, v37
    v_add_f32 v134, v134, v38
    v_add_f32 v135, v135, v39
    v_add_f32 v136, v136, v40
    v_add_f32 v137, v137, v41
    v_add_f32 v138, v138, v42
    v_add_f32 v139, v139, v43
    v_add_f32 v140, v140, v44
    v_add_f32 v141, v141, v45
    v_add_f32 v142, v142, v46
    v_add_f32 v143, v143, v47
    v_add_f32 v144, v144, v48
    v_add_f32 v145, v145, v49
    v_add_f32 v146, v146, v50
    v_add_f32 v147, v147, v51
    v_add_f32 v148, v148, v52
    v_add_f32 v149, v149, v53
    v_add_f32 v150, v150, v54
    v_add_f32 v151, v151, v55
    v_add_f32 v152, v152, v56
    v_add_f32 v153, v153, v57
    v_add_f32 v154, v154, v58
    v_add_f32 v155, v155, v59
    v_add_f32 v156, v156, v60
    v_add_f32 v157, v157, v61
    v_add_f32 v158, v158, v62
    v_add_f32 v159, v159, v63
    ds_read_b128 v[80:83], v2 offset:12288
    ds_read_b128 v[84:87], v2 offset:13312
    ds_read_b128 v[88:91], v2 offset:14336
    ds_read_b128 v[92:95], v2 offset:15360
    ds_read_b128 v[96:99], v2 offset:16384
    ds_read_b128 v[100:103], v2 offset:17408
    ds_read_b128 v[104:107], v2 offset:18432
    ds_read_b128 v[108:111], v2 offset:19456
    s_waitcnt lgkmcnt(4)
    v_add_f32 v128, v128, v64
    v_add_f32 v129, v129, v65
    v_add_f32 v130, v130, v66
    v_add_f32 v131, v131, v67
    v_add_f32 v132, v132, v68
    v_add_f32 v133, v133, v69
    v_add_f32 v134, v134, v70
    v_add_f32 v135, v135, v71
    v_add_f32 v136, v136, v72
    v_add_f32 v137, v137, v73
    v_add_f32 v138, v138, v74
    v_add_f32 v139, v139, v75
    v_add_f32 v140, v140, v76
    v_add_f32 v141, v141, v77
    v_add_f32 v142, v142, v78
    v_add_f32 v143, v143, v79
    v_add_f32 v144, v144, v80
    v_add_f32 v145, v145, v81
    v_add_f32 v146, v146, v82
    v_add_f32 v147, v147, v83
    v_add_f32 v148, v148, v84
    v_add_f32 v149, v149, v85
    v_add_f32 v150, v150, v86
    v_add_f32 v151, v151, v87
    v_add_f32 v152, v152, v88
    v_add_f32 v153, v153, v89
    v_add_f32 v154, v154, v90
    v_add_f32 v155, v155, v91
    v_add_f32 v156, v156, v92
    v_add_f32 v157, v157, v93
    v_add_f32 v158, v158, v94
    v_add_f32 v159, v159, v95
    ds_read_b128 v[112:115], v2 offset:20480
    ds_read_b128 v[116:119], v2 offset:21504
    ds_read_b128 v[120:123], v2 offset:22528
    ds_read_b128 v[124:127], v2 offset:23552
    s_waitcnt lgkmcnt(0)
    v_add_f32 v128, v128, v96
    v_add_f32 v129, v129, v97
    v_add_f32 v130, v130, v98
    v_add_f32 v131, v131, v99
    v_add_f32 v132, v132, v100
    v_add_f32 v133, v133, v101
    v_add_f32 v134, v134, v102
    v_add_f32 v135, v135, v103
    v_add_f32 v136, v136, v104
    v_add_f32 v137, v137, v105
    v_add_f32 v138, v138, v106
    v_add_f32 v139, v139, v107
    v_add_f32 v140, v140, v108
    v_add_f32 v141, v141, v109
    v_add_f32 v142, v142, v110
    v_add_f32 v143, v143, v111
    v_add_f32 v144, v144, v112
    v_add_f32 v145, v145, v113
    v_add_f32 v146, v146, v114
    v_add_f32 v147, v147, v115
    v_add_f32 v148, v148, v116
    v_add_f32 v149, v149, v117
    v_add_f32 v150, v150, v118
    v_add_f32 v151, v151, v119
    v_add_f32 v152, v152, v120
    v_add_f32 v153, v153, v121
    v_add_f32 v154, v154, v122
    v_add_f32 v155, v155, v123
    v_add_f32 v156, v156, v124
    v_add_f32 v157, v157, v125
    v_add_f32 v158, v158, v126
    v_add_f32 v159, v159, v127
    v_cvt_pk_bf16_f32 v160, v128, v132
    v_cvt_pk_bf16_f32 v161, v136, v140
    v_cvt_pk_bf16_f32 v162, v144, v148
    v_cvt_pk_bf16_f32 v163, v152, v156
    buffer_store_dwordx4 v[160:163], v13, s[28:31], s6 offen offset:0 sc1
    v_cvt_pk_bf16_f32 v164, v129, v133
    v_cvt_pk_bf16_f32 v165, v137, v141
    v_cvt_pk_bf16_f32 v166, v145, v149
    v_cvt_pk_bf16_f32 v167, v153, v157
    buffer_store_dwordx4 v[164:167], v13, s[28:31], s6 offen offset:128 sc1
    v_cvt_pk_bf16_f32 v168, v130, v134
    v_cvt_pk_bf16_f32 v169, v138, v142
    v_cvt_pk_bf16_f32 v170, v146, v150
    v_cvt_pk_bf16_f32 v171, v154, v158
    buffer_store_dwordx4 v[168:171], v13, s[28:31], s6 offen offset:256 sc1
    v_cvt_pk_bf16_f32 v172, v131, v135
    v_cvt_pk_bf16_f32 v173, v139, v143
    v_cvt_pk_bf16_f32 v174, v147, v151
    v_cvt_pk_bf16_f32 v175, v155, v159
    buffer_store_dwordx4 v[172:175], v13, s[28:31], s6 offen offset:384 sc1
    s_mov_b64 exec, 1
L_clr:
    v_readfirstlane_b32 s56, v10
    s_sub_u32 s55, s55, 1
    s_cbranch_scc1 L_poll0
    s_cmp_ge_u32 s56, 8
    s_cbranch_scc1 L_poll0
    buffer_load_dword v10, off, s[16:19], s36 sc1
    s_waitcnt vmcnt(0)
    s_branch L_clr
L_poll0:
    s_max_i32 s55, s55, 0
    s_mov_b64 exec, s[60:61]
    buffer_load_dword v8, v7, s[28:31], s54 offen sc1
    s_waitcnt vmcnt(1)
    s_mov_b64 exec, 1
    buffer_store_dword v9, off, s[28:31], s53 sc1
    s_mov_b64 exec, s[60:61]
    s_waitcnt vmcnt(1)
L_p1:
    v_cmp_gt_u32 s[56:57], 1, v8
    s_sub_u32 s55, s55, 1
    s_cbranch_scc1 L_p1e
    s_nop 2
    s_cmp_eq_u32 s56, 0
    s_cbranch_scc1 L_p1e
    buffer_load_dword v8, v7, s[28:31], s54 offen sc1
    s_waitcnt vmcnt(0)
    s_branch L_p1
L_p1e:
    s_max_i32 s55, s55, 0
    v_cmp_gt_u32 s[56:57], 2, v8
    s_mov_b64 exec, -1
    buffer_load_dwordx4 v[32:35], v11, s[28:31], s73 offen offset:0 sc1
    buffer_load_dwordx4 v[36:39], v11, s[28:31], s73 offen offset:1024 sc1
    buffer_load_dwordx4 v[44:47], v11, s[28:31], s74 offen offset:0 sc1
    buffer_load_dwordx4 v[48:51], v11, s[28:31], s74 offen offset:1024 sc1
    buffer_load_dwordx4 v[56:59], v11, s[28:31], s75 offen offset:0 sc1
    buffer_load_dwordx4 v[60:63], v11, s[28:31], s75 offen offset:1024 sc1
    buffer_load_dwordx4 v[68:71], v11, s[28:31], s76 offen offset:0 sc1
    buffer_load_dwordx4 v[72:75], v11, s[28:31], s76 offen offset:1024 sc1
    buffer_load_dwordx4 v[80:83], v11, s[28:31], s77 offen offset:0 sc1
    buffer_load_dwordx4 v[84:87], v11, s[28:31], s77 offen offset:1024 sc1
    buffer_load_dwordx4 v[92:95], v11, s[28:31], s78 offen offset:0 sc1
    buffer_load_dwordx4 v[96:99], v11, s[28:31], s78 offen offset:1024 sc1
    buffer_load_dwordx4 v[104:107], v11, s[28:31], s79 offen offset:0 sc1
    buffer_load_dwordx4 v[108:111], v11, s[28:31], s79 offen offset:1024 sc1
    s_cmp_eq_u32 s56, 0
    s_cbranch_scc1 L_fast
    s_mov_b64 exec, s[60:61]
    buffer_load_dword v8, v7, s[28:31], s54 offen sc1
    s_mov_b64 exec, -1
    s_waitcnt vmcnt(14)
    v_dot2c_f32_bf16 v16, s50, v32
    v_dot2c_f32_bf16 v17, s51, v32
    v_dot2c_f32_bf16 v18, s50, v33
    v_dot2c_f32_bf16 v19, s51, v33
    v_dot2c_f32_bf16 v20, s50, v34
    v_dot2c_f32_bf16 v21, s51, v34
    v_dot2c_f32_bf16 v22, s50, v35
    v_dot2c_f32_bf16 v23, s51, v35
    s_waitcnt vmcnt(13)
    v_dot2c_f32_bf16 v24, s50, v36
    v_dot2c_f32_bf16 v25, s51, v36
    v_dot2c_f32_bf16 v26, s50, v37
    v_dot2c_f32_bf16 v27, s51, v37
    v_dot2c_f32_bf16 v28, s50, v38
    v_dot2c_f32_bf16 v29, s51, v38
    v_dot2c_f32_bf16 v30, s50, v39
    v_dot2c_f32_bf16 v31, s51, v39
    s_waitcnt vmcnt(12)
    v_dot2c_f32_bf16 v16, s50, v44
    v_dot2c_f32_bf16 v17, s51, v44
    v_dot2c_f32_bf16 v18, s50, v45
    v_dot2c_f32_bf16 v19, s51, v45
    v_dot2c_f32_bf16 v20, s50, v46
    v_dot2c_f32_bf16 v21, s51, v46
    v_dot2c_f32_bf16 v22, s50, v47
    v_dot2c_f32_bf16 v23, s51, v47
    s_waitcnt vmcnt(11)
    v_dot2c_f32_bf16 v24, s50, v48
    v_dot2c_f32_bf16 v25, s51, v48
    v_dot2c_f32_bf16 v26, s50, v49
    v_dot2c_f32_bf16 v27, s51, v49
    v_dot2c_f32_bf16 v28, s50, v50
    v_dot2c_f32_bf16 v29, s51, v50
    v_dot2c_f32_bf16 v30, s50, v51
    v_dot2c_f32_bf16 v31, s51, v51
    s_waitcnt vmcnt(10)
    v_dot2c_f32_bf16 v16, s50, v56
    v_dot2c_f32_bf16 v17, s51, v56
    v_dot2c_f32_bf16 v18, s50, v57
    v_dot2c_f32_bf16 v19, s51, v57
    v_dot2c_f32_bf16 v20, s50, v58
    v_dot2c_f32_bf16 v21, s51, v58
    v_dot2c_f32_bf16 v22, s50, v59
    v_dot2c_f32_bf16 v23, s51, v59
    s_waitcnt vmcnt(9)
    v_dot2c_f32_bf16 v24, s50, v60
    v_dot2c_f32_bf16 v25, s51, v60
    v_dot2c_f32_bf16 v26, s50, v61
    v_dot2c_f32_bf16 v27, s51, v61
    v_dot2c_f32_bf16 v28, s50, v62
    v_dot2c_f32_bf16 v29, s51, v62
    v_dot2c_f32_bf16 v30, s50, v63
    v_dot2c_f32_bf16 v31, s51, v63
    s_waitcnt vmcnt(8)
    v_dot2c_f32_bf16 v16, s50, v68
    v_dot2c_f32_bf16 v17, s51, v68
    v_dot2c_f32_bf16 v18, s50, v69
    v_dot2c_f32_bf16 v19, s51, v69
    v_dot2c_f32_bf16 v20, s50, v70
    v_dot2c_f32_bf16 v21, s51, v70
    v_dot2c_f32_bf16 v22, s50, v71
    v_dot2c_f32_bf16 v23, s51, v71
    s_waitcnt vmcnt(7)
    v_dot2c_f32_bf16 v24, s50, v72
    v_dot2c_f32_bf16 v25, s51, v72
    v_dot2c_f32_bf16 v26, s50, v73
    v_dot2c_f32_bf16 v27, s51, v73
    v_dot2c_f32_bf16 v28, s50, v74
    v_dot2c_f32_bf16 v29, s51, v74
    v_dot2c_f32_bf16 v30, s50, v75
    v_dot2c_f32_bf16 v31, s51, v75
    s_waitcnt vmcnt(6)
    v_dot2c_f32_bf16 v16, s50, v80
    v_dot2c_f32_bf16 v17, s51, v80
    v_dot2c_f32_bf16 v18, s50, v81
    v_dot2c_f32_bf16 v19, s51, v81
    v_dot2c_f32_bf16 v20, s50, v82
    v_dot2c_f32_bf16 v21, s51, v82
    v_dot2c_f32_bf16 v22, s50, v83
    v_dot2c_f32_bf16 v23, s51, v83
    s_waitcnt vmcnt(5)
    v_dot2c_f32_bf16 v24, s50, v84
    v_dot2c_f32_bf16 v25, s51, v84
    v_dot2c_f32_bf16 v26, s50, v85
    v_dot2c_f32_bf16 v27, s51, v85
    v_dot2c_f32_bf16 v28, s50, v86
    v_dot2c_f32_bf16 v29, s51, v86
    v_dot2c_f32_bf16 v30, s50, v87
    v_dot2c_f32_bf16 v31, s51, v87
    s_waitcnt vmcnt(4)
    v_dot2c_f32_bf16 v16, s50, v92
    v_dot2c_f32_bf16 v17, s51, v92
    v_dot2c_f32_bf16 v18, s50, v93
    v_dot2c_f32_bf16 v19, s51, v93
    v_dot2c_f32_bf16 v20, s50, v94
    v_dot2c_f32_bf16 v21, s51, v94
    v_dot2c_f32_bf16 v22, s50, v95
    v_dot2c_f32_bf16 v23, s51, v95
    s_waitcnt vmcnt(3)
    v_dot2c_f32_bf16 v24, s50, v96
    v_dot2c_f32_bf16 v25, s51, v96
    v_dot2c_f32_bf16 v26, s50, v97
    v_dot2c_f32_bf16 v27, s51, v97
    v_dot2c_f32_bf16 v28, s50, v98
    v_dot2c_f32_bf16 v29, s51, v98
    v_dot2c_f32_bf16 v30, s50, v99
    v_dot2c_f32_bf16 v31, s51, v99
    s_waitcnt vmcnt(2)
    v_dot2c_f32_bf16 v16, s50, v104
    v_dot2c_f32_bf16 v17, s51, v104
    v_dot2c_f32_bf16 v18, s50, v105
    v_dot2c_f32_bf16 v19, s51, v105
    v_dot2c_f32_bf16 v20, s50, v106
    v_dot2c_f32_bf16 v21, s51, v106
    v_dot2c_f32_bf16 v22, s50, v107
    v_dot2c_f32_bf16 v23, s51, v107
    s_waitcnt vmcnt(1)
    v_dot2c_f32_bf16 v24, s50, v108
    v_dot2c_f32_bf16 v25, s51, v108
    v_dot2c_f32_bf16 v26, s50, v109
    v_dot2c_f32_bf16 v27, s51, v109
    v_dot2c_f32_bf16 v28, s50, v110
    v_dot2c_f32_bf16 v29, s51, v110
    v_dot2c_f32_bf16 v30, s50, v111
    v_dot2c_f32_bf16 v31, s51, v111
    s_waitcnt vmcnt(0)
    s_mov_b64 exec, s[60:61]
L_p2:
    v_cmp_gt_u32 s[56:57], 2, v8
    s_sub_u32 s55, s55, 1
    s_cbranch_scc1 L_p2e
    s_nop 2
    s_cmp_eq_u32 s56, 0
    s_cbranch_scc1 L_p2e
    buffer_load_dword v8, v7, s[28:31], s54 offen sc1
    s_waitcnt vmcnt(0)
    s_branch L_p2
L_p2e:
    s_max_i32 s55, s55, 0
    s_mov_b64 exec, s[48:49]
    buffer_load_dwordx4 v[40:43], v12, s[28:31], s72 offen sc1
    buffer_load_dwordx4 v[52:55], v12, s[28:31], s73 offen sc1
    buffer_load_dwordx4 v[64:67], v12, s[28:31], s74 offen sc1
    buffer_load_dwordx4 v[76:79], v12, s[28:31], s75 offen sc1
    buffer_load_dwordx4 v[88:91], v12, s[28:31], s76 offen sc1
    buffer_load_dwordx4 v[100:103], v12, s[28:31], s77 offen sc1
    buffer_load_dwordx4 v[112:115], v12, s[28:31], s78 offen sc1
    buffer_load_dwordx4 v[124:127], v12, s[28:31], s79 offen sc1
    s_mov_b64 exec, -1
    s_nop 1
    v_cvt_pk_bf16_f32 v192, v16, v17
    v_cvt_pk_bf16_f32 v193, v18, v19
    v_cvt_pk_bf16_f32 v194, v20, v21
    v_cvt_pk_bf16_f32 v195, v22, v23
    v_cvt_pk_bf16_f32 v196, v24, v25
    v_cvt_pk_bf16_f32 v197, v26, v27
    v_cvt_pk_bf16_f32 v198, v28, v29
    v_cvt_pk_bf16_f32 v199, v30, v31
    v_mov_b32 v204, v192
    v_mov_b32 v205, v193
    v_mov_b32 v206, v194
    v_mov_b32 v207, v195
    s_add_u32 s45, s46, 20480
    v_mov_b32_dpp v192, v196 row_ror:8 row_mask:0xf bank_mask:0xc
    v_mov_b32_dpp v193, v197 row_ror:8 row_mask:0xf bank_mask:0xc
    v_mov_b32_dpp v194, v198 row_ror:8 row_mask:0xf bank_mask:0xc
    v_mov_b32_dpp v195, v199 row_ror:8 row_mask:0xf bank_mask:0xc
    v_mov_b32_dpp v196, v204 row_ror:8 row_mask:0xf bank_mask:0x3
    v_mov_b32_dpp v197, v205 row_ror:8 row_mask:0xf bank_mask:0x3
    v_mov_b32_dpp v198, v206 row_ror:8 row_mask:0xf bank_mask:0x3
    v_mov_b32_dpp v199, v207 row_ror:8 row_mask:0xf bank_mask:0x3
    buffer_store_dwordx4 v[192:195], v6, s[12:15], s46 offen
    buffer_store_dwordx4 v[196:199], v6, s[12:15], s45 offen
    s_waitcnt vmcnt(9)
    v_lshlrev_b32 v176, 16, v40
    v_and_b32 v177, s52, v40
    v_lshlrev_b32 v178, 16, v41
    v_and_b32 v179, s52, v41
    v_lshlrev_b32 v180, 16, v42
    v_and_b32 v181, s52, v42
    v_lshlrev_b32 v182, 16, v43
    v_and_b32 v183, s52, v43
    s_waitcnt vmcnt(8)
    v_dot2c_f32_bf16 v176, s50, v52
    v_dot2c_f32_bf16 v177, s51, v52
    v_dot2c_f32_bf16 v178, s50, v53
    v_dot2c_f32_bf16 v179, s51, v53
    v_dot2c_f32_bf16 v180, s50, v54
    v_dot2c_f32_bf16 v181, s51, v54
    v_dot2c_f32_bf16 v182, s50, v55
    v_dot2c_f32_bf16 v183, s51, v55
    s_waitcnt vmcnt(7)
    v_dot2c_f32_bf16 v176, s50, v64
    v_dot2c_f32_bf16 v177, s51, v64
    v_dot2c_f32_bf16 v178, s50, v65
    v_dot2c_f32_bf16 v179, s51, v65
    v_dot2c_f32_bf16 v180, s50, v66
    v_dot2c_f32_bf16 v181, s51, v66
    v_dot2c_f32_bf16 v182, s50, v67
    v_dot2c_f32_bf16 v183, s51, v67
    s_waitcnt vmcnt(6)
    v_dot2c_f32_bf16 v176, s50, v76
    v_dot2c_f32_bf16 v177, s51, v76
    v_dot2c_f32_bf16 v178, s50, v77
    v_dot2c_f32_bf16 v179, s51, v77
    v_dot2c_f32_bf16 v180, s50, v78
    v_dot2c_f32_bf16 v181, s51, v78
    v_dot2c_f32_bf16 v182, s50, v79
    v_dot2c_f32_bf16 v183, s51, v79
    s_waitcnt vmcnt(5)
    v_dot2c_f32_bf16 v176, s50, v88
    v_dot2c_f32_bf16 v177, s51, v88
    v_dot2c_f32_bf16 v178, s50, v89
    v_dot2c_f32_bf16 v179, s51, v89
    v_dot2c_f32_bf16 v180, s50, v90
    v_dot2c_f32_bf16 v181, s51, v90
    v_dot2c_f32_bf16 v182, s50, v91
    v_dot2c_f32_bf16 v183, s51, v91
    s_waitcnt vmcnt(4)
    v_dot2c_f32_bf16 v176, s50, v100
    v_dot2c_f32_bf16 v177, s51, v100
    v_dot2c_f32_bf16 v178, s50, v101
    v_dot2c_f32_bf16 v179, s51, v101
    v_dot2c_f32_bf16 v180, s50, v102
    v_dot2c_f32_bf16 v181, s51, v102
    v_dot2c_f32_bf16 v182, s50, v103
    v_dot2c_f32_bf16 v183, s51, v103
    s_waitcnt vmcnt(3)
    v_dot2c_f32_bf16 v176, s50, v112
    v_dot2c_f32_bf16 v177, s51, v112
    v_dot2c_f32_bf16 v178, s50, v113
    v_dot2c_f32_bf16 v179, s51, v113
    v_dot2c_f32_bf16 v180, s50, v114
    v_dot2c_f32_bf16 v181, s51, v114
    v_dot2c_f32_bf16 v182, s50, v115
    v_dot2c_f32_bf16 v183, s51, v115
    s_waitcnt vmcnt(2)
    v_dot2c_f32_bf16 v176, s50, v124
    v_dot2c_f32_bf16 v177, s51, v124
    v_dot2c_f32_bf16 v178, s50, v125
    v_dot2c_f32_bf16 v179, s51, v125
    v_dot2c_f32_bf16 v180, s50, v126
    v_dot2c_f32_bf16 v181, s51, v126
    v_dot2c_f32_bf16 v182, s50, v127
    v_dot2c_f32_bf16 v183, s51, v127
    s_nop 1
    v_cvt_pk_bf16_f32 v200, v176, v177
    v_cvt_pk_bf16_f32 v201, v178, v179
    v_cvt_pk_bf16_f32 v202, v180, v181
    v_cvt_pk_bf16_f32 v203, v182, v183
    s_mov_b64 exec, s[48:49]
    buffer_store_dwordx4 v[200:203], v14, s[12:15], s47 offen
    s_endpgm
L_fast:
    s_mov_b64 exec, s[48:49]
    buffer_load_dwordx4 v[40:43], v12, s[28:31], s72 offen sc1
    buffer_load_dwordx4 v[52:55], v12, s[28:31], s73 offen sc1
    buffer_load_dwordx4 v[64:67], v12, s[28:31], s74 offen sc1
    buffer_load_dwordx4 v[76:79], v12, s[28:31], s75 offen sc1
    buffer_load_dwordx4 v[88:91], v12, s[28:31], s76 offen sc1
    buffer_load_dwordx4 v[100:103], v12, s[28:31], s77 offen sc1
    buffer_load_dwordx4 v[112:115], v12, s[28:31], s78 offen sc1
    buffer_load_dwordx4 v[124:127], v12, s[28:31], s79 offen sc1
    s_mov_b64 exec, -1
    s_waitcnt vmcnt(21)
    v_dot2c_f32_bf16 v16, s50, v32
    v_dot2c_f32_bf16 v17, s51, v32
    v_dot2c_f32_bf16 v18, s50, v33
    v_dot2c_f32_bf16 v19, s51, v33
    v_dot2c_f32_bf16 v20, s50, v34
    v_dot2c_f32_bf16 v21, s51, v34
    v_dot2c_f32_bf16 v22, s50, v35
    v_dot2c_f32_bf16 v23, s51, v35
    s_waitcnt vmcnt(20)
    v_dot2c_f32_bf16 v24, s50, v36
    v_dot2c_f32_bf16 v25, s51, v36
    v_dot2c_f32_bf16 v26, s50, v37
    v_dot2c_f32_bf16 v27, s51, v37
    v_dot2c_f32_bf16 v28, s50, v38
    v_dot2c_f32_bf16 v29, s51, v38
    v_dot2c_f32_bf16 v30, s50, v39
    v_dot2c_f32_bf16 v31, s51, v39
    s_waitcnt vmcnt(19)
    v_dot2c_f32_bf16 v16, s50, v44
    v_dot2c_f32_bf16 v17, s51, v44
    v_dot2c_f32_bf16 v18, s50, v45
    v_dot2c_f32_bf16 v19, s51, v45
    v_dot2c_f32_bf16 v20, s50, v46
    v_dot2c_f32_bf16 v21, s51, v46
    v_dot2c_f32_bf16 v22, s50, v47
    v_dot2c_f32_bf16 v23, s51, v47
    s_waitcnt vmcnt(18)
    v_dot2c_f32_bf16 v24, s50, v48
    v_dot2c_f32_bf16 v25, s51, v48
    v_dot2c_f32_bf16 v26, s50, v49
    v_dot2c_f32_bf16 v27, s51, v49
    v_dot2c_f32_bf16 v28, s50, v50
    v_dot2c_f32_bf16 v29, s51, v50
    v_dot2c_f32_bf16 v30, s50, v51
    v_dot2c_f32_bf16 v31, s51, v51
    s_waitcnt vmcnt(17)
    v_dot2c_f32_bf16 v16, s50, v56
    v_dot2c_f32_bf16 v17, s51, v56
    v_dot2c_f32_bf16 v18, s50, v57
    v_dot2c_f32_bf16 v19, s51, v57
    v_dot2c_f32_bf16 v20, s50, v58
    v_dot2c_f32_bf16 v21, s51, v58
    v_dot2c_f32_bf16 v22, s50, v59
    v_dot2c_f32_bf16 v23, s51, v59
    s_waitcnt vmcnt(16)
    v_dot2c_f32_bf16 v24, s50, v60
    v_dot2c_f32_bf16 v25, s51, v60
    v_dot2c_f32_bf16 v26, s50, v61
    v_dot2c_f32_bf16 v27, s51, v61
    v_dot2c_f32_bf16 v28, s50, v62
    v_dot2c_f32_bf16 v29, s51, v62
    v_dot2c_f32_bf16 v30, s50, v63
    v_dot2c_f32_bf16 v31, s51, v63
    s_waitcnt vmcnt(15)
    v_dot2c_f32_bf16 v16, s50, v68
    v_dot2c_f32_bf16 v17, s51, v68
    v_dot2c_f32_bf16 v18, s50, v69
    v_dot2c_f32_bf16 v19, s51, v69
    v_dot2c_f32_bf16 v20, s50, v70
    v_dot2c_f32_bf16 v21, s51, v70
    v_dot2c_f32_bf16 v22, s50, v71
    v_dot2c_f32_bf16 v23, s51, v71
    s_waitcnt vmcnt(14)
    v_dot2c_f32_bf16 v24, s50, v72
    v_dot2c_f32_bf16 v25, s51, v72
    v_dot2c_f32_bf16 v26, s50, v73
    v_dot2c_f32_bf16 v27, s51, v73
    v_dot2c_f32_bf16 v28, s50, v74
    v_dot2c_f32_bf16 v29, s51, v74
    v_dot2c_f32_bf16 v30, s50, v75
    v_dot2c_f32_bf16 v31, s51, v75
    s_waitcnt vmcnt(13)
    v_dot2c_f32_bf16 v16, s50, v80
    v_dot2c_f32_bf16 v17, s51, v80
    v_dot2c_f32_bf16 v18, s50, v81
    v_dot2c_f32_bf16 v19, s51, v81
    v_dot2c_f32_bf16 v20, s50, v82
    v_dot2c_f32_bf16 v21, s51, v82
    v_dot2c_f32_bf16 v22, s50, v83
    v_dot2c_f32_bf16 v23, s51, v83
    s_waitcnt vmcnt(12)
    v_dot2c_f32_bf16 v24, s50, v84
    v_dot2c_f32_bf16 v25, s51, v84
    v_dot2c_f32_bf16 v26, s50, v85
    v_dot2c_f32_bf16 v27, s51, v85
    v_dot2c_f32_bf16 v28, s50, v86
    v_dot2c_f32_bf16 v29, s51, v86
    v_dot2c_f32_bf16 v30, s50, v87
    v_dot2c_f32_bf16 v31, s51, v87
    s_waitcnt vmcnt(11)
    v_dot2c_f32_bf16 v16, s50, v92
    v_dot2c_f32_bf16 v17, s51, v92
    v_dot2c_f32_bf16 v18, s50, v93
    v_dot2c_f32_bf16 v19, s51, v93
    v_dot2c_f32_bf16 v20, s50, v94
    v_dot2c_f32_bf16 v21, s51, v94
    v_dot2c_f32_bf16 v22, s50, v95
    v_dot2c_f32_bf16 v23, s51, v95
    s_waitcnt vmcnt(10)
    v_dot2c_f32_bf16 v24, s50, v96
    v_dot2c_f32_bf16 v25, s51, v96
    v_dot2c_f32_bf16 v26, s50, v97
    v_dot2c_f32_bf16 v27, s51, v97
    v_dot2c_f32_bf16 v28, s50, v98
    v_dot2c_f32_bf16 v29, s51, v98
    v_dot2c_f32_bf16 v30, s50, v99
    v_dot2c_f32_bf16 v31, s51, v99
    s_waitcnt vmcnt(9)
    v_dot2c_f32_bf16 v16, s50, v104
    v_dot2c_f32_bf16 v17, s51, v104
    v_dot2c_f32_bf16 v18, s50, v105
    v_dot2c_f32_bf16 v19, s51, v105
    v_dot2c_f32_bf16 v20, s50, v106
    v_dot2c_f32_bf16 v21, s51, v106
    v_dot2c_f32_bf16 v22, s50, v107
    v_dot2c_f32_bf16 v23, s51, v107
    s_waitcnt vmcnt(8)
    v_dot2c_f32_bf16 v24, s50, v108
    v_dot2c_f32_bf16 v25, s51, v108
    v_dot2c_f32_bf16 v26, s50, v109
    v_dot2c_f32_bf16 v27, s51, v109
    v_dot2c_f32_bf16 v28, s50, v110
    v_dot2c_f32_bf16 v29, s51, v110
    v_dot2c_f32_bf16 v30, s50, v111
    v_dot2c_f32_bf16 v31, s51, v111
    s_nop 1
    v_cvt_pk_bf16_f32 v192, v16, v17
    v_cvt_pk_bf16_f32 v193, v18, v19
    v_cvt_pk_bf16_f32 v194, v20, v21
    v_cvt_pk_bf16_f32 v195, v22, v23
    v_cvt_pk_bf16_f32 v196, v24, v25
    v_cvt_pk_bf16_f32 v197, v26, v27
    v_cvt_pk_bf16_f32 v198, v28, v29
    v_cvt_pk_bf16_f32 v199, v30, v31
    v_mov_b32 v204, v192
    v_mov_b32 v205, v193
    v_mov_b32 v206, v194
    v_mov_b32 v207, v195
    s_add_u32 s45, s46, 20480
    v_mov_b32_dpp v192, v196 row_ror:8 row_mask:0xf bank_mask:0xc
    v_mov_b32_dpp v193, v197 row_ror:8 row_mask:0xf bank_mask:0xc
    v_mov_b32_dpp v194, v198 row_ror:8 row_mask:0xf bank_mask:0xc
    v_mov_b32_dpp v195, v199 row_ror:8 row_mask:0xf bank_mask:0xc
    v_mov_b32_dpp v196, v204 row_ror:8 row_mask:0xf bank_mask:0x3
    v_mov_b32_dpp v197, v205 row_ror:8 row_mask:0xf bank_mask:0x3
    v_mov_b32_dpp v198, v206 row_ror:8 row_mask:0xf bank_mask:0x3
    v_mov_b32_dpp v199, v207 row_ror:8 row_mask:0xf bank_mask:0x3
    buffer_store_dwordx4 v[192:195], v6, s[12:15], s46 offen
    buffer_store_dwordx4 v[196:199], v6, s[12:15], s45 offen
    s_waitcnt vmcnt(9)
    v_lshlrev_b32 v176, 16, v40
    v_and_b32 v177, s52, v40
    v_lshlrev_b32 v178, 16, v41
    v_and_b32 v179, s52, v41
    v_lshlrev_b32 v180, 16, v42
    v_and_b32 v181, s52, v42
    v_lshlrev_b32 v182, 16, v43
    v_and_b32 v183, s52, v43
    s_waitcnt vmcnt(8)
    v_dot2c_f32_bf16 v176, s50, v52
    v_dot2c_f32_bf16 v177, s51, v52
    v_dot2c_f32_bf16 v178, s50, v53
    v_dot2c_f32_bf16 v179, s51, v53
    v_dot2c_f32_bf16 v180, s50, v54
    v_dot2c_f32_bf16 v181, s51, v54
    v_dot2c_f32_bf16 v182, s50, v55
    v_dot2c_f32_bf16 v183, s51, v55
    s_waitcnt vmcnt(7)
    v_dot2c_f32_bf16 v176, s50, v64
    v_dot2c_f32_bf16 v177, s51, v64
    v_dot2c_f32_bf16 v178, s50, v65
    v_dot2c_f32_bf16 v179, s51, v65
    v_dot2c_f32_bf16 v180, s50, v66
    v_dot2c_f32_bf16 v181, s51, v66
    v_dot2c_f32_bf16 v182, s50, v67
    v_dot2c_f32_bf16 v183, s51, v67
    s_waitcnt vmcnt(6)
    v_dot2c_f32_bf16 v176, s50, v76
    v_dot2c_f32_bf16 v177, s51, v76
    v_dot2c_f32_bf16 v178, s50, v77
    v_dot2c_f32_bf16 v179, s51, v77
    v_dot2c_f32_bf16 v180, s50, v78
    v_dot2c_f32_bf16 v181, s51, v78
    v_dot2c_f32_bf16 v182, s50, v79
    v_dot2c_f32_bf16 v183, s51, v79
    s_waitcnt vmcnt(5)
    v_dot2c_f32_bf16 v176, s50, v88
    v_dot2c_f32_bf16 v177, s51, v88
    v_dot2c_f32_bf16 v178, s50, v89
    v_dot2c_f32_bf16 v179, s51, v89
    v_dot2c_f32_bf16 v180, s50, v90
    v_dot2c_f32_bf16 v181, s51, v90
    v_dot2c_f32_bf16 v182, s50, v91
    v_dot2c_f32_bf16 v183, s51, v91
    s_waitcnt vmcnt(4)
    v_dot2c_f32_bf16 v176, s50, v100
    v_dot2c_f32_bf16 v177, s51, v100
    v_dot2c_f32_bf16 v178, s50, v101
    v_dot2c_f32_bf16 v179, s51, v101
    v_dot2c_f32_bf16 v180, s50, v102
    v_dot2c_f32_bf16 v181, s51, v102
    v_dot2c_f32_bf16 v182, s50, v103
    v_dot2c_f32_bf16 v183, s51, v103
    s_waitcnt vmcnt(3)
    v_dot2c_f32_bf16 v176, s50, v112
    v_dot2c_f32_bf16 v177, s51, v112
    v_dot2c_f32_bf16 v178, s50, v113
    v_dot2c_f32_bf16 v179, s51, v113
    v_dot2c_f32_bf16 v180, s50, v114
    v_dot2c_f32_bf16 v181, s51, v114
    v_dot2c_f32_bf16 v182, s50, v115
    v_dot2c_f32_bf16 v183, s51, v115
    s_waitcnt vmcnt(2)
    v_dot2c_f32_bf16 v176, s50, v124
    v_dot2c_f32_bf16 v177, s51, v124
    v_dot2c_f32_bf16 v178, s50, v125
    v_dot2c_f32_bf16 v179, s51, v125
    v_dot2c_f32_bf16 v180, s50, v126
    v_dot2c_f32_bf16 v181, s51, v126
    v_dot2c_f32_bf16 v182, s50, v127
    v_dot2c_f32_bf16 v183, s51, v127
    s_nop 1
    v_cvt_pk_bf16_f32 v200, v176, v177
    v_cvt_pk_bf16_f32 v201, v178, v179
    v_cvt_pk_bf16_f32 v202, v180, v181
    v_cvt_pk_bf16_f32 v203, v182, v183
    s_mov_b64 exec, s[48:49]
    buffer_store_dwordx4 v[200:203], v14, s[12:15], s47 offen
L_summed:
L_main_end:
    s_endpgm
L_code_end:
.section .rodata,"a"
.p2align 6
.amdhsa_kernel concat_heads__gqa_block_cached__mha_block_cached__near_ridge_kernel
  .amdhsa_next_free_vgpr 512
  .amdhsa_next_free_sgpr 102
  .amdhsa_accum_offset 256
  .amdhsa_group_segment_fixed_size 0
  .amdhsa_kernarg_size 104
  .amdhsa_user_sgpr_count 2
  .amdhsa_user_sgpr_kernarg_segment_ptr 1
  .amdhsa_system_sgpr_workgroup_id_x 1
.end_amdhsa_kernel
```
